```python
import torch

def _softmax(x, axis=-1):
    return torch.softmax(x, dim=axis)
def _gelu(x):
    return torch.nn.functional.gelu(x, approximate="tanh")
def _silu(x):
    return torch.nn.functional.silu(x)
def _sigmoid(x):
    return torch.sigmoid(x)
def _layernorm(x, axis=-1, eps=1e-5):
    m = x.mean(dim=axis, keepdim=True)
    v = x.var(dim=axis, keepdim=True, unbiased=False)
    return (x - m) / torch.sqrt(v + eps)
def _scatter_add(tgt, idx, src, axis=0):
    return tgt.clone().index_add_(axis, idx, src)
def _segment_sum(src, seg, n):
    out = torch.zeros((n,) + src.shape[1:], dtype=src.dtype)
    return out.index_add_(0, seg, src)
def _pad(x, pw):
    flat = tuple(v for pair in reversed(pw) for v in pair)
    return torch.nn.functional.pad(x, flat)

kernel_name = 'interleave_layers__linear_attn_block__sliding_block__prompt'

def setup_inputs():

    _w = (lambda a: (lambda t: t.to(torch.bfloat16) if t.is_floating_point() else t)(torch.as_tensor(a)))
    def _A_setup():
        B, S, D = 1, 2048, 576
        return {
            "x": _w((lambda *s: torch.randn(*s, dtype=torch.bfloat16) * 0.05)(B, S, D)),
            "wqkv": _w((lambda *s: torch.randn(*s, dtype=torch.bfloat16) * 0.05)(D, 3 * D)),
            "wo": _w((lambda *s: torch.randn(*s, dtype=torch.bfloat16) * 0.05)(D, D)),
        }
    _A_in = _A_setup()

    def _B_setup():
        B, S, D = 1, 2048, 576
        return {
            "x": _w((lambda *s: torch.randn(*s, dtype=torch.bfloat16) * 0.05)(B, S, D)),
            "wqkv": _w((lambda *s: torch.randn(*s, dtype=torch.bfloat16) * 0.1)(D, 3 * D)),
            "wo": _w((lambda *s: torch.randn(*s, dtype=torch.bfloat16) * 0.05)(D, D)),
        }
    _B_in = _B_setup()

    return {
        "A_x": _A_in["x"],
        "A_wqkv": _A_in["wqkv"],
        "A_wo": _A_in["wo"],
        "B_x": _B_in["x"],
        "B_wqkv": _B_in["wqkv"],
        "B_wo": _B_in["wo"],
    }

def reference(A_x, A_wqkv, A_wo, B_x, B_wqkv, B_wo):
    def _A_ref(x, wqkv, wo):
        B, S, D = x.shape
        H = 32; Dh = D // H
        qkv = (lambda x, *d: x.permute(*d))((x @ wqkv).reshape(B, S, 3, H, Dh), 2, 0, 3, 1, 4)
        q, k, v = qkv[0], qkv[1], qkv[2]
        phi = lambda t: torch.where(t > 0, t + 1, torch.exp(t)) + 1e-6
        pq, pk = phi(q), phi(k)
        kv = torch.einsum("bhsd,bhse->bhde", pk, v)
        z = torch.einsum("bhsd->bhd", pk)
        num = torch.einsum("bhqd,bhde->bhqe", pq, kv)
        den = torch.einsum("bhqd,bhd->bhq", pq, z)[..., None] + 1e-6
        o = num / den
        return (lambda x, *d: x.permute(*d))(o, 0, 2, 1, 3).reshape(B, S, D) @ wo

    def _B_ref(x, wqkv, wo):
        B, S, D = x.shape
        H = 32; Dh = D // H; W = 256
        qkv = (lambda x, *d: x.permute(*d))((x @ wqkv).reshape(B, S, 3, H, Dh), 2, 0, 3, 1, 4)
        q, k, v = qkv[0], qkv[1], qkv[2]
        scores = torch.einsum("bhqd,bhkd->bhqk", q, k) * (Dh ** -0.5)
        idx = torch.arange(S)
        mask = (idx[:, None] - idx[None, :] >= 0) & (idx[:, None] - idx[None, :] < W)
        scores = torch.where(mask[None, None], scores, -1e9)
        p = _softmax(scores, axis=-1)
        o = torch.einsum("bhqk,bhkd->bhqd", p, v)
        return (lambda x, *d: x.permute(*d))(o, 0, 2, 1, 3).reshape(B, S, D) @ wo

    x = A_x
    x = x + _A_ref(_layernorm(x, axis=-1), A_wqkv, A_wo)
    x = x + _B_ref(_layernorm(x, axis=-1), B_wqkv, B_wo)
    x = x + _A_ref(_layernorm(x, axis=-1), A_wqkv, A_wo)
    x = x + _B_ref(_layernorm(x, axis=-1), B_wqkv, B_wo)
    return x
```

```asm
; @launch grid=(256,1,1) block=(256,1,1) lds=163840
.amdgcn_target "amdgcn-amd-amdhsa--gfx950"
.text
.globl interleave_layers__linear_attn_block__sliding_block__prompt_kernel
.p2align 8
.type interleave_layers__linear_attn_block__sliding_block__prompt_kernel,@function
interleave_layers__linear_attn_block__sliding_block__prompt_kernel:
  s_cmp_ge_u32 s2, 256
  s_cbranch_scc1 L_end
  s_load_dwordx16 s[32:47], s[0:1], 0
  s_load_dwordx2 s[48:49], s[0:1], 64
  s_cmp_ge_u32 s2, 8
  s_cbranch_scc1 Lnoepf_1
  s_getpc_b64 s[4:5]
  v_lshlrev_b32 v2, 5, v0
  v_mov_b32 v3, s5
  v_add_co_u32 v2, vcc, s4, v2
  s_nop 1
  v_addc_co_u32 v3, vcc, 0, v3, vcc
  global_load_dword v165, v[2:3], off
Lnoepf_1:
  v_lshrrev_b32 v1, 6, v0
  v_and_b32 v16, 63, v0
  v_readfirstlane_b32 s54, v1
  s_and_b32 s80, s2, 7
  s_lshr_b32 s81, s2, 3
  s_and_b32 s53, s81, 15
  s_lshr_b32 s81, s81, 4
  s_lshl_b32 s52, s80, 1
  s_add_u32 s52, s52, s81
  s_lshl_b32 s77, s53, 2
  s_add_u32 s77, s77, s54
  v_and_b32 v56, 3, v16
  v_bfe_u32 v58, v16, 2, 2
  v_lshrrev_b32 v67, 4, v16
  v_mov_b32 v50, 2147483648
  s_mul_i32 s73, s54, 18432
  s_add_u32 s51, s73, 73728
  s_mul_i32 s78, s77, 37
  s_lshr_b32 s78, s78, 8
  s_mul_i32 s79, s78, 7
  s_sub_u32 s79, s77, s79
  s_cmp_ge_u32 s78, 8
  s_cselect_b32 s82, 72, 8
  s_mov_b32 s83, 110592
  s_cselect_b32 s83, 995328, s83
  s_mul_i32 s84, s78, 248832
  s_cselect_b32 s84, 221184, s84
  v_mad_u32_u24 v60, s82, v67, v58
  v_mul_u32_u24 v60, 3456, v60
  v_and_b32 v62, 1, v56
  v_mad_u32_u24 v60, v62, 36, v60
  v_lshrrev_b32 v62, 1, v56
  v_lshl_add_u32 v60, v62, 4, v60
  s_and_b32 s72, s79, 1
  s_lshr_b32 s74, s79, 1
  s_add_u32 s80, s74, 1
  s_cmp_ge_u32 s74, 2
  s_cselect_b32 s80, 0, s80
  s_mul_i32 s80, s80, 1152
  s_mul_i32 s81, s72, 72
  s_and_b32 s85, s52, 7
  s_mul_i32 s85, s85, 144
  s_add_u32 s84, s84, s85
  s_add_u32 s80, s80, s81
  s_add_u32 s64, s84, s80
  s_add_u32 s65, s64, 13824
  s_add_u32 s66, s64, s83
  s_add_u32 s67, s65, s83
  s_cmp_lg_u32 s79, 6
  s_cbranch_scc1 Lnomx_2
  v_bfe_u32 v63, v16, 1, 2
  v_and_b32 v63, 2, v63
  v_and_b32 v64, 1, v16
  v_or_b32 v64, v63, v64
  v_cmp_eq_u32 vcc, 2, v64
  v_min_u32 v64, 2, v64
  v_mul_u32_u24 v64, 1152, v64
  v_sub_u32 v64, 2336, v64
  v_bfe_u32 v63, v16, 3, 1
  v_mad_u32_u24 v64, v63, 36, v64
  v_bfe_u32 v63, v16, 1, 1
  v_mul_u32_u24 v63, 72, v63
  v_mul_u32_u24 v62, 3456, v67
  v_add3_u32 v64, v64, v63, v62
  v_cndmask_b32 v60, v64, v50, vcc
  s_mul_i32 s82, s82, 3456
Lnomx_2:
  s_waitcnt lgkmcnt(0)
  s_load_dword s50, s[48:49], 0
  s_cmp_ge_u32 s52, 8
  s_cselect_b32 s16, s40, s34
  s_cselect_b32 s17, s41, s35
  s_mov_b32 s18, 1990656
  s_mov_b32 s19, 0x20000
  s_cselect_b32 s24, s42, s36
  s_cselect_b32 s25, s43, s37
  s_mov_b32 s26, 663552
  s_mov_b32 s27, 0x20000
  s_cmp_eq_u32 s79, 6
  s_cbranch_scc1 Lmxjob_3
  s_add_u32 m0, s51, 0
  s_nop 0
  buffer_load_dwordx4 v60, s[16:19], s64 offen lds
  s_add_u32 m0, s51, 1024
  s_nop 0
  buffer_load_dwordx4 v60, s[16:19], s65 offen lds
  s_add_u32 m0, s51, 2048
  s_nop 0
  buffer_load_dwordx4 v60, s[16:19], s66 offen lds
  s_add_u32 m0, s51, 3072
  s_nop 0
  buffer_load_dwordx4 v60, s[16:19], s67 offen lds
  s_branch Ljobs_4
Lmxjob_3:
  s_add_u32 m0, s51, 0
  s_nop 0
  buffer_load_dword v60, s[16:19], s64 offen lds
  s_add_u32 m0, s51, 1024
  s_nop 0
  buffer_load_dword v60, s[16:19], s65 offen lds
  s_add_u32 m0, s51, 2048
  s_nop 0
  buffer_load_dword v60, s[16:19], s66 offen lds
  s_add_u32 m0, s51, 3072
  s_nop 0
  buffer_load_dword v60, s[16:19], s67 offen lds
  s_add_u32 m0, s51, 256
  s_add_u32 s64, s64, s82
  buffer_load_dword v60, s[16:19], s64 offen lds
  s_add_u32 m0, s51, 1280
  s_add_u32 s65, s65, s82
  buffer_load_dword v60, s[16:19], s65 offen lds
  s_add_u32 m0, s51, 2304
  s_add_u32 s66, s66, s82
  buffer_load_dword v60, s[16:19], s66 offen lds
  s_add_u32 m0, s51, 3328
  s_add_u32 s67, s67, s82
  buffer_load_dword v60, s[16:19], s67 offen lds
  s_add_u32 m0, s51, 512
  s_add_u32 s64, s64, s82
  buffer_load_dword v60, s[16:19], s64 offen lds
  s_add_u32 m0, s51, 1536
  s_add_u32 s65, s65, s82
  buffer_load_dword v60, s[16:19], s65 offen lds
  s_add_u32 m0, s51, 2560
  s_add_u32 s66, s66, s82
  buffer_load_dword v60, s[16:19], s66 offen lds
  s_add_u32 m0, s51, 3584
  s_add_u32 s67, s67, s82
  buffer_load_dword v60, s[16:19], s67 offen lds
  s_add_u32 m0, s51, 768
  s_add_u32 s64, s64, s82
  buffer_load_dword v60, s[16:19], s64 offen lds
  s_add_u32 m0, s51, 1792
  s_add_u32 s65, s65, s82
  buffer_load_dword v60, s[16:19], s65 offen lds
  s_add_u32 m0, s51, 2816
  s_add_u32 s66, s66, s82
  buffer_load_dword v60, s[16:19], s66 offen lds
  s_add_u32 m0, s51, 3840
  s_add_u32 s67, s67, s82
  buffer_load_dword v60, s[16:19], s67 offen lds
Ljobs_4:
  s_lshl_b32 s68, s53, 1
  s_add_u32 s68, s68, s54
  s_cmp_ge_u32 s54, 2
  s_cselect_b32 s68, 27, s68
  s_mul_i32 s100, s68, 86
  s_lshr_b32 s100, s100, 8
  s_mul_i32 s101, s100, 3
  s_sub_u32 s101, s68, s101
  v_cmp_gt_u32 s[86:87], 2, v56
  v_lshlrev_b32 v65, 4, v56
  v_lshlrev_b32 v61, 3, v56
  v_cndmask_b32 v61, v50, v61, s[86:87]
  s_cmp_eq_u32 s101, 2
  s_cselect_b64 s[86:87], -1, 0
  v_cndmask_b32 v65, v65, v61, s[86:87]
  v_lshrrev_b32 v63, 1, v67
  v_mad_u32_u24 v62, v63, 18, v58
  v_and_b32 v63, 1, v67
  v_lshl_add_u32 v62, v63, 3, v62
  v_mul_u32_u24 v61, 72, v67
  v_lshrrev_b32 v63, 1, v58
  v_mul_u32_u24 v63, 18, v63
  v_and_b32 v64, 1, v58
  v_add3_u32 v61, v61, v63, v64
  s_mov_b32 s83, 41472
  s_mov_b32 s81, 4608
  s_mul_i32 s84, s100, 82944
  s_cmp_ge_u32 s100, 8
  s_cselect_b64 s[88:89], -1, 0
  s_cselect_b32 s83, 331776, s83
  s_cselect_b32 s81, 41472, s81
  s_cselect_b32 s84, 18432, s84
  v_cndmask_b32 v62, v62, v61, s[88:89]
  v_mul_u32_u24 v62, 1152, v62
  v_add_u32 v65, v65, v62
  s_add_u32 s84, s84, s85
  s_lshl_b32 s80, s101, 6
  s_add_u32 s84, s84, s80
  s_cmp_ge_u32 s68, 27
  s_cselect_b32 s20, 1073741824, s84
  s_add_u32 s21, s20, s81
  s_add_u32 s22, s20, s83
  s_add_u32 s23, s21, s83
  s_mov_b32 s12, s32
  s_mov_b32 s13, s33
  s_mov_b32 s14, 2359296
  s_mov_b32 s15, 0x20000
  s_barrier
  s_add_u32 m0, s51, 4096
  s_nop 0
  buffer_load_dwordx4 v65, s[24:27], s20 offen lds
  s_add_u32 m0, s51, 5120
  s_nop 0
  buffer_load_dwordx4 v65, s[24:27], s21 offen lds
  s_add_u32 m0, s51, 6144
  s_nop 0
  buffer_load_dwordx4 v65, s[24:27], s22 offen lds
  s_add_u32 m0, s51, 7168
  s_nop 0
  buffer_load_dwordx4 v65, s[24:27], s23 offen lds
  s_lshl_b32 s76, s52, 2
  s_add_u32 s76, s76, s54
  s_mul_i32 s62, s76, 36864
  v_and_b32 v63, 7, v16
  v_xor_b32 v63, v63, v67
  v_lshrrev_b32 v64, 3, v16
  v_mul_u32_u24 v64, 1152, v64
  v_lshl_add_u32 v70, v63, 4, v64
  v_xor_b32 v71, 64, v70
  v_add_u32 v71, 9216, v71
  s_add_u32 s75, s62, 18432
  s_mov_b32 s8, s48
  s_add_u32 m0, s73, 0
  s_mov_b32 s9, s49
  buffer_load_dwordx4 v70, s[12:15], s62 offen offset:0 lds
  s_mov_b32 s10, 41943040
  s_mov_b32 s11, 0x20000
  s_mov_b32 s28, s44
  s_mov_b32 s29, s45
  s_mov_b32 s30, 2359296
  s_mov_b32 s31, 0x20000
  s_mov_b32 s96, s46
  s_mov_b32 s97, s47
  s_mov_b32 s98, 256
  s_mov_b32 s99, 0x20000
  s_getreg_b32 s59, hwreg(HW_REG_XCC_ID, 0, 4)
  s_mov_b32 s57, 200000
  s_add_u32 m0, s73, 896
  v_lshlrev_b32 v1, 4, v16
  buffer_load_dwordx4 v70, s[12:15], s62 offen offset:128 lds
  v_lshlrev_b32 v12, 2, v16
  v_and_b32 v66, 15, v16
  s_mov_b32 s44, 5120
  s_lshl_b32 s41, s74, 11
  s_cmp_eq_u32 s74, 2
  s_cselect_b32 s44, 2048, s44
  s_cselect_b32 s41, 97280, s41
  s_mov_b32 s69, 1024
  s_cmp_eq_u32 s79, 6
  s_cselect_b32 s41, 4096, s41
  s_cselect_b32 s69, 136192, s69
  s_lshl_b32 s80, s52, 1
  s_add_u32 s80, s80, s72
  s_mul_i32 s80, s80, 136192
  s_add_u32 s41, s41, s80
  s_add_u32 s41, s41, 2097152
  s_cmp_ge_u32 s77, 63
  s_cselect_b32 s41, 1073741824, s41
  s_lshl_b32 s80, s78, 1
  s_add_u32 s80, s80, 1
  s_mul_i32 s80, s80, s44
  s_add_u32 s42, s41, s80
  s_add_u32 s43, s42, s44
  s_and_b32 s80, s78, 3
  s_lshl_b32 s80, s80, 8
  s_lshr_b32 s81, s78, 2
  s_lshl_b32 s81, s81, 6
  s_add_u32 s80, s80, s81
  v_cmp_eq_u32 s[92:93], 0, v67
  v_lshlrev_b32 v69, 8, v67
  v_lshl_add_u32 v69, v66, 2, v69
  v_add_u32 v69, s80, v69
  s_cmp_ge_u32 s78, 8
  s_cselect_b64 s[86:87], -1, s[92:93]
  v_cndmask_b32 v69, v50, v69, s[86:87]
  v_mov_b32 v128, 0x3f803f80
  v_mov_b32 v112, -1
  v_mov_b32 v129, 0x3f803f80
  v_mov_b32 v113, -1
  v_mov_b32 v130, 0x3f803f80
  v_mov_b32 v114, -1
  v_mov_b32 v131, 0x3f803f80
  v_mov_b32 v115, -1
  v_add_u32 v68, s51, v1
  s_lshl_b32 s58, s52, 7
  s_lshl_b32 s81, s53, 3
  s_add_u32 s58, s58, s81
  s_add_u32 s58, s58, 4096
  s_cmp_eq_u32 s54, 0
  s_cselect_b32 s58, s58, 1073741824
  s_mul_i32 s6, s100, 5
  s_add_u32 s6, s6, s101
  s_lshl_b32 s6, s6, 11
  s_mul_i32 s81, s52, 92160
  s_add_u32 s6, s6, s81
  s_add_u32 s6, s6, 6553600
  s_cmp_ge_u32 s68, 27
  s_cselect_b32 s6, 1073741824, s6
  s_add_u32 s7, s6, 5120
  s_cmp_eq_u32 s101, 2
  s_cselect_b32 s70, 1073741824, s6
  s_add_u32 s71, s70, 5120
  s_lshl_b32 s3, s52, 1
  s_lshr_b32 s83, s54, 1
  s_add_u32 s3, s3, s83
  s_lshl_b32 s3, s3, 4
  s_add_u32 s3, s3, s53
  s_mul_i32 s3, s3, 1536
  s_and_b32 s83, s54, 1
  s_mul_i32 s83, s83, 512
  s_add_u32 s3, s3, s83
  s_add_u32 s3, s3, 524288
  v_lshrrev_b32 v91, 1, v66
  v_lshrrev_b32 v90, 3, v66
  v_mul_u32_u24 v90, 9216, v90
  v_and_b32 v63, 7, v66
  v_lshl_add_u32 v90, v63, 7, v90
  v_add_u32 v90, s73, v90
  v_add_u32 v63, 0, v67
  v_xor_b32 v64, v63, v91
  v_and_b32 v64, 7, v64
  v_lshrrev_b32 v63, 3, v63
  v_lshl_add_u32 v64, v64, 4, v90
  v_lshl_add_u32 v72, v63, 10, v64
  v_add_u32 v63, 4, v67
  v_xor_b32 v64, v63, v91
  v_and_b32 v64, 7, v64
  v_lshrrev_b32 v63, 3, v63
  v_lshl_add_u32 v64, v64, 4, v90
  v_lshl_add_u32 v73, v63, 10, v64
  v_add_u32 v63, 9, v67
  v_xor_b32 v64, v63, v91
  v_and_b32 v64, 7, v64
  v_lshrrev_b32 v63, 3, v63
  v_lshl_add_u32 v64, v64, 4, v90
  v_lshl_add_u32 v74, v63, 10, v64
  v_add_u32 v63, 13, v67
  v_xor_b32 v64, v63, v91
  v_and_b32 v64, 7, v64
  v_lshrrev_b32 v63, 3, v63
  v_lshl_add_u32 v64, v64, 4, v90
  v_lshl_add_u32 v75, v63, 10, v64
  v_add_u32 v63, 18, v67
  v_xor_b32 v64, v63, v91
  v_and_b32 v64, 7, v64
  v_lshrrev_b32 v63, 3, v63
  v_lshl_add_u32 v64, v64, 4, v90
  v_lshl_add_u32 v76, v63, 10, v64
  v_add_u32 v63, 22, v67
  v_xor_b32 v64, v63, v91
  v_and_b32 v64, 7, v64
  v_lshrrev_b32 v63, 3, v63
  v_lshl_add_u32 v64, v64, 4, v90
  v_lshl_add_u32 v77, v63, 10, v64
  v_add_u32 v63, 27, v67
  v_xor_b32 v64, v63, v91
  v_and_b32 v64, 7, v64
  v_lshrrev_b32 v63, 3, v63
  v_lshl_add_u32 v64, v64, 4, v90
  v_lshl_add_u32 v78, v63, 10, v64
  v_add_u32 v63, 31, v67
  v_xor_b32 v64, v63, v91
  v_and_b32 v64, 7, v64
  v_lshrrev_b32 v63, 3, v63
  v_lshl_add_u32 v64, v64, 4, v90
  v_lshl_add_u32 v79, v63, 10, v64
  v_add_u32 v63, 36, v67
  v_xor_b32 v64, v63, v91
  v_and_b32 v64, 7, v64
  v_lshrrev_b32 v63, 3, v63
  v_lshl_add_u32 v64, v64, 4, v90
  v_lshl_add_u32 v80, v63, 10, v64
  v_add_u32 v63, 40, v67
  v_xor_b32 v64, v63, v91
  v_and_b32 v64, 7, v64
  v_lshrrev_b32 v63, 3, v63
  v_lshl_add_u32 v64, v64, 4, v90
  v_lshl_add_u32 v81, v63, 10, v64
  v_add_u32 v63, 45, v67
  v_xor_b32 v64, v63, v91
  v_and_b32 v64, 7, v64
  v_lshrrev_b32 v63, 3, v63
  v_lshl_add_u32 v64, v64, 4, v90
  v_lshl_add_u32 v82, v63, 10, v64
  v_add_u32 v63, 49, v67
  v_xor_b32 v64, v63, v91
  v_and_b32 v64, 7, v64
  v_lshrrev_b32 v63, 3, v63
  v_lshl_add_u32 v64, v64, 4, v90
  v_lshl_add_u32 v83, v63, 10, v64
  v_add_u32 v63, 54, v67
  v_xor_b32 v64, v63, v91
  v_and_b32 v64, 7, v64
  v_lshrrev_b32 v63, 3, v63
  v_lshl_add_u32 v64, v64, 4, v90
  v_lshl_add_u32 v84, v63, 10, v64
  v_add_u32 v63, 58, v67
  v_xor_b32 v64, v63, v91
  v_and_b32 v64, 7, v64
  v_lshrrev_b32 v63, 3, v63
  v_lshl_add_u32 v64, v64, 4, v90
  v_lshl_add_u32 v85, v63, 10, v64
  v_add_u32 v63, 63, v67
  v_xor_b32 v64, v63, v91
  v_and_b32 v64, 7, v64
  v_lshrrev_b32 v63, 3, v63
  v_lshl_add_u32 v64, v64, 4, v90
  v_lshl_add_u32 v86, v63, 10, v64
  v_add_u32 v63, 67, v67
  v_xor_b32 v64, v63, v91
  v_and_b32 v64, 7, v64
  v_lshrrev_b32 v63, 3, v63
  v_lshl_add_u32 v64, v64, 4, v90
  v_lshl_add_u32 v87, v63, 10, v64
  v_mad_u32_u24 v63, v67, 9, 8
  v_xor_b32 v64, v63, v91
  v_and_b32 v64, 7, v64
  v_lshrrev_b32 v63, 3, v63
  v_lshl_add_u32 v64, v64, 4, v90
  v_lshl_add_u32 v88, v63, 10, v64
  v_mad_u32_u24 v63, v67, 9, 44
  v_xor_b32 v64, v63, v91
  v_and_b32 v64, 7, v64
  v_lshrrev_b32 v63, 3, v63
  v_lshl_add_u32 v64, v64, 4, v90
  v_lshl_add_u32 v89, v63, 10, v64
  v_add_u32 v2, 65536, v1
  v_add_u32 v18, 131072, v1
  v_lshlrev_b32 v63, 12, s54
  v_add_u32 v38, v63, v1
  v_add_u32 v42, 65536, v38
  v_min_u32 v63, 2, v67
  v_lshlrev_b32 v63, 6, v63
  v_lshl_add_u32 v44, v66, 2, v63
  v_cmp_gt_u32 s[46:47], 3, v67
  s_lshr_b32 s80, s53, 3
  s_lshl_b32 s80, s80, 1
  s_lshr_b32 s81, s54, 1
  s_add_u32 s80, s80, s81
  s_sub_u32 s80, s80, s54
  s_mul_i32 s80, s80, 18432
  s_and_b32 s81, s54, 1
  s_mul_i32 s81, s81, 73728
  s_add_u32 s80, s80, s81
  v_add_u32 v90, s80, v90
  s_and_b32 s81, s53, 7
  s_mul_i32 s81, s81, 9
  v_add_u32 v63, s81, v67
  v_xor_b32 v64, v63, v91
  v_and_b32 v64, 7, v64
  v_lshrrev_b32 v63, 3, v63
  v_lshl_add_u32 v64, v64, 4, v90
  v_lshl_add_u32 v172, v63, 10, v64
  s_add_u32 s81, s81, 4
  v_add_u32 v63, s81, v67
  v_xor_b32 v64, v63, v91
  v_and_b32 v64, 7, v64
  v_lshrrev_b32 v63, 3, v63
  v_lshl_add_u32 v64, v64, 4, v90
  v_lshl_add_u32 v173, v63, 10, v64
  s_add_u32 s81, s81, 4
  v_mov_b32 v63, s81
  v_xor_b32 v64, v63, v91
  v_and_b32 v64, 7, v64
  v_lshrrev_b32 v63, 3, v63
  v_lshl_add_u32 v64, v64, 4, v90
  v_lshl_add_u32 v174, v63, 10, v64
  s_add_u32 s81, s81, 4
  v_and_b32 v63, 1, v67
  v_lshl_add_u32 v174, v63, 3, v174
  s_lshr_b32 s80, s53, 1
  s_and_b32 s81, s53, 7
  v_mov_b32 v63, s80
  v_mov_b32 v64, s81
  v_cmp_gt_u32 vcc, 16, v16
  s_nop 1
  v_cndmask_b32 v63, v64, v63, vcc
  v_and_b32 v64, 8, v16
  v_add_u32 v63, v63, v64
  v_mov_b32 v64, s52
  v_cmp_gt_u32 vcc, 32, v16
  s_nop 1
  v_cndmask_b32 v63, v64, v63, vcc
  v_and_b32 v64, 7, v16
  v_lshlrev_b32 v64, 4, v64
  v_lshl_add_u32 v92, v63, 7, v64
  v_add_u32 v92, 4096, v92
  s_mul_i32 s38, s53, 136192
  s_add_u32 s38, s38, 2097152
  s_getpc_b64 s[4:5]
L_pc:
  s_sub_u32 s4, s4, L_pc-interleave_layers__linear_attn_block__sliding_block__prompt_kernel
  s_subb_u32 s5, s5, 0
  s_lshr_b32 s80, s2, 3
  s_lshl_b32 s80, s80, 2
  s_add_u32 s80, s80, s54
  s_lshl_b32 s80, s80, 7
  v_min_u32 v63, 7, v16
  v_lshl_add_u32 v63, v63, 14, s80
  v_min_u32 v63, L_codeend-interleave_layers__linear_attn_block__sliding_block__prompt_kernel-4, v63
  v_mov_b32 v167, s5
  v_add_co_u32 v166, vcc, s4, v63
  s_nop 1
  v_addc_co_u32 v167, vcc, 0, v167, vcc
  s_waitcnt vmcnt(6)
  ds_read_b64_tr_b16 a[160:161], v68 offset:0
  ds_read_b64_tr_b16 a[162:163], v68 offset:1024
  ds_read_b64_tr_b16 a[164:165], v68 offset:2048
  ds_read_b64_tr_b16 a[166:167], v68 offset:3072
  ds_read_b64_tr_b16 a[168:169], v68 offset:8
  ds_read_b64_tr_b16 a[170:171], v68 offset:1032
  ds_read_b64_tr_b16 a[172:173], v68 offset:2056
  ds_read_b64_tr_b16 a[174:175], v68 offset:3080
  s_waitcnt lgkmcnt(0)
  s_add_u32 s55, s50, 0x9e3779b9
  v_mfma_f32_16x16x32_bf16 v[120:123], v[128:131], a[160:163], 0
  v_mfma_f32_16x16x32_bf16 v[120:123], v[128:131], a[164:167], v[120:123]
  buffer_store_dwordx4 a[160:163], v1, s[8:11], s42 offen sc1
  buffer_store_dwordx4 a[164:167], v1, s[8:11], s43 offen sc1
  s_add_u32 s42, s42, s69
  s_add_u32 s43, s43, s69
  v_mfma_f32_16x16x32_bf16 v[124:127], v[128:131], a[168:171], 0
  v_mfma_f32_16x16x32_bf16 v[124:127], v[128:131], a[172:175], v[124:127]
  buffer_store_dwordx4 a[168:171], v1, s[8:11], s42 offen sc1
  buffer_store_dwordx4 a[172:175], v1, s[8:11], s43 offen sc1
  s_waitcnt vmcnt(6)
  ds_read_b64_tr_b16 a[176:177], v68 offset:4096
  ds_read_b64_tr_b16 a[178:179], v68 offset:5120
  ds_read_b64_tr_b16 a[180:181], v68 offset:6144
  ds_read_b64_tr_b16 a[182:183], v68 offset:7168
  ds_read_b64_tr_b16 a[184:185], v68 offset:4104
  ds_read_b64_tr_b16 a[186:187], v68 offset:5128
  ds_read_b64_tr_b16 a[188:189], v68 offset:6152
  ds_read_b64_tr_b16 a[190:191], v68 offset:7176
  v_cvt_pk_bf16_f32 v121, v120, v120
  v_lshlrev_b32 v122, 16, v121
  v_sub_f32 v122, v120, v122
  v_cvt_pk_bf16_f32 v121, v120, v122
  v_cndmask_b32 v121, 0, v121, s[92:93]
  buffer_store_dword v121, v69, s[8:11], s41 offen sc1
  s_add_u32 s41, s41, s69
  v_cvt_pk_bf16_f32 v125, v124, v124
  v_lshlrev_b32 v126, 16, v125
  v_sub_f32 v126, v124, v126
  v_cvt_pk_bf16_f32 v125, v124, v126
  v_cndmask_b32 v125, 0, v125, s[92:93]
  buffer_store_dword v125, v69, s[8:11], s41 offen sc1
  s_waitcnt lgkmcnt(0)
  buffer_store_dwordx4 a[176:179], v1, s[8:11], s6 offen sc1
  buffer_store_dwordx4 a[180:183], v1, s[8:11], s7 offen sc1
  buffer_store_dwordx4 a[184:187], v1, s[8:11], s70 offen offset:1024 sc1
  buffer_store_dwordx4 a[188:191], v1, s[8:11], s71 offen offset:1024 sc1
  buffer_store_dwordx4 v[112:115], v1, s[8:11], s3 offen sc1
  s_barrier
  s_lshl_b32 s80, s52, 6
  s_add_u32 s80, s80, s77
  s_mul_i32 s80, s80, 2304
  v_min_u32 v63, 17, v16
  v_lshlrev_b32 v63, 7, v63
  buffer_load_dword v165, v63, s[12:15], s80 offen
  global_load_dword v165, v[166:167], off
  v_mov_b32 v17, s55
  v_mov_b32 v22, s55
  v_mov_b32 v23, s59
  s_add_u32 m0, s73, 1792
  v_mov_b32 v50, 2147483648
  buffer_load_dwordx4 v70, s[12:15], s62 offen offset:256 lds
  v_and_b32 v51, 31, v16
  v_lshrrev_b32 v52, 5, v16
  v_and_b32 v53, 15, v16
  v_lshrrev_b32 v55, 4, v16
  v_lshlrev_b32 v48, 2, v52
  v_sub_u32 v45, v51, v48
  s_and_b32 s60, s53, 7
  s_lshr_b32 s80, s53, 3
  s_lshl_b32 s81, s52, 3
  s_lshl_b32 s82, s80, 2
  s_add_u32 s81, s81, s82
  s_add_u32 s81, s81, s54
  s_lshr_b32 s61, s81, 1
  s_mul_i32 s70, s81, 18432
  s_add_u32 m0, s73, 2688
  s_mul_i32 s82, s60, 144
  buffer_load_dwordx4 v70, s[12:15], s62 offen offset:384 lds
  s_add_u32 s82, s82, s70
  v_mul_u32_u24 v13, 1152, v53
  v_cmp_gt_u32 vcc, 2, v55
  v_add_u32 v13, s82, v13
  v_lshl_add_u32 v14, v55, 3, v13
  v_lshl_add_u32 v13, v55, 4, v13
  v_cndmask_b32 v14, v50, v14, vcc
  v_lshlrev_b32 v6, 4, v53
  v_lshl_add_u32 v5, v55, 3, v6
  v_cndmask_b32 v5, v50, v5, vcc
  v_cmp_eq_u32 vcc, 0, v55
  v_lshl_add_u32 v4, v55, 9, v6
  v_and_b32 v39, 127, v12
  v_cndmask_b32 v6, v50, v6, vcc
  s_add_u32 m0, s73, 3584
  s_mul_i32 s64, s61, 36864
  buffer_load_dwordx4 v70, s[12:15], s62 offen offset:512 lds
  s_and_b32 s82, s54, 1
  s_lshl_b32 s83, s82, 10
  s_add_u32 s64, s64, s83
  s_lshr_b32 s83, s60, 2
  s_lshl_b32 s83, s83, 11
  s_and_b32 s84, s60, 3
  s_lshl_b32 s84, s84, 8
  s_add_u32 s83, s83, s84
  s_add_u32 s65, s64, s83
  s_add_u32 s65, s65, 32768
  s_lshl_b32 s83, s60, 12
  s_add_u32 s64, s64, s83
  s_lshl_b32 s66, s61, 12
  s_lshl_b32 s83, s60, 9
  s_add_u32 m0, s73, 4480
  s_add_u32 s66, s66, s83
  buffer_load_dwordx4 v70, s[12:15], s62 offen offset:640 lds
  s_lshl_b32 s83, s82, 8
  s_add_u32 s66, s66, s83
  s_add_u32 s66, s66, 262144
  s_lshl_b32 s63, s76, 12
  s_add_u32 s63, s63, 262144
  v_bfe_u32 v48, v16, 4, 1
  v_mul_u32_u24 v48, 18432, v48
  v_lshl_add_u32 v8, v53, 4, v48
  v_lshl_add_u32 v7, v52, 8, v8
  v_mul_u32_u24 v48, 36864, v52
  v_add_u32 v175, v48, v8
  v_cmp_gt_u32 vcc, 32, v16
  s_mul_i32 s80, s54, 5120
  s_sub_u32 s80, 15360, s80
  s_add_u32 m0, s73, 5376
  v_cndmask_b32 v8, v50, v8, vcc
  buffer_load_dwordx4 v70, s[12:15], s62 offen offset:768 lds
  s_and_b32 s85, s54, 2
  s_sub_u32 s85, 2, s85
  s_lshl_b32 s85, s85, 1
  s_add_u32 s85, s85, s82
  s_mul_i32 s85, s85, 2560
  v_add_u32 v9, s85, v1
  v_lshlrev_b32 v10, 4, v51
  v_add_u32 v10, s85, v10
  v_add_u32 v10, 2056, v10
  s_mov_b32 s45, s80
  v_and_b32 v48, 1, v55
  v_mul_u32_u24 v48, 2560, v48
  v_lshl_add_u32 v48, v52, 9, v48
  v_lshl_add_u32 v3, v53, 4, v48
  s_add_u32 m0, s73, 6272
  v_add_u32 v19, s80, v3
  buffer_load_dwordx4 v70, s[12:15], s62 offen offset:896 lds
  v_mul_u32_u24 v20, 2560, v52
  v_lshl_add_u32 v20, v51, 4, v20
  v_add_u32 v20, 2048, v20
  v_add_u32 v43, s80, v20
  v_and_b32 v48, 1, v16
  v_lshlrev_b32 v48, 9, v48
  v_bfe_u32 v49, v16, 1, 1
  v_lshl_add_u32 v48, v49, 3, v48
  v_add_u32 v48, 1024, v48
  v_bfe_u32 v49, v16, 4, 1
  v_cmp_eq_u32 vcc, 1, v49
  v_mov_b32 v49, 2048
  v_mov_b32 v54, 0x3eae1a93
  v_cndmask_b32 v48, v48, v49, vcc
  s_waitcnt vmcnt(8)
  s_barrier
  s_mov_b64 exec, 1
  buffer_store_dwordx2 v[22:23], v12, s[8:11], s58 offen sc1
  s_mov_b64 exec, -1
  s_add_u32 m0, s73, 7168
  v_cndmask_b32 v21, 1.0, v54, vcc
  buffer_load_dwordx4 v70, s[12:15], s62 offen offset:1024 lds
  v_bfe_u32 v49, v16, 2, 2
  v_lshl_add_u32 v49, v52, 2, v49
  v_lshl_add_u32 v48, v49, 4, v48
  v_add_u32 v11, s85, v48
  s_mul_i32 s81, s82, 2560
  v_bfe_u32 v49, v16, 2, 2
  s_add_u32 m0, s73, 9216
  v_lshl_add_u32 v49, v55, 3, v49
  buffer_load_dwordx4 v71, s[12:15], s62 offen offset:0 lds
  v_lshlrev_b32 v49, 4, v49
  v_add_u32 v0, s81, v49
  v_and_b32 v48, 1, v16
  v_bfe_u32 v49, v16, 1, 1
  v_lshl_add_u32 v54, v48, 3, v0
  v_lshl_add_u32 v40, v49, 9, v54
  s_add_u32 m0, s73, 10112
  v_lshlrev_b32 v48, 9, v48
  buffer_load_dwordx4 v71, s[12:15], s62 offen offset:128 lds
  v_lshl_add_u32 v48, v49, 3, v48
  v_mov_b32 v54, 1024
  s_cmp_ge_u32 s54, 2
  s_cselect_b64 s[88:89], -1, 0
  v_cndmask_b32 v48, v48, v54, s[88:89]
  v_add3_u32 v41, v48, v54, v0
  s_and_b32 s81, s54, 2
  s_add_u32 m0, s73, 11008
  s_lshl_b32 s81, s81, 3
  buffer_load_dwordx4 v71, s[12:15], s62 offen offset:256 lds
  v_add_u32 v48, s81, v53
  v_cmp_gt_u32 s[86:87], 20, v48
  v_cmp_gt_u32 vcc, 16, v51
  v_mad_u32_u24 v49, v52, 20, v48
  v_lshlrev_b32 v49, 4, v49
  s_and_b64 vcc, vcc, s[86:87]
  s_add_u32 m0, s73, 11904
  v_cndmask_b32 v36, v50, v49, vcc
  buffer_load_dwordx4 v71, s[12:15], s62 offen offset:384 lds
  v_lshlrev_b32 v48, 2, v48
  s_mov_b32 vcc_hi, 0
  v_cndmask_b32 v37, v50, v48, vcc
  v_cmp_gt_u32 vcc, 20, v51
  v_and_b32 v48, 3, v51
  v_add_u32 v48, 16, v48
  s_add_u32 m0, s73, 12800
  v_cndmask_b32 v48, v48, v51, vcc
  buffer_load_dwordx4 v71, s[12:15], s62 offen offset:512 lds
  v_lshlrev_b32 v35, 2, v48
  v_add_u32 v35, 158336, v35
  v_mad_u32_u24 v48, v52, 20, v48
  v_lshlrev_b32 v48, 4, v48
  v_add_u32 v34, 157696, v48
  s_mul_i32 s81, s54, 23
  s_add_u32 m0, s73, 13696
  v_add_u32 v48, s81, v51
  buffer_load_dwordx4 v71, s[12:15], s62 offen offset:640 lds
  v_cmp_gt_u32 vcc, 90, v48
  v_cmp_gt_u32 s[86:87], 23, v51
  v_lshlrev_b32 v48, 4, v48
  v_mov_b32 v54, 1536
  s_and_b64 vcc, vcc, s[86:87]
  v_mad_u32_u24 v49, v52, v54, v48
  s_add_u32 m0, s73, 14592
  v_cndmask_b32 v32, v50, v49, vcc
  buffer_load_dwordx4 v71, s[12:15], s62 offen offset:768 lds
  v_lshl_add_u32 v48, v52, 3, v48
  v_cndmask_b32 v48, v54, v48, vcc
  v_add_u32 v33, 157696, v48
  s_mul_i32 s81, s53, 2304
  s_add_u32 s81, s81, s62
  v_lshlrev_b32 v48, 7, v16
  s_add_u32 m0, s73, 15488
  v_cmp_gt_u32 vcc, 18, v16
  buffer_load_dwordx4 v71, s[12:15], s62 offen offset:896 lds
  v_add_u32 v49, s81, v48
  s_lshl_b32 s81, s53, 8
  s_add_u32 s81, s81, s63
  s_sub_u32 s81, s81, 2304
  v_cndmask_b32 v47, v50, v49, vcc
  v_add_u32 v49, 8388608, v49
  s_add_u32 m0, s73, 16384
  v_add_u32 v48, s81, v48
  buffer_load_dwordx4 v71, s[12:15], s62 offen offset:1024 lds
  v_cndmask_b32 v48, v48, v49, vcc
  v_cmp_gt_u32 vcc, 20, v16
  s_lshl_b32 s69, s76, 7
  s_add_u32 s69, s69, 16384
  v_mov_b32 v49, s69
  v_cndmask_b32 v46, v49, v48, vcc
  s_add_u32 m0, s73, 73728
  s_lshl_b32 s83, s53, 3
  buffer_load_dwordx4 v70, s[12:15], s75 offen offset:0 lds
  s_add_u32 s69, s69, s83
  s_mul_i32 s83, s82, -124
  s_add_u32 s20, s69, s83
  s_lshl_b32 s71, s61, 7
  s_add_u32 s71, s71, 16384
  s_add_u32 s70, s70, 8388608
  s_add_u32 m0, s73, 74624
  s_add_u32 s67, s62, 8388608
  buffer_load_dwordx4 v70, s[12:15], s75 offen offset:128 lds
  s_lshr_b32 s83, s53, 3
  s_lshl_b32 s83, s83, 10
  s_bfe_u32 s84, s53, 0x20001
  s_lshl_b32 s84, s84, 8
  s_add_u32 s83, s83, s84
  s_and_b32 s84, s53, 1
  s_add_u32 m0, s73, 75520
  s_lshl_b32 s84, s84, 3
  buffer_load_dwordx4 v70, s[12:15], s75 offen offset:256 lds
  s_add_u32 s83, s83, s84
  s_add_u32 s68, s67, s83
  s_add_u32 s68, s68, 16384
  s_lshl_b32 s83, s53, 10
  s_add_u32 s67, s67, s83
  s_mul_i32 s83, s82, -36352
  s_add_u32 m0, s73, 76416
  s_add_u32 s16, s67, s83
  buffer_load_dwordx4 v70, s[12:15], s75 offen offset:384 lds
  s_add_u32 s17, s16, 36864
  s_mul_i32 s83, s82, -36860
  s_add_u32 s18, s68, s83
  s_lshl_b32 s83, s53, 6
  s_add_u32 s83, s83, s76
  s_mul_i32 s72, s83, 5120
  s_add_u32 m0, s73, 77312
  s_add_u32 s72, s72, 10747904
  buffer_load_dwordx4 v70, s[12:15], s75 offen offset:512 lds
  s_mul_i32 s74, s53, 24576
  s_add_u32 s74, s74, 524288
  s_mul_i32 s25, s52, 1536
  s_add_u32 s25, s25, s74
  s_mul_i32 s83, s82, 720
  s_add_u32 s25, s25, s83
  s_add_u32 m0, s73, 78208
  s_mul_i32 s39, s60, 92160
  buffer_load_dwordx4 v70, s[12:15], s75 offen offset:640 lds
  s_add_u32 s39, s39, 6553600
  s_sub_u32 s41, s72, 20480
  s_cmp_ge_u32 s52, 1
  s_cselect_b32 s41, s41, 1073741824
  s_sub_u32 s42, s72, 40960
  s_cmp_ge_u32 s52, 2
  s_cselect_b32 s42, s42, 1073741824
  s_add_u32 m0, s73, 79104
  s_nop 0
  buffer_load_dwordx4 v70, s[12:15], s75 offen offset:768 lds
  s_add_u32 m0, s73, 80000
  s_nop 0
  buffer_load_dwordx4 v70, s[12:15], s75 offen offset:896 lds
  s_add_u32 m0, s73, 80896
  s_nop 0
  buffer_load_dwordx4 v70, s[12:15], s75 offen offset:1024 lds
  s_add_u32 m0, s73, 82944
  s_nop 0
  buffer_load_dwordx4 v71, s[12:15], s75 offen offset:0 lds
  s_waitcnt vmcnt(10)
  s_barrier
  s_bitcmp1_b32 s54, 0
  s_cbranch_scc1 Lnoxr_5
  ds_read_b128 v[22:25], v172
  ds_read_b128 v[26:29], v173
  ds_read_b64 v[30:31], v174
Lnoxr_5:
  s_add_u32 m0, s73, 83840
  ds_read_b128 v[176:179], v72
  v_add_u32 v72, 73728, v72
  buffer_load_dwordx4 v71, s[12:15], s75 offen offset:128 lds
  ds_read_b128 v[184:187], v73
  v_add_u32 v73, 73728, v73
  ds_read_b128 v[192:195], v74
  v_add_u32 v74, 73728, v74
  ds_read_b128 v[200:203], v75
  v_add_u32 v75, 73728, v75
  ds_read_b128 v[208:211], v76
  v_add_u32 v76, 73728, v76
  ds_read_b128 v[216:219], v77
  v_add_u32 v77, 73728, v77
  ds_read_b128 v[224:227], v78
  v_add_u32 v78, 73728, v78
  s_add_u32 m0, s73, 84736
  ds_read_b128 v[232:235], v79
  v_add_u32 v79, 73728, v79
  buffer_load_dwordx4 v71, s[12:15], s75 offen offset:256 lds
  s_waitcnt lgkmcnt(7)
  v_mfma_f32_16x16x32_bf16 v[136:139], v[128:131], v[176:179], 0
  ds_read_b128 v[240:243], v80
  v_add_u32 v80, 73728, v80
  v_mfma_f32_16x16x32_bf16 v[144:147], v[176:179], v[176:179], 0
  s_waitcnt lgkmcnt(7)
  v_mfma_f32_16x16x32_bf16 v[136:139], v[128:131], v[184:187], v[136:139]
  s_add_u32 m0, s73, 85632
  ds_read_b128 v[248:251], v81
  v_add_u32 v81, 73728, v81
  buffer_load_dwordx4 v71, s[12:15], s75 offen offset:384 lds
  v_mfma_f32_16x16x32_bf16 v[144:147], v[184:187], v[184:187], v[144:147]
  s_waitcnt lgkmcnt(7)
  v_mfma_f32_16x16x32_bf16 v[136:139], v[128:131], v[192:195], v[136:139]
  ds_read_b128 a[192:195], v82
  v_add_u32 v82, 73728, v82
  v_mfma_f32_16x16x32_bf16 v[144:147], v[192:195], v[192:195], v[144:147]
  s_waitcnt lgkmcnt(7)
  s_add_u32 m0, s73, 86528
  v_mfma_f32_16x16x32_bf16 v[136:139], v[128:131], v[200:203], v[136:139]
  buffer_load_dwordx4 v71, s[12:15], s75 offen offset:512 lds
  ds_read_b128 a[200:203], v83
  v_add_u32 v83, 73728, v83
  v_mfma_f32_16x16x32_bf16 v[144:147], v[200:203], v[200:203], v[144:147]
  s_waitcnt lgkmcnt(7)
  v_mfma_f32_16x16x32_bf16 v[136:139], v[128:131], v[208:211], v[136:139]
  ds_read_b128 a[208:211], v84
  v_add_u32 v84, 73728, v84
  v_mfma_f32_16x16x32_bf16 v[144:147], v[208:211], v[208:211], v[144:147]
  s_cmp_eq_u32 s54, 0
  s_cselect_b32 s51, 0, 1073741824
  s_mov_b64 exec, 0xff
  buffer_load_dwordx4 v[168:171], v92, s[8:11], s51 offen sc1
  s_mov_b64 exec, -1
  s_add_u32 m0, s73, 87424
  s_waitcnt lgkmcnt(7)
  buffer_load_dwordx4 v71, s[12:15], s75 offen offset:640 lds
  v_mfma_f32_16x16x32_bf16 v[136:139], v[128:131], v[216:219], v[136:139]
  ds_read_b128 a[216:219], v85
  v_add_u32 v85, 73728, v85
  v_mfma_f32_16x16x32_bf16 v[144:147], v[216:219], v[216:219], v[144:147]
  s_waitcnt lgkmcnt(7)
  v_mfma_f32_16x16x32_bf16 v[136:139], v[128:131], v[224:227], v[136:139]
  ds_read_b128 a[224:227], v86
  v_add_u32 v86, 73728, v86
  s_add_u32 m0, s73, 88320
  v_mfma_f32_16x16x32_bf16 v[144:147], v[224:227], v[224:227], v[144:147]
  buffer_load_dwordx4 v71, s[12:15], s75 offen offset:768 lds
  s_waitcnt lgkmcnt(7)
  v_mfma_f32_16x16x32_bf16 v[136:139], v[128:131], v[232:235], v[136:139]
  ds_read_b128 a[232:235], v87
  v_add_u32 v87, 73728, v87
  v_mfma_f32_16x16x32_bf16 v[144:147], v[232:235], v[232:235], v[144:147]
  s_waitcnt lgkmcnt(7)
  v_mfma_f32_16x16x32_bf16 v[136:139], v[128:131], v[240:243], v[136:139]
  s_add_u32 m0, s73, 89216
  ds_read_b128 a[240:243], v88
  v_add_u32 v88, 73728, v88
  buffer_load_dwordx4 v71, s[12:15], s75 offen offset:896 lds
  v_mfma_f32_16x16x32_bf16 v[144:147], v[240:243], v[240:243], v[144:147]
  s_waitcnt lgkmcnt(7)
  v_mfma_f32_16x16x32_bf16 v[136:139], v[128:131], v[248:251], v[136:139]
  ds_read_b128 a[248:251], v89
  v_add_u32 v89, 73728, v89
  v_mfma_f32_16x16x32_bf16 v[144:147], v[248:251], v[248:251], v[144:147]
  s_waitcnt lgkmcnt(0)
  s_add_u32 m0, s73, 90112
  s_nop 0
  buffer_load_dwordx4 v71, s[12:15], s75 offen offset:1024 lds
  s_lshl_b32 s40, s54, 12
  s_add_u32 s33, s40, s38
  s_add_u32 s40, s40, 38912
  v_mfma_f32_16x16x32_bf16 v[136:139], v[128:131], a[192:195], v[136:139]
  v_mfma_f32_16x16x32_bf16 v[144:147], a[192:195], a[192:195], v[144:147]
  v_mfma_f32_16x16x32_bf16 v[136:139], v[128:131], a[200:203], v[136:139]
  v_mfma_f32_16x16x32_bf16 v[144:147], a[200:203], a[200:203], v[144:147]
  v_mfma_f32_16x16x32_bf16 v[136:139], v[128:131], a[208:211], v[136:139]
  v_mfma_f32_16x16x32_bf16 v[144:147], a[208:211], a[208:211], v[144:147]
  v_mfma_f32_16x16x32_bf16 v[136:139], v[128:131], a[216:219], v[136:139]
  v_mfma_f32_16x16x32_bf16 v[144:147], a[216:219], a[216:219], v[144:147]
  v_mfma_f32_16x16x32_bf16 v[136:139], v[128:131], a[224:227], v[136:139]
  v_mfma_f32_16x16x32_bf16 v[144:147], a[224:227], a[224:227], v[144:147]
  v_mfma_f32_16x16x32_bf16 v[136:139], v[128:131], a[232:235], v[136:139]
  v_mfma_f32_16x16x32_bf16 v[144:147], a[232:235], a[232:235], v[144:147]
  v_mfma_f32_16x16x32_bf16 v[136:139], v[128:131], a[240:243], v[136:139]
  v_mfma_f32_16x16x32_bf16 v[144:147], a[240:243], a[240:243], v[144:147]
  v_mfma_f32_16x16x32_bf16 v[136:139], v[128:131], a[248:251], v[136:139]
  v_mfma_f32_16x16x32_bf16 v[144:147], a[248:251], a[248:251], v[144:147]
  s_cmp_lg_u32 s54, 0
  s_cbranch_scc1 Lp1ok_8
  s_waitcnt vmcnt(4)
Lp1chk_6:
  v_cmp_ne_u32 vcc, s55, v168
  v_cmp_ne_u32 s[86:87], s55, v170
  s_nop 0
  s_or_b64 vcc, vcc, s[86:87]
  s_and_b32 vcc_lo, vcc_lo, 0xff
  s_cbranch_scc0 Lp1ok_8
  s_cmp_eq_u32 s57, 0
  s_cbranch_scc1 Lp1ok_8
  s_sub_u32 s57, s57, 1
  s_mov_b64 exec, 0xff
  buffer_load_dwordx4 v[168:171], v92, s[8:11], 0 offen sc1
  s_mov_b64 exec, -1
  s_waitcnt vmcnt(0)
  s_branch Lp1chk_6
Lp1ok_8:
  s_waitcnt vmcnt(0)
  s_barrier
  s_bitcmp0_b32 s54, 0
  s_cbranch_scc1 Lnoxr_10
  ds_read_b128 v[22:25], v172
  ds_read_b128 v[26:29], v173
  ds_read_b64 v[30:31], v174
Lnoxr_10:
  s_add_u32 m0, s40, 0
  s_nop 0
  buffer_load_dwordx4 v1, s[8:11], s33 offen offset:0 sc1 lds
  ds_read_b128 v[180:183], v72
  ds_read_b128 v[188:191], v73
  ds_read_b128 v[196:199], v74
  ds_read_b128 v[204:207], v75
  ds_read_b128 v[212:215], v76
  ds_read_b128 v[220:223], v77
  s_add_u32 m0, s40, 0
  s_nop 0
  buffer_load_dwordx4 v1, s[8:11], s33 offen offset:1024 sc1 lds
  ds_read_b128 v[228:231], v78
  ds_read_b128 v[236:239], v79
  s_waitcnt lgkmcnt(7)
  v_mfma_f32_16x16x32_bf16 v[140:143], v[128:131], v[180:183], 0
  ds_read_b128 v[244:247], v80
  v_mfma_f32_16x16x32_bf16 v[148:151], v[180:183], v[180:183], 0
  s_add_u32 m0, s40, 0
  s_nop 0
  buffer_load_dwordx4 v1, s[8:11], s33 offen offset:2048 sc1 lds
  s_waitcnt lgkmcnt(7)
  v_mfma_f32_16x16x32_bf16 v[140:143], v[128:131], v[188:191], v[140:143]
  ds_read_b128 v[252:255], v81
  v_mfma_f32_16x16x32_bf16 v[148:151], v[188:191], v[188:191], v[148:151]
  s_waitcnt lgkmcnt(7)
  v_mfma_f32_16x16x32_bf16 v[140:143], v[128:131], v[196:199], v[140:143]
  s_add_u32 m0, s40, 0
  s_nop 0
  buffer_load_dwordx4 v1, s[8:11], s33 offen offset:3072 sc1 lds
  ds_read_b128 a[196:199], v82
  v_mfma_f32_16x16x32_bf16 v[148:151], v[196:199], v[196:199], v[148:151]
  s_waitcnt lgkmcnt(7)
  v_mfma_f32_16x16x32_bf16 v[140:143], v[128:131], v[204:207], v[140:143]
  ds_read_b128 a[204:207], v83
  v_mfma_f32_16x16x32_bf16 v[148:151], v[204:207], v[204:207], v[148:151]
  s_add_u32 s33, s33, 16384
  s_add_u32 m0, s40, 16384
  s_nop 0
  buffer_load_dwordx4 v1, s[8:11], s33 offen offset:0 sc1 lds
  s_waitcnt lgkmcnt(7)
  v_mfma_f32_16x16x32_bf16 v[140:143], v[128:131], v[212:215], v[140:143]
  ds_read_b128 a[212:215], v84
  v_mfma_f32_16x16x32_bf16 v[148:151], v[212:215], v[212:215], v[148:151]
  s_waitcnt lgkmcnt(7)
  v_mfma_f32_16x16x32_bf16 v[140:143], v[128:131], v[220:223], v[140:143]
  s_add_u32 m0, s40, 16384
  s_nop 0
  buffer_load_dwordx4 v1, s[8:11], s33 offen offset:1024 sc1 lds
  ds_read_b128 a[220:223], v85
  v_mfma_f32_16x16x32_bf16 v[148:151], v[220:223], v[220:223], v[148:151]
  s_waitcnt lgkmcnt(7)
  v_mfma_f32_16x16x32_bf16 v[140:143], v[128:131], v[228:231], v[140:143]
  ds_read_b128 a[228:231], v86
  v_mfma_f32_16x16x32_bf16 v[148:151], v[228:231], v[228:231], v[148:151]
  s_add_u32 m0, s40, 16384
  s_nop 0
  buffer_load_dwordx4 v1, s[8:11], s33 offen offset:2048 sc1 lds
  s_waitcnt lgkmcnt(7)
  v_mfma_f32_16x16x32_bf16 v[140:143], v[128:131], v[236:239], v[140:143]
  ds_read_b128 a[236:239], v87
  v_mfma_f32_16x16x32_bf16 v[148:151], v[236:239], v[236:239], v[148:151]
  s_waitcnt lgkmcnt(7)
  v_mfma_f32_16x16x32_bf16 v[140:143], v[128:131], v[244:247], v[140:143]
  s_add_u32 m0, s40, 16384
  s_nop 0
  buffer_load_dwordx4 v1, s[8:11], s33 offen offset:3072 sc1 lds
  ds_read_b128 a[244:247], v88
  v_mfma_f32_16x16x32_bf16 v[148:151], v[244:247], v[244:247], v[148:151]
  s_waitcnt lgkmcnt(7)
  v_mfma_f32_16x16x32_bf16 v[140:143], v[128:131], v[252:255], v[140:143]
  ds_read_b128 a[252:255], v89
  v_mfma_f32_16x16x32_bf16 v[148:151], v[252:255], v[252:255], v[148:151]
  s_waitcnt lgkmcnt(0)
  s_barrier
  s_add_u32 s33, s33, 16384
  s_add_u32 m0, s40, 32768
  s_nop 0
  buffer_load_dwordx4 v1, s[8:11], s33 offen offset:0 sc1 lds
  v_mfma_f32_16x16x32_bf16 v[140:143], v[128:131], a[196:199], v[140:143]
  v_mfma_f32_16x16x32_bf16 v[148:151], a[196:199], a[196:199], v[148:151]
  v_mfma_f32_16x16x32_bf16 v[140:143], v[128:131], a[204:207], v[140:143]
  v_mfma_f32_16x16x32_bf16 v[148:151], a[204:207], a[204:207], v[148:151]
  s_add_u32 m0, s40, 32768
  s_nop 0
  buffer_load_dwordx4 v1, s[8:11], s33 offen offset:1024 sc1 lds
  v_mfma_f32_16x16x32_bf16 v[140:143], v[128:131], a[212:215], v[140:143]
  v_mfma_f32_16x16x32_bf16 v[148:151], a[212:215], a[212:215], v[148:151]
  v_mfma_f32_16x16x32_bf16 v[140:143], v[128:131], a[220:223], v[140:143]
  v_mfma_f32_16x16x32_bf16 v[148:151], a[220:223], a[220:223], v[148:151]
  s_add_u32 m0, s40, 32768
  s_nop 0
  buffer_load_dwordx4 v1, s[8:11], s33 offen offset:2048 sc1 lds
  v_mfma_f32_16x16x32_bf16 v[140:143], v[128:131], a[228:231], v[140:143]
  v_mfma_f32_16x16x32_bf16 v[148:151], a[228:231], a[228:231], v[148:151]
  v_mfma_f32_16x16x32_bf16 v[140:143], v[128:131], a[236:239], v[140:143]
  v_mfma_f32_16x16x32_bf16 v[148:151], a[236:239], a[236:239], v[148:151]
  s_add_u32 m0, s40, 32768
  s_nop 0
  buffer_load_dwordx4 v1, s[8:11], s33 offen offset:3072 sc1 lds
  v_mfma_f32_16x16x32_bf16 v[140:143], v[128:131], a[244:247], v[140:143]
  v_mfma_f32_16x16x32_bf16 v[148:151], a[244:247], a[244:247], v[148:151]
  v_mfma_f32_16x16x32_bf16 v[140:143], v[128:131], a[252:255], v[140:143]
  v_mfma_f32_16x16x32_bf16 v[148:151], a[252:255], a[252:255], v[148:151]
  v_and_b32 v63, 3, v66
  v_lshrrev_b32 v64, 2, v66
  v_cmp_eq_u32 s[86:87], 1, v63
  v_cmp_eq_u32 s[88:89], 2, v63
  v_cmp_eq_u32 s[90:91], 3, v63
  v_cmp_eq_u32 vcc, v64, v67
  v_mov_b32 v55, v92
  v_mov_b32 v96, v136
  v_cndmask_b32 v144, v144, v145, s[86:87]
  v_cndmask_b32 v144, v144, v146, s[88:89]
  v_cndmask_b32 v144, v144, v147, s[90:91]
  v_cndmask_b32 v97, 0, v144, vcc
  v_mov_b32 v104, v140
  v_cndmask_b32 v148, v148, v149, s[86:87]
  v_cndmask_b32 v148, v148, v150, s[88:89]
  v_cndmask_b32 v148, v148, v151, s[90:91]
  v_cndmask_b32 v105, 0, v148, vcc
  v_cmp_gt_u32 vcc, 2, v67
  s_nop 1
  v_cndmask_b32 v30, 0, v30, vcc
  v_cndmask_b32 v31, 0, v31, vcc
  s_mul_i32 s34, s54, 10240
  s_min_u32 s34, s34, 28672
  s_add_u32 s35, s34, 0
  s_add_u32 s34, s34, s38
  s_add_u32 s34, s34, 97280
  v_mul_f32 v96, 0xbae38e39, v96
  v_mul_f32 v104, 0xbae38e39, v104
  v_cvt_pk_bf16_f32 v156, v96, v96
  v_cvt_pk_bf16_f32 v160, v104, v104
  v_cndmask_b32 v157, 0, v156, s[46:47]
  v_cndmask_b32 v158, 0, v156, s[46:47]
  v_cndmask_b32 v159, 0, v156, s[46:47]
  v_cndmask_b32 v156, 0, v156, s[46:47]
  v_cndmask_b32 v161, 0, v160, s[46:47]
  v_cndmask_b32 v162, 0, v160, s[46:47]
  v_cndmask_b32 v163, 0, v160, s[46:47]
  v_cndmask_b32 v160, 0, v160, s[46:47]
  s_mul_i32 s36, s54, 5120
  s_min_u32 s36, s36, 15360
  s_add_u32 s37, s36, 137216
  s_add_u32 s36, s36, s39
  s_add_u32 s36, s36, 71680
  s_waitcnt vmcnt(8)
  s_barrier
  ds_read2st64_b32 v[112:113], v44 offset0:152 offset1:153
  ds_read2st64_b32 v[114:115], v44 offset0:154 offset1:155
  ds_read2st64_b32 v[116:117], v44 offset0:156 offset1:157
  ds_read2st64_b32 v[118:119], v44 offset0:158 offset1:159
  ds_read2st64_b32 v[120:121], v44 offset0:160 offset1:161
  ds_read2st64_b32 v[122:123], v44 offset0:162 offset1:163
  ds_read2st64_b32 v[124:125], v44 offset0:164 offset1:165
  ds_read2st64_b32 v[126:127], v44 offset0:166 offset1:167
  ds_read2st64_b32 v[128:129], v44 offset0:168 offset1:169
  ds_read2st64_b32 v[130:131], v44 offset0:170 offset1:171
  ds_read_b128 v[132:135], v1 offset:44032
  s_waitcnt lgkmcnt(9)
  v_mfma_f32_16x16x32_bf16 v[56:59], v[112:115], v[156:159], 0
  s_add_u32 s33, s33, 16384
  s_add_u32 m0, s40, 49152
  v_mfma_f32_16x16x32_bf16 v[60:63], v[112:115], v[160:163], 0
  ds_read_b128 v[112:115], v1 offset:45056
  s_waitcnt lgkmcnt(8)
  v_mfma_f32_16x16x32_bf16 v[64:67], v[116:119], v[156:159], 0
  buffer_load_dwordx4 v1, s[8:11], s33 offen offset:0 sc1 lds
  ds_read_b128 a[0:3], v38 offset:38912
  v_mfma_f32_16x16x32_bf16 v[68:71], v[116:119], v[160:163], 0
  ds_read_b128 v[116:119], v1 offset:46080
  s_waitcnt lgkmcnt(8)
  v_mfma_f32_16x16x32_bf16 v[72:75], v[120:123], v[156:159], 0
  ds_read_b128 a[4:7], v38 offset:39936
  v_mov_b32 v98, v97
  v_mfma_f32_16x16x32_bf16 v[76:79], v[120:123], v[160:163], 0
  ds_read_b128 v[120:123], v1 offset:47104
  s_waitcnt lgkmcnt(8)
  v_mfma_f32_16x16x32_bf16 v[80:83], v[124:127], v[156:159], 0
  buffer_load_dwordx4 v1, s[8:11], s33 offen offset:1024 sc1 lds
  ds_read_b128 a[8:11], v38 offset:40960
  v_mfma_f32_16x16x32_bf16 v[84:87], v[124:127], v[160:163], 0
  ds_read_b128 v[124:127], v1 offset:48128
  s_waitcnt lgkmcnt(8)
  v_mfma_f32_16x16x32_bf16 v[88:91], v[128:131], v[156:159], 0
  ds_read_b128 a[12:15], v38 offset:41984
  v_mov_b32 v99, v105
  v_mfma_f32_16x16x32_bf16 v[92:95], v[128:131], v[160:163], 0
  ds_read_b128 v[128:131], v1 offset:49152
  s_waitcnt lgkmcnt(9)
  v_mfma_f32_16x16x32_bf16 v[56:59], v[132:135], v[176:179], v[56:59]
  v_permlane32_swap_b32 v98, v97
  v_mfma_f32_16x16x32_bf16 v[60:63], v[132:135], v[180:183], v[60:63]
  ds_read_b128 v[132:135], v1 offset:50176
  s_waitcnt lgkmcnt(9)
  v_mfma_f32_16x16x32_bf16 v[64:67], v[112:115], v[176:179], v[64:67]
  buffer_load_dwordx4 v1, s[8:11], s33 offen offset:2048 sc1 lds
  v_mfma_f32_16x16x32_bf16 v[68:71], v[112:115], v[180:183], v[68:71]
  ds_read_b128 v[112:115], v1 offset:51200
  s_waitcnt lgkmcnt(8)
  v_mfma_f32_16x16x32_bf16 v[72:75], v[116:119], v[176:179], v[72:75]
  v_permlane32_swap_b32 v99, v105
  v_mfma_f32_16x16x32_bf16 v[76:79], v[116:119], v[180:183], v[76:79]
  ds_read_b128 v[116:119], v1 offset:52224
  s_waitcnt lgkmcnt(7)
  v_mfma_f32_16x16x32_bf16 v[80:83], v[120:123], v[176:179], v[80:83]
  v_add_f32 v97, v97, v98
  v_add_f32 v105, v105, v99
  v_mfma_f32_16x16x32_bf16 v[84:87], v[120:123], v[180:183], v[84:87]
  ds_read_b128 v[120:123], v1 offset:53248
  s_waitcnt lgkmcnt(6)
  v_mfma_f32_16x16x32_bf16 v[88:91], v[124:127], v[176:179], v[88:91]
  buffer_load_dwordx4 v1, s[8:11], s33 offen offset:3072 sc1 lds
  v_mov_b32 v98, v97
  v_mfma_f32_16x16x32_bf16 v[92:95], v[124:127], v[180:183], v[92:95]
  ds_read_b128 v[124:127], v1 offset:54272
  s_waitcnt lgkmcnt(5)
  v_mfma_f32_16x16x32_bf16 v[56:59], v[128:131], v[184:187], v[56:59]
  s_add_u32 s33, s33, 16384
  v_mov_b32 v99, v105
  v_mfma_f32_16x16x32_bf16 v[60:63], v[128:131], v[188:191], v[60:63]
  s_waitcnt vmcnt(8)
  s_barrier
  ds_read_b128 v[128:131], v1 offset:55296
  s_waitcnt lgkmcnt(5)
  v_mfma_f32_16x16x32_bf16 v[64:67], v[132:135], v[184:187], v[64:67]
  s_add_u32 m0, s40, 65536
  ds_read_b128 a[16:19], v38 offset:55296
  v_mfma_f32_16x16x32_bf16 v[68:71], v[132:135], v[188:191], v[68:71]
  ds_read_b128 v[132:135], v1 offset:56320
  s_waitcnt lgkmcnt(6)
  v_mfma_f32_16x16x32_bf16 v[72:75], v[112:115], v[184:187], v[72:75]
  buffer_load_dwordx4 v1, s[8:11], s33 offen offset:0 sc1 lds
  ds_read_b128 a[20:23], v38 offset:56320
  v_mfma_f32_16x16x32_bf16 v[76:79], v[112:115], v[188:191], v[76:79]
  ds_read_b128 v[112:115], v1 offset:57344
  s_waitcnt lgkmcnt(7)
  v_mfma_f32_16x16x32_bf16 v[80:83], v[116:119], v[184:187], v[80:83]
  ds_read_b128 a[24:27], v38 offset:57344
  v_mfma_f32_16x16x32_bf16 v[84:87], v[116:119], v[188:191], v[84:87]
  ds_read_b128 v[116:119], v1 offset:58368
  s_waitcnt lgkmcnt(8)
  v_mfma_f32_16x16x32_bf16 v[88:91], v[120:123], v[184:187], v[88:91]
  ds_read_b128 a[28:31], v38 offset:58368
  v_mfma_f32_16x16x32_bf16 v[92:95], v[120:123], v[188:191], v[92:95]
  ds_read_b128 v[120:123], v1 offset:59392
  s_waitcnt lgkmcnt(9)
  v_mfma_f32_16x16x32_bf16 v[56:59], v[124:127], v[192:195], v[56:59]
  buffer_load_dwordx4 v1, s[8:11], s33 offen offset:1024 sc1 lds
  v_mfma_f32_16x16x32_bf16 v[60:63], v[124:127], v[196:199], v[60:63]
  ds_read_b128 v[124:127], v1 offset:60416
  s_waitcnt lgkmcnt(9)
  v_mfma_f32_16x16x32_bf16 v[64:67], v[128:131], v[192:195], v[64:67]
  v_permlane16_swap_b32 v98, v97
  v_mfma_f32_16x16x32_bf16 v[68:71], v[128:131], v[196:199], v[68:71]
  ds_read_b128 v[128:131], v1 offset:61440
  s_waitcnt lgkmcnt(8)
  v_mfma_f32_16x16x32_bf16 v[72:75], v[132:135], v[192:195], v[72:75]
  v_permlane16_swap_b32 v99, v105
  v_mfma_f32_16x16x32_bf16 v[76:79], v[132:135], v[196:199], v[76:79]
  ds_read_b128 v[132:135], v1 offset:62464
  s_waitcnt lgkmcnt(7)
  v_mfma_f32_16x16x32_bf16 v[80:83], v[112:115], v[192:195], v[80:83]
  buffer_load_dwordx4 v1, s[8:11], s33 offen offset:2048 sc1 lds
  v_add_f32 v97, v97, v98
  v_mfma_f32_16x16x32_bf16 v[84:87], v[112:115], v[196:199], v[84:87]
  ds_read_b128 v[112:115], v1 offset:63488
  s_waitcnt lgkmcnt(6)
  v_mfma_f32_16x16x32_bf16 v[88:91], v[116:119], v[192:195], v[88:91]
  v_add_f32 v105, v105, v99
  v_mul_f32 v97, 0x3ae38e39, v97
  v_mfma_f32_16x16x32_bf16 v[92:95], v[116:119], v[196:199], v[92:95]
  ds_read_b128 v[116:119], v1 offset:64512
  s_waitcnt lgkmcnt(5)
  v_mfma_f32_16x16x32_bf16 v[56:59], v[120:123], v[200:203], v[56:59]
  v_mul_f32 v105, 0x3ae38e39, v105
  v_fma_f32 v97, -v96, v96, v97
  v_mfma_f32_16x16x32_bf16 v[60:63], v[120:123], v[204:207], v[60:63]
  ds_read_b128 v[120:123], v2 offset:0
  s_waitcnt lgkmcnt(5)
  v_mfma_f32_16x16x32_bf16 v[64:67], v[124:127], v[200:203], v[64:67]
  buffer_load_dwordx4 v1, s[8:11], s33 offen offset:3072 sc1 lds
  v_fma_f32 v105, -v104, v104, v105
  v_mfma_f32_16x16x32_bf16 v[68:71], v[124:127], v[204:207], v[68:71]
  ds_read_b128 v[124:127], v2 offset:1024
  s_waitcnt lgkmcnt(5)
  v_mfma_f32_16x16x32_bf16 v[72:75], v[128:131], v[200:203], v[72:75]
  s_add_u32 s33, s33, 16384
  v_max_f32 v97, 0, v97
  v_mfma_f32_16x16x32_bf16 v[76:79], v[128:131], v[204:207], v[76:79]
  ds_read_b128 v[128:131], v2 offset:2048
  s_waitcnt lgkmcnt(5)
  v_mfma_f32_16x16x32_bf16 v[80:83], v[132:135], v[200:203], v[80:83]
  s_add_u32 m0, s40, 81920
  v_max_f32 v105, 0, v105
  v_mfma_f32_16x16x32_bf16 v[84:87], v[132:135], v[204:207], v[84:87]
  ds_read_b128 v[132:135], v2 offset:3072
  s_waitcnt lgkmcnt(5)
  v_mfma_f32_16x16x32_bf16 v[88:91], v[112:115], v[200:203], v[88:91]
  buffer_load_dwordx4 v1, s[8:11], s33 offen offset:0 sc1 lds
  v_add_f32 v97, 0x3727c5ac, v97
  v_mfma_f32_16x16x32_bf16 v[92:95], v[112:115], v[204:207], v[92:95]
  ds_read_b128 v[112:115], v2 offset:4096
  s_waitcnt lgkmcnt(5)
  v_mfma_f32_16x16x32_bf16 v[56:59], v[116:119], v[208:211], v[56:59]
  v_add_f32 v105, 0x3727c5ac, v105
  v_mfma_f32_16x16x32_bf16 v[60:63], v[116:119], v[212:215], v[60:63]
  ds_read_b128 v[116:119], v2 offset:5120
  s_waitcnt lgkmcnt(5)
  v_mfma_f32_16x16x32_bf16 v[64:67], v[120:123], v[208:211], v[64:67]
  v_rsq_f32 v152, v97
  v_mfma_f32_16x16x32_bf16 v[68:71], v[120:123], v[212:215], v[68:71]
  s_waitcnt vmcnt(9)
  s_barrier
  buffer_load_dwordx4 v[168:171], v55, s[8:11], 0 offen sc1
  ds_read_b128 v[120:123], v2 offset:6144
  s_waitcnt lgkmcnt(5)
  v_mfma_f32_16x16x32_bf16 v[72:75], v[124:127], v[208:211], v[72:75]
  buffer_load_dwordx4 v1, s[8:11], s33 offen offset:1024 sc1 lds
  ds_read_b128 a[32:35], v42 offset:6144
  v_mfma_f32_16x16x32_bf16 v[76:79], v[124:127], v[212:215], v[76:79]
  ds_read_b128 v[124:127], v2 offset:7168
  s_waitcnt lgkmcnt(6)
  v_mfma_f32_16x16x32_bf16 v[80:83], v[128:131], v[208:211], v[80:83]
  ds_read_b128 a[36:39], v42 offset:7168
  v_mfma_f32_16x16x32_bf16 v[84:87], v[128:131], v[212:215], v[84:87]
  ds_read_b128 v[128:131], v2 offset:8192
  s_waitcnt lgkmcnt(7)
  v_mfma_f32_16x16x32_bf16 v[88:91], v[132:135], v[208:211], v[88:91]
  ds_read_b128 a[40:43], v42 offset:8192
  v_mfma_f32_16x16x32_bf16 v[92:95], v[132:135], v[212:215], v[92:95]
  ds_read_b128 v[132:135], v2 offset:9216
  s_waitcnt lgkmcnt(8)
  v_mfma_f32_16x16x32_bf16 v[56:59], v[112:115], v[216:219], v[56:59]
  buffer_load_dwordx4 v1, s[8:11], s33 offen offset:2048 sc1 lds
  ds_read_b128 a[44:47], v42 offset:9216
  v_mfma_f32_16x16x32_bf16 v[60:63], v[112:115], v[220:223], v[60:63]
  ds_read_b128 v[112:115], v2 offset:10240
  s_waitcnt lgkmcnt(9)
  v_mfma_f32_16x16x32_bf16 v[64:67], v[116:119], v[216:219], v[64:67]
  v_rsq_f32 v153, v105
  v_mfma_f32_16x16x32_bf16 v[68:71], v[116:119], v[220:223], v[68:71]
  ds_read_b128 v[116:119], v2 offset:11264
  s_waitcnt lgkmcnt(9)
  v_mfma_f32_16x16x32_bf16 v[72:75], v[120:123], v[216:219], v[72:75]
  v_mul_f32 v154, 0x3fb8aa3b, v152
  v_mul_f32 v155, 0x3fb8aa3b, v153
  v_mfma_f32_16x16x32_bf16 v[76:79], v[120:123], v[220:223], v[76:79]
  ds_read_b128 v[120:123], v2 offset:12288
  s_waitcnt lgkmcnt(8)
  v_mfma_f32_16x16x32_bf16 v[80:83], v[124:127], v[216:219], v[80:83]
  buffer_load_dwordx4 v1, s[8:11], s33 offen offset:3072 sc1 lds
  v_mfma_f32_16x16x32_bf16 v[84:87], v[124:127], v[220:223], v[84:87]
  ds_read_b128 v[124:127], v2 offset:13312
  s_waitcnt lgkmcnt(7)
  v_mfma_f32_16x16x32_bf16 v[88:91], v[128:131], v[216:219], v[88:91]
  v_mfma_f32_16x16x32_bf16 v[92:95], v[128:131], v[220:223], v[92:95]
  ds_read_b128 v[128:131], v2 offset:14336
  s_waitcnt lgkmcnt(6)
  v_mfma_f32_16x16x32_bf16 v[56:59], v[132:135], v[224:227], v[56:59]
  s_add_u32 m0, s35, 0
  v_mfma_f32_16x16x32_bf16 v[60:63], v[132:135], v[228:231], v[60:63]
  ds_read_b128 v[132:135], v2 offset:15360
  s_waitcnt lgkmcnt(5)
  v_mfma_f32_16x16x32_bf16 v[64:67], v[112:115], v[224:227], v[64:67]
  buffer_load_dwordx4 v1, s[8:11], s34 offen offset:0 sc1 lds
  v_mfma_f32_16x16x32_bf16 v[68:71], v[112:115], v[228:231], v[68:71]
  ds_read_b128 v[112:115], v2 offset:16384
  s_waitcnt lgkmcnt(5)
  v_mfma_f32_16x16x32_bf16 v[72:75], v[116:119], v[224:227], v[72:75]
  v_mfma_f32_16x16x32_bf16 v[76:79], v[116:119], v[228:231], v[76:79]
  ds_read_b128 v[116:119], v2 offset:17408
  s_waitcnt lgkmcnt(5)
  v_mfma_f32_16x16x32_bf16 v[80:83], v[120:123], v[224:227], v[80:83]
  v_mfma_f32_16x16x32_bf16 v[84:87], v[120:123], v[228:231], v[84:87]
  ds_read_b128 v[120:123], v2 offset:18432
  s_waitcnt lgkmcnt(5)
  v_mfma_f32_16x16x32_bf16 v[88:91], v[124:127], v[224:227], v[88:91]
  buffer_load_dwordx4 v1, s[8:11], s34 offen offset:1024 sc1 lds
  v_mfma_f32_16x16x32_bf16 v[92:95], v[124:127], v[228:231], v[92:95]
  ds_read_b128 v[124:127], v2 offset:19456
  s_waitcnt lgkmcnt(5)
  v_mfma_f32_16x16x32_bf16 v[56:59], v[128:131], v[232:235], v[56:59]
  v_mfma_f32_16x16x32_bf16 v[60:63], v[128:131], v[236:239], v[60:63]
  ds_read_b128 v[128:131], v2 offset:20480
  s_waitcnt lgkmcnt(5)
  v_mfma_f32_16x16x32_bf16 v[64:67], v[132:135], v[232:235], v[64:67]
  v_mfma_f32_16x16x32_bf16 v[68:71], v[132:135], v[236:239], v[68:71]
  ds_read_b128 v[132:135], v2 offset:21504
  s_waitcnt lgkmcnt(5)
  v_mfma_f32_16x16x32_bf16 v[72:75], v[112:115], v[232:235], v[72:75]
  buffer_load_dwordx4 v1, s[8:11], s34 offen offset:2048 sc1 lds
  v_mfma_f32_16x16x32_bf16 v[76:79], v[112:115], v[236:239], v[76:79]
  s_waitcnt vmcnt(12)
  s_barrier
  ds_read_b128 v[112:115], v2 offset:22528
  s_waitcnt lgkmcnt(5)
  v_mfma_f32_16x16x32_bf16 v[80:83], v[116:119], v[232:235], v[80:83]
  ds_read_b128 a[48:51], v42 offset:22528
  v_mfma_f32_16x16x32_bf16 v[84:87], v[116:119], v[236:239], v[84:87]
  ds_read_b128 v[116:119], v2 offset:23552
  s_waitcnt lgkmcnt(6)
  v_mfma_f32_16x16x32_bf16 v[88:91], v[120:123], v[232:235], v[88:91]
  ds_read_b128 a[52:55], v42 offset:23552
  v_mfma_f32_16x16x32_bf16 v[92:95], v[120:123], v[236:239], v[92:95]
  ds_read_b128 v[120:123], v2 offset:24576
  s_waitcnt lgkmcnt(7)
  v_mfma_f32_16x16x32_bf16 v[56:59], v[124:127], v[240:243], v[56:59]
  buffer_load_dwordx4 v1, s[8:11], s34 offen offset:3072 sc1 lds
  ds_read_b128 a[56:59], v42 offset:24576
  v_mfma_f32_16x16x32_bf16 v[60:63], v[124:127], v[244:247], v[60:63]
  ds_read_b128 v[124:127], v2 offset:25600
  s_waitcnt lgkmcnt(8)
  v_mfma_f32_16x16x32_bf16 v[64:67], v[128:131], v[240:243], v[64:67]
  s_add_u32 s34, s34, 4096
  ds_read_b128 a[60:63], v42 offset:25600
  v_mfma_f32_16x16x32_bf16 v[68:71], v[128:131], v[244:247], v[68:71]
  ds_read_b128 v[128:131], v2 offset:26624
  s_waitcnt lgkmcnt(9)
  v_mfma_f32_16x16x32_bf16 v[72:75], v[132:135], v[240:243], v[72:75]
  s_add_u32 m0, s35, 4096
  v_mfma_f32_16x16x32_bf16 v[76:79], v[132:135], v[244:247], v[76:79]
  ds_read_b128 v[132:135], v2 offset:27648
  s_waitcnt lgkmcnt(9)
  v_mfma_f32_16x16x32_bf16 v[80:83], v[112:115], v[240:243], v[80:83]
  buffer_load_dwordx4 v1, s[8:11], s34 offen offset:0 sc1 lds
  v_mfma_f32_16x16x32_bf16 v[84:87], v[112:115], v[244:247], v[84:87]
  ds_read_b128 v[112:115], v2 offset:28672
  s_waitcnt lgkmcnt(8)
  v_mfma_f32_16x16x32_bf16 v[88:91], v[116:119], v[240:243], v[88:91]
  v_mfma_f32_16x16x32_bf16 v[92:95], v[116:119], v[244:247], v[92:95]
  ds_read_b128 v[116:119], v2 offset:29696
  s_waitcnt lgkmcnt(7)
  v_mfma_f32_16x16x32_bf16 v[56:59], v[120:123], v[248:251], v[56:59]
  v_mfma_f32_16x16x32_bf16 v[60:63], v[120:123], v[252:255], v[60:63]
  ds_read_b128 v[120:123], v2 offset:30720
  s_waitcnt lgkmcnt(6)
  v_mfma_f32_16x16x32_bf16 v[64:67], v[124:127], v[248:251], v[64:67]
  buffer_load_dwordx4 v1, s[8:11], s34 offen offset:1024 sc1 lds
  v_mfma_f32_16x16x32_bf16 v[68:71], v[124:127], v[252:255], v[68:71]
  ds_read_b128 v[124:127], v2 offset:31744
  s_waitcnt lgkmcnt(5)
  v_mfma_f32_16x16x32_bf16 v[72:75], v[128:131], v[248:251], v[72:75]
  v_mfma_f32_16x16x32_bf16 v[76:79], v[128:131], v[252:255], v[76:79]
  ds_read_b128 v[128:131], v2 offset:32768
  s_waitcnt lgkmcnt(5)
  v_mfma_f32_16x16x32_bf16 v[80:83], v[132:135], v[248:251], v[80:83]
  v_mfma_f32_16x16x32_bf16 v[84:87], v[132:135], v[252:255], v[84:87]
  ds_read_b128 v[132:135], v2 offset:33792
  s_waitcnt lgkmcnt(5)
  v_mfma_f32_16x16x32_bf16 v[88:91], v[112:115], v[248:251], v[88:91]
  buffer_load_dwordx4 v1, s[8:11], s34 offen offset:2048 sc1 lds
  v_mfma_f32_16x16x32_bf16 v[92:95], v[112:115], v[252:255], v[92:95]
  ds_read_b128 v[112:115], v2 offset:34816
  s_waitcnt lgkmcnt(5)
  v_mfma_f32_16x16x32_bf16 v[56:59], v[116:119], a[192:195], v[56:59]
  v_mfma_f32_16x16x32_bf16 v[60:63], v[116:119], a[196:199], v[60:63]
  ds_read_b128 v[116:119], v2 offset:35840
  s_waitcnt lgkmcnt(5)
  v_mfma_f32_16x16x32_bf16 v[64:67], v[120:123], a[192:195], v[64:67]
  v_mfma_f32_16x16x32_bf16 v[68:71], v[120:123], a[196:199], v[68:71]
  ds_read_b128 v[120:123], v2 offset:36864
  s_waitcnt lgkmcnt(5)
  v_mfma_f32_16x16x32_bf16 v[72:75], v[124:127], a[192:195], v[72:75]
  buffer_load_dwordx4 v1, s[8:11], s34 offen offset:3072 sc1 lds
  v_mfma_f32_16x16x32_bf16 v[76:79], v[124:127], a[196:199], v[76:79]
  ds_read_b128 v[124:127], v2 offset:37888
  s_waitcnt lgkmcnt(5)
  v_mfma_f32_16x16x32_bf16 v[80:83], v[128:131], a[192:195], v[80:83]
  s_add_u32 s34, s34, 4096
  v_mfma_f32_16x16x32_bf16 v[84:87], v[128:131], a[196:199], v[84:87]
  s_waitcnt vmcnt(13)
  s_barrier
  s_waitcnt vmcnt(11)
Lp2chk_11:
  v_cmp_ne_u32 vcc, s55, v168
  v_cmp_ne_u32 s[86:87], s55, v170
  v_cmp_ne_u32 s[88:89], s59, v169
  v_cmp_ne_u32 s[90:91], s59, v171
  s_or_b64 vcc, vcc, s[86:87]
  s_cbranch_scc1 Lretry_13
Lp2ok_12:
  s_or_b32 s56, s89, s91
  ds_read_b128 v[128:131], v2 offset:38912
  s_waitcnt lgkmcnt(5)
  v_mfma_f32_16x16x32_bf16 v[88:91], v[132:135], a[192:195], v[88:91]
  s_add_u32 m0, s35, 8192
  ds_read_b128 a[64:67], v42 offset:38912
  v_mfma_f32_16x16x32_bf16 v[92:95], v[132:135], a[196:199], v[92:95]
  ds_read_b128 v[132:135], v2 offset:39936
  s_waitcnt lgkmcnt(6)
  v_mfma_f32_16x16x32_bf16 v[56:59], v[112:115], a[200:203], v[56:59]
  buffer_load_dwordx4 v1, s[8:11], s34 offen offset:0 sc1 lds
  ds_read_b128 a[68:71], v42 offset:39936
  v_mfma_f32_16x16x32_bf16 v[60:63], v[112:115], a[204:207], v[60:63]
  ds_read_b128 v[112:115], v2 offset:40960
  s_waitcnt lgkmcnt(7)
  v_mfma_f32_16x16x32_bf16 v[64:67], v[116:119], a[200:203], v[64:67]
  ds_read_b128 a[72:75], v42 offset:40960
  v_mfma_f32_16x16x32_bf16 v[68:71], v[116:119], a[204:207], v[68:71]
  ds_read_b128 v[116:119], v2 offset:41984
  s_waitcnt lgkmcnt(8)
  v_mfma_f32_16x16x32_bf16 v[72:75], v[120:123], a[200:203], v[72:75]
  ds_read_b128 a[76:79], v42 offset:41984
  v_mfma_f32_16x16x32_bf16 v[76:79], v[120:123], a[204:207], v[76:79]
  ds_read_b128 v[120:123], v2 offset:43008
  s_waitcnt lgkmcnt(9)
  v_mfma_f32_16x16x32_bf16 v[80:83], v[124:127], a[200:203], v[80:83]
  buffer_load_dwordx4 v1, s[8:11], s34 offen offset:1024 sc1 lds
  v_mfma_f32_16x16x32_bf16 v[84:87], v[124:127], a[204:207], v[84:87]
  ds_read_b128 v[124:127], v2 offset:44032
  s_waitcnt lgkmcnt(9)
  v_mfma_f32_16x16x32_bf16 v[88:91], v[128:131], a[200:203], v[88:91]
  v_mfma_f32_16x16x32_bf16 v[92:95], v[128:131], a[204:207], v[92:95]
  ds_read_b128 v[128:131], v2 offset:45056
  s_waitcnt lgkmcnt(8)
  v_mfma_f32_16x16x32_bf16 v[56:59], v[132:135], a[208:211], v[56:59]
  v_mfma_f32_16x16x32_bf16 v[60:63], v[132:135], a[212:215], v[60:63]
  ds_read_b128 v[132:135], v2 offset:46080
  s_waitcnt lgkmcnt(7)
  v_mfma_f32_16x16x32_bf16 v[64:67], v[112:115], a[208:211], v[64:67]
  buffer_load_dword v165, v46, s[8:11], 0 offen sc1
  global_load_dword v165, v[166:167], off sc1
  v_mfma_f32_16x16x32_bf16 v[68:71], v[112:115], a[212:215], v[68:71]
  ds_read_b128 v[112:115], v2 offset:47104
  s_waitcnt lgkmcnt(6)
  v_mfma_f32_16x16x32_bf16 v[72:75], v[116:119], a[208:211], v[72:75]
  s_lshl_b32 s40, s54, 12
  s_add_u32 s33, s40, s38
  v_mfma_f32_16x16x32_bf16 v[76:79], v[116:119], a[212:215], v[76:79]
  ds_read_b128 v[116:119], v2 offset:48128
  s_waitcnt lgkmcnt(5)
  v_mfma_f32_16x16x32_bf16 v[80:83], v[120:123], a[208:211], v[80:83]
  s_add_u32 s33, s33, 2179072
  buffer_load_dwordx4 a[96:99], v1, s[8:11], s33 offen offset:0 sc1
  v_mfma_f32_16x16x32_bf16 v[84:87], v[120:123], a[212:215], v[84:87]
  ds_read_b128 v[120:123], v2 offset:49152
  s_waitcnt lgkmcnt(5)
  v_mfma_f32_16x16x32_bf16 v[88:91], v[124:127], a[208:211], v[88:91]
  buffer_load_dwordx4 a[100:103], v1, s[8:11], s33 offen offset:1024 sc1
  v_mfma_f32_16x16x32_bf16 v[92:95], v[124:127], a[212:215], v[92:95]
  ds_read_b128 v[124:127], v2 offset:50176
  s_waitcnt lgkmcnt(5)
  v_mfma_f32_16x16x32_bf16 v[56:59], v[128:131], a[216:219], v[56:59]
  v_mfma_f32_16x16x32_bf16 v[60:63], v[128:131], a[220:223], v[60:63]
  ds_read_b128 v[128:131], v2 offset:51200
  s_waitcnt lgkmcnt(5)
  v_mfma_f32_16x16x32_bf16 v[64:67], v[132:135], a[216:219], v[64:67]
  v_mfma_f32_16x16x32_bf16 v[68:71], v[132:135], a[220:223], v[68:71]
  ds_read_b128 v[132:135], v2 offset:52224
  s_waitcnt lgkmcnt(5)
  v_mfma_f32_16x16x32_bf16 v[72:75], v[112:115], a[216:219], v[72:75]
  buffer_load_dwordx4 a[104:107], v1, s[8:11], s33 offen offset:2048 sc1
  v_mfma_f32_16x16x32_bf16 v[76:79], v[112:115], a[220:223], v[76:79]
  ds_read_b128 v[112:115], v2 offset:53248
  s_waitcnt lgkmcnt(5)
  v_mfma_f32_16x16x32_bf16 v[80:83], v[116:119], a[216:219], v[80:83]
  v_mfma_f32_16x16x32_bf16 v[84:87], v[116:119], a[220:223], v[84:87]
  ds_read_b128 v[116:119], v2 offset:54272
  s_waitcnt lgkmcnt(5)
  v_mfma_f32_16x16x32_bf16 v[88:91], v[120:123], a[216:219], v[88:91]
  v_mfma_f32_16x16x32_bf16 v[92:95], v[120:123], a[220:223], v[92:95]
  s_waitcnt vmcnt(15)
  s_barrier
  ds_read_b128 v[120:123], v2 offset:55296
  s_waitcnt lgkmcnt(5)
  v_mfma_f32_16x16x32_bf16 v[56:59], v[124:127], a[224:227], v[56:59]
  buffer_load_dwordx4 a[108:111], v1, s[8:11], s33 offen offset:3072 sc1
  ds_read_b128 a[80:83], v42 offset:55296
  v_mfma_f32_16x16x32_bf16 v[60:63], v[124:127], a[228:231], v[60:63]
  ds_read_b128 v[124:127], v2 offset:56320
  s_waitcnt lgkmcnt(6)
  v_mfma_f32_16x16x32_bf16 v[64:67], v[128:131], a[224:227], v[64:67]
  s_add_u32 s33, s33, 16384
  ds_read_b128 a[84:87], v42 offset:56320
  v_mfma_f32_16x16x32_bf16 v[68:71], v[128:131], a[228:231], v[68:71]
  ds_read_b128 v[128:131], v2 offset:57344
  s_waitcnt lgkmcnt(7)
  v_mfma_f32_16x16x32_bf16 v[72:75], v[132:135], a[224:227], v[72:75]
  ds_read_b128 a[88:91], v42 offset:57344
  v_mfma_f32_16x16x32_bf16 v[76:79], v[132:135], a[228:231], v[76:79]
  ds_read_b128 v[132:135], v2 offset:58368
  s_waitcnt lgkmcnt(8)
  v_mfma_f32_16x16x32_bf16 v[80:83], v[112:115], a[224:227], v[80:83]
  buffer_load_dwordx4 a[112:115], v1, s[8:11], s33 offen offset:0 sc1
  ds_read_b128 a[92:95], v42 offset:58368
  v_mfma_f32_16x16x32_bf16 v[84:87], v[112:115], a[228:231], v[84:87]
  ds_read_b128 v[112:115], v2 offset:59392
  s_waitcnt lgkmcnt(9)
  v_mfma_f32_16x16x32_bf16 v[88:91], v[116:119], a[224:227], v[88:91]
  v_mfma_f32_16x16x32_bf16 v[92:95], v[116:119], a[228:231], v[92:95]
  ds_read_b128 v[116:119], v2 offset:60416
  s_waitcnt lgkmcnt(9)
  v_mfma_f32_16x16x32_bf16 v[56:59], v[120:123], a[232:235], v[56:59]
  v_mfma_f32_16x16x32_bf16 v[60:63], v[120:123], a[236:239], v[60:63]
  ds_read_b128 v[120:123], v2 offset:61440
  s_waitcnt lgkmcnt(8)
  v_mfma_f32_16x16x32_bf16 v[64:67], v[124:127], a[232:235], v[64:67]
  buffer_load_dwordx4 a[116:119], v1, s[8:11], s33 offen offset:1024 sc1
  v_mfma_f32_16x16x32_bf16 v[68:71], v[124:127], a[236:239], v[68:71]
  ds_read_b128 v[124:127], v2 offset:62464
  s_waitcnt lgkmcnt(7)
  v_mfma_f32_16x16x32_bf16 v[72:75], v[128:131], a[232:235], v[72:75]
  v_mfma_f32_16x16x32_bf16 v[76:79], v[128:131], a[236:239], v[76:79]
  ds_read_b128 v[128:131], v2 offset:63488
  s_waitcnt lgkmcnt(6)
  v_mfma_f32_16x16x32_bf16 v[80:83], v[132:135], a[232:235], v[80:83]
  v_mfma_f32_16x16x32_bf16 v[84:87], v[132:135], a[236:239], v[84:87]
  ds_read_b128 v[132:135], v2 offset:64512
  s_waitcnt lgkmcnt(5)
  v_mfma_f32_16x16x32_bf16 v[88:91], v[112:115], a[232:235], v[88:91]
  v_mfma_f32_16x16x32_bf16 v[92:95], v[112:115], a[236:239], v[92:95]
  ds_read_b128 v[112:115], v18 offset:0
  s_waitcnt lgkmcnt(5)
  v_mfma_f32_16x16x32_bf16 v[56:59], v[116:119], a[240:243], v[56:59]
  v_mfma_f32_16x16x32_bf16 v[60:63], v[116:119], a[244:247], v[60:63]
  ds_read_b128 v[116:119], v18 offset:1024
  s_waitcnt lgkmcnt(5)
  v_mfma_f32_16x16x32_bf16 v[64:67], v[120:123], a[240:243], v[64:67]
  v_mfma_f32_16x16x32_bf16 v[68:71], v[120:123], a[244:247], v[68:71]
  ds_read_b128 v[120:123], v18 offset:2048
  s_waitcnt lgkmcnt(5)
  v_mfma_f32_16x16x32_bf16 v[72:75], v[124:127], a[240:243], v[72:75]
  v_mfma_f32_16x16x32_bf16 v[76:79], v[124:127], a[244:247], v[76:79]
  ds_read_b128 v[124:127], v18 offset:3072
  s_waitcnt lgkmcnt(5)
  v_mfma_f32_16x16x32_bf16 v[80:83], v[128:131], a[240:243], v[80:83]
  v_mfma_f32_16x16x32_bf16 v[84:87], v[128:131], a[244:247], v[84:87]
  ds_read_b128 v[128:131], v18 offset:4096
  s_waitcnt lgkmcnt(5)
  v_mfma_f32_16x16x32_bf16 v[88:91], v[132:135], a[240:243], v[88:91]
  v_mfma_f32_16x16x32_bf16 v[92:95], v[132:135], a[244:247], v[92:95]
  s_waitcnt lgkmcnt(4)
  v_mfma_f32_16x16x32_bf16 v[56:59], v[112:115], a[248:251], v[56:59]
  v_mfma_f32_16x16x32_bf16 v[60:63], v[112:115], a[252:255], v[60:63]
  s_waitcnt lgkmcnt(3)
  v_mfma_f32_16x16x32_bf16 v[64:67], v[116:119], a[248:251], v[64:67]
  v_mfma_f32_16x16x32_bf16 v[68:71], v[116:119], a[252:255], v[68:71]
  s_waitcnt lgkmcnt(2)
  v_mfma_f32_16x16x32_bf16 v[72:75], v[120:123], a[248:251], v[72:75]
  v_mfma_f32_16x16x32_bf16 v[76:79], v[120:123], a[252:255], v[76:79]
  s_waitcnt lgkmcnt(1)
  v_mfma_f32_16x16x32_bf16 v[80:83], v[124:127], a[248:251], v[80:83]
  v_mfma_f32_16x16x32_bf16 v[84:87], v[124:127], a[252:255], v[84:87]
  s_waitcnt lgkmcnt(0)
  v_mfma_f32_16x16x32_bf16 v[88:91], v[128:131], a[248:251], v[88:91]
  v_mfma_f32_16x16x32_bf16 v[92:95], v[128:131], a[252:255], v[92:95]
  v_pk_mul_f32 v[112:113], v[56:57], v[154:155] op_sel_hi:[1,0]
  v_pk_mul_f32 v[114:115], v[58:59], v[154:155] op_sel_hi:[1,0]
  v_pk_mul_f32 v[116:117], v[60:61], v[154:155] op_sel:[0,1] op_sel_hi:[1,1]
  v_pk_mul_f32 v[118:119], v[62:63], v[154:155] op_sel:[0,1] op_sel_hi:[1,1]
  v_pk_mul_f32 v[120:121], v[64:65], v[154:155] op_sel_hi:[1,0]
  v_pk_mul_f32 v[122:123], v[66:67], v[154:155] op_sel_hi:[1,0]
  v_pk_mul_f32 v[124:125], v[68:69], v[154:155] op_sel:[0,1] op_sel_hi:[1,1]
  v_pk_mul_f32 v[126:127], v[70:71], v[154:155] op_sel:[0,1] op_sel_hi:[1,1]
  v_pk_mul_f32 v[128:129], v[90:91], v[154:155] op_sel_hi:[1,0]
  v_pk_mul_f32 v[130:131], v[94:95], v[154:155] op_sel:[0,1] op_sel_hi:[1,1]
  v_exp_f32 v112, v112 clamp
  v_exp_f32 v113, v113 clamp
  v_pk_fma_f32 v[56:57], v[56:57], v[152:153], 1.0 op_sel_hi:[1,0,0]
  v_exp_f32 v114, v114 clamp
  v_exp_f32 v115, v115 clamp
  v_pk_fma_f32 v[58:59], v[58:59], v[152:153], 1.0 op_sel_hi:[1,0,0]
  v_exp_f32 v116, v116 clamp
  v_exp_f32 v117, v117 clamp
  v_pk_fma_f32 v[60:61], v[60:61], v[152:153], 1.0 op_sel:[0,1,0] op_sel_hi:[1,1,0]
  v_exp_f32 v118, v118 clamp
  v_exp_f32 v119, v119 clamp
  v_pk_fma_f32 v[62:63], v[62:63], v[152:153], 1.0 op_sel:[0,1,0] op_sel_hi:[1,1,0]
  v_exp_f32 v120, v120 clamp
  v_exp_f32 v121, v121 clamp
  v_pk_fma_f32 v[64:65], v[64:65], v[152:153], 1.0 op_sel_hi:[1,0,0]
  v_exp_f32 v122, v122 clamp
  v_exp_f32 v123, v123 clamp
  v_pk_fma_f32 v[66:67], v[66:67], v[152:153], 1.0 op_sel_hi:[1,0,0]
  v_exp_f32 v124, v124 clamp
  v_exp_f32 v125, v125 clamp
  v_pk_fma_f32 v[68:69], v[68:69], v[152:153], 1.0 op_sel:[0,1,0] op_sel_hi:[1,1,0]
  v_exp_f32 v126, v126 clamp
  v_exp_f32 v127, v127 clamp
  v_pk_fma_f32 v[70:71], v[70:71], v[152:153], 1.0 op_sel:[0,1,0] op_sel_hi:[1,1,0]
  v_exp_f32 v128, v128 clamp
  v_exp_f32 v129, v129 clamp
  v_pk_fma_f32 v[90:91], v[90:91], v[152:153], 1.0 op_sel_hi:[1,0,0]
  v_exp_f32 v130, v130 clamp
  v_exp_f32 v131, v131 clamp
  v_pk_fma_f32 v[94:95], v[94:95], v[152:153], 1.0 op_sel:[0,1,0] op_sel_hi:[1,1,0]
  s_mov_b32 s86, 0x358637bd
  s_mov_b32 s87, 0x358637bd
  v_max_f32 v56, v56, v112
  v_max_f32 v57, v57, v113
  v_pk_add_f32 v[56:57], v[56:57], s[86:87]
  v_max_f32 v58, v58, v114
  v_max_f32 v59, v59, v115
  v_pk_add_f32 v[58:59], v[58:59], s[86:87]
  v_max_f32 v60, v60, v116
  v_max_f32 v61, v61, v117
  v_pk_add_f32 v[60:61], v[60:61], s[86:87]
  v_max_f32 v62, v62, v118
  v_max_f32 v63, v63, v119
  v_pk_add_f32 v[62:63], v[62:63], s[86:87]
  v_max_f32 v64, v64, v120
  v_max_f32 v65, v65, v121
  v_pk_add_f32 v[64:65], v[64:65], s[86:87]
  v_max_f32 v66, v66, v122
  v_max_f32 v67, v67, v123
  v_pk_add_f32 v[66:67], v[66:67], s[86:87]
  v_max_f32 v68, v68, v124
  v_max_f32 v69, v69, v125
  v_pk_add_f32 v[68:69], v[68:69], s[86:87]
  v_max_f32 v70, v70, v126
  v_max_f32 v71, v71, v127
  v_pk_add_f32 v[70:71], v[70:71], s[86:87]
  v_max_f32 v90, v90, v128
  v_max_f32 v91, v91, v129
  v_pk_add_f32 v[90:91], v[90:91], s[86:87]
  v_max_f32 v94, v94, v130
  v_max_f32 v95, v95, v131
  v_pk_add_f32 v[94:95], v[94:95], s[86:87]
  v_cvt_pk_bf16_f32 v132, v56, v57
  v_cvt_pk_bf16_f32 v133, v58, v59
  v_cvt_pk_bf16_f32 v134, v64, v65
  v_cvt_pk_bf16_f32 v135, v66, v67
  v_cvt_pk_bf16_f32 v136, v60, v61
  v_cvt_pk_bf16_f32 v137, v62, v63
  v_cvt_pk_bf16_f32 v138, v68, v69
  v_cvt_pk_bf16_f32 v139, v70, v71
  ds_write_b128 v19, v[132:135] offset:38912
  ds_write_b128 v19, v[136:139] offset:39168
  v_pk_mul_f32 v[72:73], v[72:73], v[152:153] op_sel_hi:[1,0]
  v_pk_mul_f32 v[74:75], v[74:75], v[152:153] op_sel_hi:[1,0]
  v_pk_mul_f32 v[76:77], v[76:77], v[152:153] op_sel:[0,1] op_sel_hi:[1,1]
  v_pk_mul_f32 v[78:79], v[78:79], v[152:153] op_sel:[0,1] op_sel_hi:[1,1]
  v_pk_mul_f32 v[80:81], v[80:81], v[152:153] op_sel_hi:[1,0]
  v_pk_mul_f32 v[82:83], v[82:83], v[152:153] op_sel_hi:[1,0]
  v_pk_mul_f32 v[84:85], v[84:85], v[152:153] op_sel:[0,1] op_sel_hi:[1,1]
  v_pk_mul_f32 v[86:87], v[86:87], v[152:153] op_sel:[0,1] op_sel_hi:[1,1]
  v_cvt_pk_bf16_f32 v140, v72, v73
  v_cvt_pk_bf16_f32 v141, v74, v75
  v_cvt_pk_bf16_f32 v142, v80, v81
  v_cvt_pk_bf16_f32 v143, v82, v83
  v_cvt_pk_bf16_f32 v144, v76, v77
  v_cvt_pk_bf16_f32 v145, v78, v79
  v_cvt_pk_bf16_f32 v146, v84, v85
  v_cvt_pk_bf16_f32 v147, v86, v87
  ds_write_b128 v19, v[140:143] offset:39936
  ds_write_b128 v19, v[144:147] offset:40192
  v_pk_mul_f32 v[88:89], v[88:89], v[152:153] op_sel_hi:[1,0]
  v_pk_mul_f32 v[92:93], v[92:93], v[152:153] op_sel:[0,1] op_sel_hi:[1,1]
  v_cvt_pk_bf16_f32 v148, v88, v89
  v_cvt_pk_bf16_f32 v48, v92, v93
  v_cvt_pk_bf16_f32 v150, v90, v91
  v_cvt_pk_bf16_f32 v164, v94, v95
  v_mov_b32 v149, 0x3f803f80
  v_mov_b32 v151, 0
  v_permlane16_swap_b32 v148, v48
  v_permlane16_swap_b32 v150, v164
  ds_write_b128 v43, v[148:151] offset:38912
  buffer_load_dwordx4 a[120:123], v1, s[8:11], s33 offen offset:2048 sc1
  buffer_load_dwordx4 a[124:127], v1, s[8:11], s33 offen offset:3072 sc1
  s_add_u32 s33, s33, 16384
  buffer_load_dwordx4 a[128:131], v1, s[8:11], s33 offen offset:0 sc1
  buffer_load_dwordx4 a[132:135], v1, s[8:11], s33 offen offset:1024 sc1
  buffer_load_dwordx4 a[136:139], v1, s[8:11], s33 offen offset:2048 sc1
  buffer_load_dwordx4 a[140:143], v1, s[8:11], s33 offen offset:3072 sc1
  s_waitcnt vmcnt(14) lgkmcnt(0)
  s_barrier
  ds_read_b64_tr_b16 v[56:57], v41 offset:38912
  ds_read_b64_tr_b16 v[58:59], v41 offset:38976
  ds_read_b64_tr_b16 v[60:61], v40 offset:38912
  ds_read_b64_tr_b16 v[62:63], v40 offset:38976
  ds_read_b64_tr_b16 v[64:65], v0 offset:40968
  ds_read_b64_tr_b16 v[66:67], v0 offset:41032
  ds_read_b64_tr_b16 v[68:69], v41 offset:44032
  ds_read_b64_tr_b16 v[70:71], v41 offset:44096
  ds_read_b64_tr_b16 v[72:73], v40 offset:44032
  ds_read_b64_tr_b16 v[74:75], v40 offset:44096
  ds_read_b64_tr_b16 v[76:77], v0 offset:46088
  ds_read_b64_tr_b16 v[78:79], v0 offset:46152
  s_waitcnt lgkmcnt(8)
  v_mfma_f32_16x16x32_bf16 v[80:83], v[60:63], v[56:59], 0
  s_waitcnt lgkmcnt(6)
  v_mfma_f32_16x16x32_bf16 v[84:87], v[64:67], v[56:59], 0
  ds_read_b64_tr_b16 v[132:133], v41 offset:49152
  ds_read_b64_tr_b16 v[134:135], v41 offset:49216
  ds_read_b64_tr_b16 v[136:137], v40 offset:49152
  ds_read_b64_tr_b16 v[138:139], v40 offset:49216
  ds_read_b64_tr_b16 v[140:141], v0 offset:51208
  ds_read_b64_tr_b16 v[142:143], v0 offset:51272
  s_waitcnt lgkmcnt(8)
  v_mfma_f32_16x16x32_bf16 v[80:83], v[72:75], v[68:71], v[80:83]
  s_waitcnt lgkmcnt(6)
  v_mfma_f32_16x16x32_bf16 v[84:87], v[76:79], v[68:71], v[84:87]
  ds_read_b64_tr_b16 v[56:57], v41 offset:54272
  ds_read_b64_tr_b16 v[58:59], v41 offset:54336
  ds_read_b64_tr_b16 v[60:61], v40 offset:54272
  ds_read_b64_tr_b16 v[62:63], v40 offset:54336
  ds_read_b64_tr_b16 v[64:65], v0 offset:56328
  ds_read_b64_tr_b16 v[66:67], v0 offset:56392
  s_waitcnt lgkmcnt(8)
  v_mfma_f32_16x16x32_bf16 v[80:83], v[136:139], v[132:135], v[80:83]
  s_waitcnt lgkmcnt(6)
  v_mfma_f32_16x16x32_bf16 v[84:87], v[140:143], v[132:135], v[84:87]
  ds_read2st64_b32 v[112:113], v44 offset0:0 offset1:1
  ds_read2st64_b32 v[114:115], v44 offset0:2 offset1:3
  ds_read2st64_b32 v[116:117], v44 offset0:4 offset1:5
  ds_read2st64_b32 v[118:119], v44 offset0:6 offset1:7
  s_waitcnt lgkmcnt(6)
  v_mfma_f32_16x16x32_bf16 v[80:83], v[60:63], v[56:59], v[80:83]
  s_waitcnt lgkmcnt(4)
  v_mfma_f32_16x16x32_bf16 v[84:87], v[64:67], v[56:59], v[84:87]
  s_nop 5
  v_cvt_pk_bf16_f32 v88, v80, v81
  v_cvt_pk_bf16_f32 v89, v82, v83
  v_cvt_pk_bf16_f32 v90, v80, v81
  v_cvt_pk_bf16_f32 v91, v82, v83
  v_cvt_pk_bf16_f32 v92, v84, v85
  v_permlane16_swap_b32 v88, v90
  v_permlane16_swap_b32 v89, v91
  buffer_store_dword v92, v37, s[8:11], s25 offen offset:640 sc1
  buffer_store_dwordx4 v[88:91], v36, s[8:11], s25 offen sc1
  s_mov_b32 s80, s74
  ds_read_b128 v[120:123], v1 offset:2048
  ds_read_b128 v[124:127], v1 offset:4096
  ds_read_b128 v[128:131], v1 offset:3072
  s_waitcnt lgkmcnt(5)
  v_mfma_f32_16x16x32_bf16 v[96:99], v[112:115], v[156:159], 0
  v_mfma_f32_16x16x32_bf16 v[100:103], v[112:115], v[160:163], 0
  ds_read_b128 v[112:115], v1 offset:6144
  s_waitcnt lgkmcnt(4)
  v_mfma_f32_16x16x32_bf16 v[104:107], v[116:119], v[156:159], 0
  s_add_u32 m0, s37, 0
  v_mfma_f32_16x16x32_bf16 v[108:111], v[116:119], v[160:163], 0
  ds_read_b128 v[116:119], v1 offset:8192
  s_waitcnt lgkmcnt(4)
  v_mfma_f32_16x16x32_bf16 v[96:99], v[120:123], v[176:179], v[96:99]
  buffer_load_dwordx4 v1, s[8:11], s36 offen offset:0 sc1 lds
  v_cmp_gt_u32 vcc, 32, v16
  v_mfma_f32_16x16x32_bf16 v[100:103], v[120:123], v[180:183], v[100:103]
  ds_read_b128 v[120:123], v1 offset:10240
  s_waitcnt lgkmcnt(4)
  v_mfma_f32_16x16x32_bf16 v[96:99], v[124:127], v[184:187], v[96:99]
  buffer_load_dwordx4 v1, s[8:11], s36 offen offset:1024 sc1 lds
  v_mov_b32 v169, 0
  v_mfma_f32_16x16x32_bf16 v[100:103], v[124:127], v[188:191], v[100:103]
  ds_read_b128 v[124:127], v1 offset:5120
  s_waitcnt lgkmcnt(4)
  v_mfma_f32_16x16x32_bf16 v[104:107], v[128:131], v[176:179], v[104:107]
  buffer_load_dwordx4 v1, s[8:11], s36 offen offset:2048 sc1 lds
  v_mov_b32 v171, 0
  v_mfma_f32_16x16x32_bf16 v[108:111], v[128:131], v[180:183], v[108:111]
  ds_read_b128 v[128:131], v1 offset:12288
  s_waitcnt lgkmcnt(4)
  v_mfma_f32_16x16x32_bf16 v[96:99], v[112:115], v[192:195], v[96:99]
  buffer_load_dwordx4 v1, s[8:11], s36 offen offset:3072 sc1 lds
  s_add_u32 s36, s36, 4096
  v_mfma_f32_16x16x32_bf16 v[100:103], v[112:115], v[196:199], v[100:103]
  ds_read_b128 v[112:115], v1 offset:14336
  s_waitcnt lgkmcnt(4)
  v_mfma_f32_16x16x32_bf16 v[96:99], v[116:119], v[200:203], v[96:99]
  s_add_u32 m0, s37, 4096
  v_mov_b32 v48, 0x3f80
  v_mfma_f32_16x16x32_bf16 v[100:103], v[116:119], v[204:207], v[100:103]
  ds_read_b128 v[116:119], v1 offset:16384
  s_waitcnt lgkmcnt(4)
  v_mfma_f32_16x16x32_bf16 v[96:99], v[120:123], v[208:211], v[96:99]
  buffer_load_dwordx4 v1, s[8:11], s36 offen offset:0 sc1 lds
  s_mul_i32 s36, s54, 8192
  v_mfma_f32_16x16x32_bf16 v[100:103], v[120:123], v[212:215], v[100:103]
  ds_read_b128 v[120:123], v1 offset:7168
  s_waitcnt lgkmcnt(4)
  v_mfma_f32_16x16x32_bf16 v[104:107], v[124:127], v[184:187], v[104:107]
  s_min_u32 s36, s36, 23552
  s_add_u32 s37, s36, 65536
  v_mfma_f32_16x16x32_bf16 v[108:111], v[124:127], v[188:191], v[108:111]
  ds_read_b128 v[124:127], v1 offset:18432
  s_waitcnt lgkmcnt(4)
  v_mfma_f32_16x16x32_bf16 v[96:99], v[128:131], v[216:219], v[96:99]
  s_add_u32 s36, s36, s39
  s_add_u32 m0, s37, 0
  v_mfma_f32_16x16x32_bf16 v[100:103], v[128:131], v[220:223], v[100:103]
  ds_read_b128 v[128:131], v1 offset:20480
  s_waitcnt lgkmcnt(4)
  v_mfma_f32_16x16x32_bf16 v[96:99], v[112:115], v[224:227], v[96:99]
  buffer_load_dwordx4 v1, s[8:11], s36 offen offset:0 sc1 lds
  buffer_load_dwordx4 v1, s[8:11], s36 offen offset:1024 sc1 lds
  v_mfma_f32_16x16x32_bf16 v[100:103], v[112:115], v[228:231], v[100:103]
  ds_read_b128 v[112:115], v1 offset:9216
  s_waitcnt lgkmcnt(4)
  v_mfma_f32_16x16x32_bf16 v[96:99], v[116:119], v[232:235], v[96:99]
  buffer_load_dwordx4 v1, s[8:11], s36 offen offset:2048 sc1 lds
  buffer_load_dwordx4 v1, s[8:11], s36 offen offset:3072 sc1 lds
  v_mfma_f32_16x16x32_bf16 v[100:103], v[116:119], v[236:239], v[100:103]
  ds_read_b128 v[116:119], v1 offset:22528
  s_waitcnt lgkmcnt(4)
  v_mfma_f32_16x16x32_bf16 v[104:107], v[120:123], v[192:195], v[104:107]
  s_add_u32 s36, s36, 4096
  s_add_u32 m0, s37, 4096
  v_mfma_f32_16x16x32_bf16 v[108:111], v[120:123], v[196:199], v[108:111]
  ds_read_b128 v[120:123], v1 offset:24576
  s_waitcnt lgkmcnt(4)
  v_mfma_f32_16x16x32_bf16 v[96:99], v[124:127], v[240:243], v[96:99]
  buffer_load_dwordx4 v1, s[8:11], s36 offen offset:0 sc1 lds
  buffer_load_dwordx4 v1, s[8:11], s36 offen offset:1024 sc1 lds
  v_mfma_f32_16x16x32_bf16 v[100:103], v[124:127], v[244:247], v[100:103]
  ds_read_b128 v[124:127], v1 offset:26624
  s_waitcnt lgkmcnt(4)
  v_mfma_f32_16x16x32_bf16 v[96:99], v[128:131], v[248:251], v[96:99]
  buffer_load_dwordx4 v1, s[8:11], s36 offen offset:2048 sc1 lds
  buffer_load_dwordx4 v1, s[8:11], s36 offen offset:3072 sc1 lds
  v_mfma_f32_16x16x32_bf16 v[100:103], v[128:131], v[252:255], v[100:103]
  ds_read_b128 v[128:131], v1 offset:11264
  s_waitcnt lgkmcnt(4)
  v_mfma_f32_16x16x32_bf16 v[104:107], v[112:115], v[200:203], v[104:107]
  s_mul_i32 s36, s54, 10240
  s_min_u32 s36, s36, 29696
  v_mfma_f32_16x16x32_bf16 v[108:111], v[112:115], v[204:207], v[108:111]
  ds_read_b128 v[112:115], v1 offset:28672
  s_waitcnt lgkmcnt(4)
  v_mfma_f32_16x16x32_bf16 v[96:99], v[116:119], a[192:195], v[96:99]
  s_add_u32 s37, s36, 97280
  s_add_u32 s36, s36, s39
  v_mfma_f32_16x16x32_bf16 v[100:103], v[116:119], a[196:199], v[100:103]
  ds_read_b128 v[116:119], v1 offset:30720
  s_waitcnt lgkmcnt(4)
  v_mfma_f32_16x16x32_bf16 v[96:99], v[120:123], a[200:203], v[96:99]
  s_add_u32 s36, s36, 31744
  s_add_u32 m0, s37, 0
  v_mfma_f32_16x16x32_bf16 v[100:103], v[120:123], a[204:207], v[100:103]
  ds_read_b128 v[120:123], v1 offset:32768
  s_waitcnt lgkmcnt(4)
  v_mfma_f32_16x16x32_bf16 v[96:99], v[124:127], a[208:211], v[96:99]
  buffer_load_dwordx4 v1, s[8:11], s36 offen offset:0 sc1 lds
  buffer_load_dwordx4 v1, s[8:11], s36 offen offset:1024 sc1 lds
  v_mfma_f32_16x16x32_bf16 v[100:103], v[124:127], a[212:215], v[100:103]
  ds_read_b128 v[124:127], v1 offset:13312
  s_waitcnt lgkmcnt(4)
  v_mfma_f32_16x16x32_bf16 v[104:107], v[128:131], v[208:211], v[104:107]
  buffer_load_dwordx4 v1, s[8:11], s36 offen offset:2048 sc1 lds
  buffer_load_dwordx4 v1, s[8:11], s36 offen offset:3072 sc1 lds
  v_mfma_f32_16x16x32_bf16 v[108:111], v[128:131], v[212:215], v[108:111]
  ds_read_b128 v[128:131], v1 offset:34816
  s_waitcnt lgkmcnt(4)
  v_mfma_f32_16x16x32_bf16 v[96:99], v[112:115], a[216:219], v[96:99]
  v_mov_b32 v49, 1.0
  v_cndmask_b32 v168, 0, v164, vcc
  v_mfma_f32_16x16x32_bf16 v[100:103], v[112:115], a[220:223], v[100:103]
  ds_read_b128 v[112:115], v1 offset:36864
  s_waitcnt lgkmcnt(4)
  v_mfma_f32_16x16x32_bf16 v[96:99], v[116:119], a[224:227], v[96:99]
  v_cndmask_b32 v170, v164, 0, vcc
  s_add_u32 s25, s25, 393216
  v_mfma_f32_16x16x32_bf16 v[100:103], v[116:119], a[228:231], v[100:103]
  ds_read_b128 v[116:119], v1 offset:15360
  s_waitcnt lgkmcnt(4)
  v_mfma_f32_16x16x32_bf16 v[96:99], v[120:123], a[232:235], v[96:99]
  v_mfma_f32_16x16x32_bf16 v[100:103], v[120:123], a[236:239], v[100:103]
  ds_read_b128 v[120:123], v1 offset:17408
  s_waitcnt lgkmcnt(4)
  v_mfma_f32_16x16x32_bf16 v[104:107], v[124:127], v[216:219], v[104:107]
  v_mfma_f32_16x16x32_bf16 v[108:111], v[124:127], v[220:223], v[108:111]
  ds_read_b128 v[124:127], v1 offset:19456
  s_waitcnt lgkmcnt(4)
  v_mfma_f32_16x16x32_bf16 v[96:99], v[128:131], a[240:243], v[96:99]
  buffer_load_dwordx4 v[56:59], v32, s[8:11], s80 offen offset:0 sc1
  v_mfma_f32_16x16x32_bf16 v[100:103], v[128:131], a[244:247], v[100:103]
  ds_read_b128 v[128:131], v1 offset:21504
  s_waitcnt lgkmcnt(4)
  v_mfma_f32_16x16x32_bf16 v[96:99], v[112:115], a[248:251], v[96:99]
  buffer_load_dwordx4 v[60:63], v32, s[8:11], s80 offen offset:3072 sc1
  s_add_u32 s80, s80, 6144
  v_mfma_f32_16x16x32_bf16 v[100:103], v[112:115], a[252:255], v[100:103]
  ds_read_b128 v[112:115], v1 offset:23552
  s_waitcnt lgkmcnt(4)
  v_mfma_f32_16x16x32_bf16 v[104:107], v[116:119], v[224:227], v[104:107]
  buffer_load_dwordx4 v[64:67], v32, s[8:11], s80 offen offset:0 sc1
  v_mfma_f32_16x16x32_bf16 v[108:111], v[116:119], v[228:231], v[108:111]
  ds_read_b128 v[116:119], v1 offset:25600
  s_waitcnt lgkmcnt(4)
  v_mfma_f32_16x16x32_bf16 v[104:107], v[120:123], v[232:235], v[104:107]
  buffer_load_dwordx4 v[68:71], v32, s[8:11], s80 offen offset:3072 sc1
  s_add_u32 s80, s80, 6144
  v_mfma_f32_16x16x32_bf16 v[108:111], v[120:123], v[236:239], v[108:111]
  ds_read_b128 v[120:123], v1 offset:27648
  s_waitcnt lgkmcnt(4)
  v_mfma_f32_16x16x32_bf16 v[104:107], v[124:127], v[240:243], v[104:107]
  buffer_load_dwordx4 v[72:75], v32, s[8:11], s80 offen offset:0 sc1
  v_mul_f32 v136, v96, v154
  v_mfma_f32_16x16x32_bf16 v[108:111], v[124:127], v[244:247], v[108:111]
  ds_read_b128 v[124:127], v1 offset:29696
  s_waitcnt lgkmcnt(4)
  v_mfma_f32_16x16x32_bf16 v[104:107], v[128:131], v[248:251], v[104:107]
  buffer_load_dwordx4 v[76:79], v32, s[8:11], s80 offen offset:3072 sc1
  s_add_u32 s80, s80, 6144
  v_mfma_f32_16x16x32_bf16 v[108:111], v[128:131], v[252:255], v[108:111]
  ds_read_b128 v[128:131], v1 offset:31744
  s_waitcnt lgkmcnt(4)
  v_mfma_f32_16x16x32_bf16 v[104:107], v[112:115], a[192:195], v[104:107]
  buffer_load_dwordx4 v[80:83], v32, s[8:11], s80 offen offset:0 sc1
  v_mul_f32 v137, v97, v154
  v_mfma_f32_16x16x32_bf16 v[108:111], v[112:115], a[196:199], v[108:111]
  ds_read_b128 v[112:115], v1 offset:33792
  s_waitcnt lgkmcnt(4)
  v_mfma_f32_16x16x32_bf16 v[104:107], v[116:119], a[200:203], v[104:107]
  buffer_load_dwordx4 v[84:87], v32, s[8:11], s80 offen offset:3072 sc1
  v_mul_f32 v138, v98, v154
  v_mfma_f32_16x16x32_bf16 v[108:111], v[116:119], a[204:207], v[108:111]
  ds_read_b128 v[116:119], v1 offset:35840
  s_waitcnt lgkmcnt(4)
  v_mfma_f32_16x16x32_bf16 v[104:107], v[120:123], a[208:211], v[104:107]
  v_mul_f32 v139, v99, v154
  v_mul_f32 v140, v100, v155
  v_mfma_f32_16x16x32_bf16 v[108:111], v[120:123], a[212:215], v[108:111]
  ds_read_b128 v[120:123], v1 offset:37888
  s_waitcnt lgkmcnt(4)
  v_mfma_f32_16x16x32_bf16 v[104:107], v[124:127], a[216:219], v[104:107]
  v_mul_f32 v141, v101, v155
  v_mul_f32 v142, v102, v155
  v_mfma_f32_16x16x32_bf16 v[108:111], v[124:127], a[220:223], v[108:111]
  s_waitcnt lgkmcnt(3)
  v_mfma_f32_16x16x32_bf16 v[104:107], v[128:131], a[224:227], v[104:107]
  v_mul_f32 v143, v103, v155
  v_mfma_f32_16x16x32_bf16 v[108:111], v[128:131], a[228:231], v[108:111]
  s_waitcnt lgkmcnt(2)
  v_mfma_f32_16x16x32_bf16 v[104:107], v[112:115], a[232:235], v[104:107]
  v_exp_f32 v136, v136 clamp
  v_mfma_f32_16x16x32_bf16 v[108:111], v[112:115], a[236:239], v[108:111]
  s_waitcnt lgkmcnt(1)
  v_mfma_f32_16x16x32_bf16 v[104:107], v[116:119], a[240:243], v[104:107]
  v_exp_f32 v137, v137 clamp
  v_mfma_f32_16x16x32_bf16 v[108:111], v[116:119], a[244:247], v[108:111]
  s_waitcnt lgkmcnt(0)
  v_mfma_f32_16x16x32_bf16 v[104:107], v[120:123], a[248:251], v[104:107]
  v_exp_f32 v138, v138 clamp
  v_mfma_f32_16x16x32_bf16 v[108:111], v[120:123], a[252:255], v[108:111]
  v_exp_f32 v139, v139 clamp
  v_exp_f32 v140, v140 clamp
  v_exp_f32 v141, v141 clamp
  v_exp_f32 v142, v142 clamp
  v_exp_f32 v143, v143 clamp
  v_fma_f32 v96, v96, v152, 1.0
  v_fma_f32 v97, v97, v152, 1.0
  v_fma_f32 v98, v98, v152, 1.0
  v_fma_f32 v99, v99, v152, 1.0
  v_fma_f32 v100, v100, v153, 1.0
  v_fma_f32 v101, v101, v153, 1.0
  v_fma_f32 v102, v102, v153, 1.0
  v_fma_f32 v103, v103, v153, 1.0
  v_max_f32 v96, v96, v136
  v_max_f32 v97, v97, v137
  v_max_f32 v98, v98, v138
  v_max_f32 v99, v99, v139
  v_max_f32 v100, v100, v140
  v_max_f32 v101, v101, v141
  v_max_f32 v102, v102, v142
  v_max_f32 v103, v103, v143
  v_pk_mul_f32 v[112:113], v[104:105], v[154:155] op_sel_hi:[1,0]
  v_pk_mul_f32 v[114:115], v[106:107], v[154:155] op_sel_hi:[1,0]
  v_pk_mul_f32 v[116:117], v[108:109], v[154:155] op_sel:[0,1] op_sel_hi:[1,1]
  v_pk_mul_f32 v[118:119], v[110:111], v[154:155] op_sel:[0,1] op_sel_hi:[1,1]
  v_exp_f32 v112, v112 clamp
  v_exp_f32 v113, v113 clamp
  v_pk_fma_f32 v[104:105], v[104:105], v[152:153], 1.0 op_sel_hi:[1,0,0]
  v_exp_f32 v114, v114 clamp
  s_add_u32 s36, s36, 4096
  s_add_u32 m0, s37, 4096
  v_exp_f32 v115, v115 clamp
  v_pk_fma_f32 v[106:107], v[106:107], v[152:153], 1.0 op_sel_hi:[1,0,0]
  v_exp_f32 v116, v116 clamp
  v_exp_f32 v117, v117 clamp
  v_pk_fma_f32 v[108:109], v[108:109], v[152:153], 1.0 op_sel:[0,1,0] op_sel_hi:[1,1,0]
  v_exp_f32 v118, v118 clamp
  v_exp_f32 v119, v119 clamp
  v_pk_fma_f32 v[110:111], v[110:111], v[152:153], 1.0 op_sel:[0,1,0] op_sel_hi:[1,1,0]
  buffer_load_dwordx4 v1, s[8:11], s36 offen offset:0 sc1 lds
  buffer_load_dwordx4 v1, s[8:11], s36 offen offset:1024 sc1 lds
  s_mov_b32 s86, 0x358637bd
  s_mov_b32 s87, 0x358637bd
  v_max_f32 v104, v104, v112
  v_max_f32 v105, v105, v113
  v_pk_add_f32 v[104:105], v[104:105], s[86:87]
  v_max_f32 v106, v106, v114
  v_max_f32 v107, v107, v115
  v_pk_add_f32 v[106:107], v[106:107], s[86:87]
  buffer_load_dwordx4 v1, s[8:11], s36 offen offset:2048 sc1 lds
  buffer_load_dwordx4 v1, s[8:11], s36 offen offset:3072 sc1 lds
  v_max_f32 v108, v108, v116
  v_max_f32 v109, v109, v117
  v_pk_add_f32 v[108:109], v[108:109], s[86:87]
  v_max_f32 v110, v110, v118
  v_max_f32 v111, v111, v119
  v_pk_add_f32 v[110:111], v[110:111], s[86:87]
  v_pk_add_f32 v[96:97], v[96:97], s[86:87]
  v_pk_add_f32 v[98:99], v[98:99], s[86:87]
  s_add_u32 s36, s36, 4096
  s_add_u32 m0, s37, 8192
  v_pk_add_f32 v[100:101], v[100:101], s[86:87]
  v_pk_add_f32 v[102:103], v[102:103], s[86:87]
  v_cvt_pk_bf16_f32 v156, v96, v97
  v_cvt_pk_bf16_f32 v157, v98, v99
  v_cvt_pk_bf16_f32 v158, v104, v105
  v_cvt_pk_bf16_f32 v159, v106, v107
  v_cvt_pk_bf16_f32 v160, v100, v101
  v_cvt_pk_bf16_f32 v161, v102, v103
  v_cvt_pk_bf16_f32 v162, v108, v109
  v_cvt_pk_bf16_f32 v163, v110, v111
  v_permlane16_swap_b32 v156, v160
  v_permlane16_swap_b32 v157, v161
  v_permlane16_swap_b32 v158, v162
  v_permlane16_swap_b32 v159, v163
Lgat_14:
  s_waitcnt vmcnt(11)
  v_lshlrev_b32 v88, 16, v56
  v_and_b32 v89, 0xffff0000, v56
  v_lshlrev_b32 v90, 16, v57
  v_and_b32 v91, 0xffff0000, v57
  v_lshlrev_b32 v92, 16, v58
  v_and_b32 v93, 0xffff0000, v58
  v_lshlrev_b32 v94, 16, v59
  v_and_b32 v95, 0xffff0000, v59
  s_waitcnt vmcnt(10)
  v_dot2c_f32_bf16 v88, v60, v48
  v_dot2c_f32_bf16 v89, v60, v49
  v_dot2c_f32_bf16 v90, v61, v48
  v_dot2c_f32_bf16 v91, v61, v49
  v_dot2c_f32_bf16 v92, v62, v48
  v_dot2c_f32_bf16 v93, v62, v49
  v_dot2c_f32_bf16 v94, v63, v48
  v_dot2c_f32_bf16 v95, v63, v49
  s_waitcnt vmcnt(9)
  v_dot2c_f32_bf16 v88, v64, v48
  v_dot2c_f32_bf16 v89, v64, v49
  v_dot2c_f32_bf16 v90, v65, v48
  v_dot2c_f32_bf16 v91, v65, v49
  v_dot2c_f32_bf16 v92, v66, v48
  v_dot2c_f32_bf16 v93, v66, v49
  v_dot2c_f32_bf16 v94, v67, v48
  v_dot2c_f32_bf16 v95, v67, v49
  s_waitcnt vmcnt(8)
  v_dot2c_f32_bf16 v88, v68, v48
  v_dot2c_f32_bf16 v89, v68, v49
  v_dot2c_f32_bf16 v90, v69, v48
  v_dot2c_f32_bf16 v91, v69, v49
  v_dot2c_f32_bf16 v92, v70, v48
  v_dot2c_f32_bf16 v93, v70, v49
  v_dot2c_f32_bf16 v94, v71, v48
  v_dot2c_f32_bf16 v95, v71, v49
  s_waitcnt vmcnt(7)
  v_dot2c_f32_bf16 v88, v72, v48
  v_dot2c_f32_bf16 v89, v72, v49
  v_dot2c_f32_bf16 v90, v73, v48
  v_dot2c_f32_bf16 v91, v73, v49
  v_dot2c_f32_bf16 v92, v74, v48
  v_dot2c_f32_bf16 v93, v74, v49
  v_dot2c_f32_bf16 v94, v75, v48
  v_dot2c_f32_bf16 v95, v75, v49
  s_waitcnt vmcnt(6)
  v_dot2c_f32_bf16 v88, v76, v48
  v_dot2c_f32_bf16 v89, v76, v49
  v_dot2c_f32_bf16 v90, v77, v48
  v_dot2c_f32_bf16 v91, v77, v49
  v_dot2c_f32_bf16 v92, v78, v48
  v_dot2c_f32_bf16 v93, v78, v49
  v_dot2c_f32_bf16 v94, v79, v48
  v_dot2c_f32_bf16 v95, v79, v49
  s_waitcnt vmcnt(5)
  v_dot2c_f32_bf16 v88, v80, v48
  v_dot2c_f32_bf16 v89, v80, v49
  v_dot2c_f32_bf16 v90, v81, v48
  v_dot2c_f32_bf16 v91, v81, v49
  v_dot2c_f32_bf16 v92, v82, v48
  v_dot2c_f32_bf16 v93, v82, v49
  v_dot2c_f32_bf16 v94, v83, v48
  v_dot2c_f32_bf16 v95, v83, v49
  s_waitcnt vmcnt(4)
  v_dot2c_f32_bf16 v88, v84, v48
  v_dot2c_f32_bf16 v89, v84, v49
  v_dot2c_f32_bf16 v90, v85, v48
  v_dot2c_f32_bf16 v91, v85, v49
  v_dot2c_f32_bf16 v92, v86, v48
  v_dot2c_f32_bf16 v93, v86, v49
  v_dot2c_f32_bf16 v94, v87, v48
  v_dot2c_f32_bf16 v95, v87, v49
  s_nop 1
  v_permlane32_swap_b32 v88, v92
  v_permlane32_swap_b32 v89, v93
  v_permlane32_swap_b32 v90, v94
  v_permlane32_swap_b32 v91, v95
  v_pk_add_f32 v[88:89], v[88:89], v[92:93]
  v_pk_add_f32 v[90:91], v[90:91], v[94:95]
  v_cmp_u_f32 vcc, v88, v89
  v_cmp_u_f32 s[86:87], v90, v91
  v_cvt_pk_bf16_f32 v88, v88, v89
  v_cvt_pk_bf16_f32 v89, v90, v91
  s_or_b64 vcc, vcc, s[86:87]
  s_cbranch_scc0 Lgatdone_16
  s_cmp_eq_u32 s57, 0
  s_cbranch_scc1 Lgatdone_16
  s_sub_u32 s57, s57, 1
  s_mov_b32 s80, s74
  buffer_load_dwordx4 v[56:59], v32, s[8:11], s80 offen offset:0 sc1
  buffer_load_dwordx4 v[60:63], v32, s[8:11], s80 offen offset:3072 sc1
  s_add_u32 s80, s80, 6144
  buffer_load_dwordx4 v[64:67], v32, s[8:11], s80 offen offset:0 sc1
  buffer_load_dwordx4 v[68:71], v32, s[8:11], s80 offen offset:3072 sc1
  s_add_u32 s80, s80, 6144
  buffer_load_dwordx4 v[72:75], v32, s[8:11], s80 offen offset:0 sc1
  buffer_load_dwordx4 v[76:79], v32, s[8:11], s80 offen offset:3072 sc1
  s_add_u32 s80, s80, 6144
  buffer_load_dwordx4 v[80:83], v32, s[8:11], s80 offen offset:0 sc1
  buffer_load_dwordx4 v[84:87], v32, s[8:11], s80 offen offset:3072 sc1
  s_waitcnt vmcnt(0)
  s_branch Lgat_14
Lgatdone_16:
  ds_write_b64 v33, v[88:89]
  v_mov_b32 v137, 0
  v_mov_b32 v139, 0
  s_add_u32 s74, s74, 393216
  buffer_load_dwordx4 v1, s[8:11], s36 offen offset:0 sc1 lds
  buffer_load_dwordx4 v1, s[8:11], s36 offen offset:1024 sc1 lds
  s_waitcnt lgkmcnt(0)
  s_barrier
  ds_read_b128 v[128:131], v34 offset:0
  ds_read_b32 v136, v35 offset:0
  ds_read_b128 v[132:135], v34 offset:720
  ds_read_b32 v138, v35 offset:720
  s_add_u32 s33, s33, 16384
  buffer_load_dwordx4 a[144:147], v1, s[8:11], s33 offen offset:0 sc1
  buffer_load_dwordx4 a[148:151], v1, s[8:11], s33 offen offset:1024 sc1
  s_waitcnt lgkmcnt(0)
  v_mfma_f32_32x32x16_bf16 v[208:223], v[128:131], v[156:159], 0
  v_mfma_f32_32x32x8_bf16 v[208:223], v[136:137], v[168:169], v[208:223]
  v_mfma_f32_32x32x16_bf16 v[224:239], v[132:135], v[160:163], 0
  v_mfma_f32_32x32x8_bf16 v[224:239], v[138:139], v[170:171], v[224:239]
  s_nop 9
  v_add_f32 v218, 0x358637bd, v218
  v_rcp_f32 v220, v218
  s_nop 0
  v_pk_mul_f32 v[208:209], v[208:209], v[220:221] op_sel_hi:[1,0]
  v_pk_mul_f32 v[210:211], v[210:211], v[220:221] op_sel_hi:[1,0]
  v_pk_mul_f32 v[212:213], v[212:213], v[220:221] op_sel_hi:[1,0]
  v_pk_mul_f32 v[214:215], v[214:215], v[220:221] op_sel_hi:[1,0]
  v_pk_mul_f32 v[216:217], v[216:217], v[220:221] op_sel_hi:[1,0]
  v_cvt_pk_bf16_f32 v240, v208, v209
  v_cvt_pk_bf16_f32 v241, v210, v211
  v_cvt_pk_bf16_f32 v242, v212, v213
  v_cvt_pk_bf16_f32 v243, v214, v215
  s_cmp_lg_u32 s56, 0
  s_cbranch_scc1 Lsafe_18
  buffer_store_dwordx4 v[240:243], v7, s[8:11], s67 offen offset:0
Lback_19:
  v_cvt_pk_bf16_f32 v248, v216, v217
  v_add_f32 v234, 0x358637bd, v234
  v_rcp_f32 v236, v234
  s_nop 0
  v_pk_mul_f32 v[224:225], v[224:225], v[236:237] op_sel_hi:[1,0]
  v_pk_mul_f32 v[226:227], v[226:227], v[236:237] op_sel_hi:[1,0]
  v_pk_mul_f32 v[228:229], v[228:229], v[236:237] op_sel_hi:[1,0]
  v_pk_mul_f32 v[230:231], v[230:231], v[236:237] op_sel_hi:[1,0]
  v_pk_mul_f32 v[232:233], v[232:233], v[236:237] op_sel_hi:[1,0]
  v_cvt_pk_bf16_f32 v244, v224, v225
  v_cvt_pk_bf16_f32 v245, v226, v227
  v_cvt_pk_bf16_f32 v246, v228, v229
  v_cvt_pk_bf16_f32 v247, v230, v231
  v_cvt_pk_bf16_f32 v249, v232, v233
  s_cmp_lg_u32 s56, 0
  s_cbranch_scc1 Lsafe_20
  buffer_store_dwordx4 v[244:247], v7, s[8:11], s67 offen offset:512
  buffer_store_dwordx2 v[248:249], v8, s[8:11], s68 offen
Lback_21:
  buffer_load_dwordx4 a[152:155], v1, s[8:11], s33 offen offset:2048 sc1
  buffer_load_dwordx4 a[156:159], v1, s[8:11], s33 offen offset:3072 sc1
  v_lshlrev_b32 v56, 16, v22
  v_and_b32 v57, 0xffff0000, v22
  v_lshlrev_b32 v58, 16, v23
  v_and_b32 v59, 0xffff0000, v23
  v_lshlrev_b32 v60, 16, v24
  v_and_b32 v61, 0xffff0000, v24
  v_lshlrev_b32 v62, 16, v25
  v_and_b32 v63, 0xffff0000, v25
  v_lshlrev_b32 v64, 16, v26
  v_and_b32 v65, 0xffff0000, v26
  v_lshlrev_b32 v66, 16, v27
  v_and_b32 v67, 0xffff0000, v27
  v_lshlrev_b32 v68, 16, v28
  v_and_b32 v69, 0xffff0000, v28
  v_lshlrev_b32 v70, 16, v29
  v_and_b32 v71, 0xffff0000, v29
  v_lshlrev_b32 v72, 16, v30
  v_and_b32 v73, 0xffff0000, v30
  v_lshlrev_b32 v74, 16, v31
  v_and_b32 v75, 0xffff0000, v31
  s_waitcnt vmcnt(7)
  s_barrier
  s_waitcnt vmcnt(51)
  ds_write_b128 v38, a[96:99] offset:0
  s_waitcnt vmcnt(50)
  ds_write_b128 v38, a[100:103] offset:1024
  s_waitcnt vmcnt(49)
  ds_write_b128 v38, a[104:107] offset:2048
  s_waitcnt vmcnt(48)
  ds_write_b128 v38, a[108:111] offset:3072
  s_mov_b64 exec, 3
  s_waitcnt vmcnt(2)
  s_cmp_lg_u32 s56, 0
  s_cbranch_scc1 Lsafe_22
  buffer_store_dword v17, v12, s[8:11], s69 offen
Lback_23:
  s_mov_b64 exec, -1
  ds_read_b128 v[76:79], v2 offset:0
  ds_read_b128 v[80:83], v2 offset:1024
  ds_read_b128 v[84:87], v2 offset:2048
  ds_read_b128 v[88:91], v2 offset:3072
  ds_read_b128 v[92:95], v2 offset:4096
  ds_read_b128 v[96:99], v2 offset:5120
  ds_read_b128 v[100:103], v2 offset:6144
  ds_read_b128 v[104:107], v2 offset:7168
  ds_read_b128 v[108:111], v2 offset:8192
  ds_read_b128 v[112:115], v2 offset:9216
  s_waitcnt vmcnt(48)
  ds_write_b128 v38, a[112:115] offset:16384
  s_waitcnt vmcnt(47)
  ds_write_b128 v38, a[116:119] offset:17408
  buffer_load_dword v165, v39, s[8:11], s71 offen sc1
  s_waitcnt vmcnt(46)
  ds_write_b128 v38, a[120:123] offset:18432
  s_waitcnt vmcnt(45)
  ds_write_b128 v38, a[124:127] offset:19456
  s_lshl_b32 s80, s54, 3
  v_subrev_u32 v48, s80, v45
  v_mov_b32 v49, 0xff800000
  s_lshl_b32 s80, s54, 10
  v_cmp_le_i32 s[86:87], 0, v48
  v_cmp_le_i32 s[88:89], 1, v48
  v_cmp_le_i32 s[90:91], 2, v48
  v_cmp_le_i32 s[92:93], 3, v48
  v_add_u32 v48, s80, v18
  v_cndmask_b32 v52, v49, 0, s[86:87]
  v_cndmask_b32 v53, v49, 0, s[88:89]
  v_cndmask_b32 v54, v49, 0, s[90:91]
  v_cndmask_b32 v55, v49, 0, s[92:93]
  ds_write_b128 v48, v[52:55] offset:28672
  s_mul_i32 s34, s54, 10240
  s_min_u32 s34, s34, 28672
  s_add_u32 s35, s34, 97280
  s_add_u32 s34, s34, s38
  s_add_u32 s34, s34, 2276352
  s_mov_b32 s32, s70
Lpoll_24:
  s_waitcnt vmcnt(0)
  v_cmp_ne_u32 vcc, s55, v165
  s_nop 0
  s_cmp_lg_u64 vcc, 0
  s_cbranch_scc0 Lpdone_26
  s_cmp_eq_u32 s57, 0
  s_cbranch_scc1 Lpdone_26
  s_sub_u32 s57, s57, 1
  buffer_load_dword v165, v39, s[8:11], s71 offen sc1
  s_branch Lpoll_24
Lpdone_26:
  buffer_load_dwordx4 v[176:179], v1, s[8:11], s32 offen offset:0 sc1
  buffer_load_dwordx4 v[180:183], v1, s[8:11], s32 offen offset:1024 sc1
  s_waitcnt vmcnt(47)
  ds_write_b128 v38, a[128:131] offset:32768
  buffer_load_dwordx4 v[184:187], v1, s[8:11], s32 offen offset:2048 sc1
  s_waitcnt vmcnt(47)
  ds_write_b128 v38, a[132:135] offset:33792
  buffer_load_dwordx4 v[188:191], v1, s[8:11], s32 offen offset:3072 sc1
  s_waitcnt vmcnt(47)
  ds_write_b128 v38, a[136:139] offset:34816
  s_add_u32 s32, s32, 4096
  buffer_load_dwordx4 v[192:195], v1, s[8:11], s32 offen offset:0 sc1
  s_waitcnt vmcnt(47)
  ds_write_b128 v38, a[140:143] offset:35840
  buffer_load_dwordx4 v[196:199], v1, s[8:11], s32 offen offset:1024 sc1
  s_waitcnt vmcnt(5) lgkmcnt(5)
  v_mfma_f32_16x16x32_bf16 v[56:59], v[76:79], v[176:179], v[56:59]
  ds_read_b128 v[116:119], v2 offset:10240
  buffer_load_dwordx4 v[200:203], v1, s[8:11], s32 offen offset:2048 sc1
  v_mfma_f32_16x16x32_bf16 v[60:63], v[80:83], v[176:179], v[60:63]
  ds_read_b128 v[120:123], v2 offset:11264
  buffer_load_dwordx4 v[204:207], v1, s[8:11], s32 offen offset:3072 sc1
  v_mfma_f32_16x16x32_bf16 v[64:67], v[84:87], v[176:179], v[64:67]
  ds_read_b128 v[124:127], v2 offset:12288
  s_add_u32 s32, s32, 4096
  v_mfma_f32_16x16x32_bf16 v[68:71], v[88:91], v[176:179], v[68:71]
  ds_read_b128 v[128:131], v2 offset:13312
  v_mfma_f32_16x16x32_bf16 v[72:75], v[92:95], v[176:179], v[72:75]
  ds_read_b128 v[132:135], v2 offset:14336
  s_waitcnt vmcnt(6) lgkmcnt(5)
  v_mfma_f32_16x16x32_bf16 v[56:59], v[96:99], v[180:183], v[56:59]
  ds_read_b128 v[76:79], v2 offset:15360
  buffer_load_dwordx4 v[208:211], v1, s[8:11], s32 offen offset:0 sc1
  v_mfma_f32_16x16x32_bf16 v[60:63], v[100:103], v[180:183], v[60:63]
  ds_read_b128 v[80:83], v2 offset:16384
  buffer_load_dwordx4 v[212:215], v1, s[8:11], s32 offen offset:1024 sc1
  v_mfma_f32_16x16x32_bf16 v[64:67], v[104:107], v[180:183], v[64:67]
  ds_read_b128 v[84:87], v2 offset:17408
  v_mfma_f32_16x16x32_bf16 v[68:71], v[108:111], v[180:183], v[68:71]
  ds_read_b128 v[88:91], v2 offset:18432
  v_mfma_f32_16x16x32_bf16 v[72:75], v[112:115], v[180:183], v[72:75]
  ds_read_b128 v[92:95], v2 offset:19456
  s_waitcnt vmcnt(7) lgkmcnt(5)
  v_mfma_f32_16x16x32_bf16 v[56:59], v[116:119], v[184:187], v[56:59]
  ds_read_b128 v[96:99], v2 offset:20480
  buffer_load_dwordx4 v[216:219], v1, s[8:11], s32 offen offset:2048 sc1
  v_mfma_f32_16x16x32_bf16 v[60:63], v[120:123], v[184:187], v[60:63]
  ds_read_b128 v[100:103], v2 offset:21504
  v_mfma_f32_16x16x32_bf16 v[64:67], v[124:127], v[184:187], v[64:67]
  ds_read_b128 v[104:107], v2 offset:22528
  v_mfma_f32_16x16x32_bf16 v[68:71], v[128:131], v[184:187], v[68:71]
  ds_read_b128 v[108:111], v2 offset:23552
  v_mfma_f32_16x16x32_bf16 v[72:75], v[132:135], v[184:187], v[72:75]
  ds_read_b128 v[112:115], v2 offset:24576
  s_waitcnt vmcnt(7) lgkmcnt(5)
  v_mfma_f32_16x16x32_bf16 v[56:59], v[76:79], v[188:191], v[56:59]
  ds_read_b128 v[116:119], v2 offset:25600
  buffer_load_dwordx4 v[220:223], v1, s[8:11], s32 offen offset:3072 sc1
  v_mfma_f32_16x16x32_bf16 v[60:63], v[80:83], v[188:191], v[60:63]
  ds_read_b128 v[120:123], v2 offset:26624
  s_add_u32 s32, s32, 4096
  v_mfma_f32_16x16x32_bf16 v[64:67], v[84:87], v[188:191], v[64:67]
  ds_read_b128 v[124:127], v2 offset:27648
  buffer_load_dwordx4 v[224:227], v1, s[8:11], s32 offen offset:0 sc1
  v_mfma_f32_16x16x32_bf16 v[68:71], v[88:91], v[188:191], v[68:71]
  ds_read_b128 v[128:131], v2 offset:28672
  v_mfma_f32_16x16x32_bf16 v[72:75], v[92:95], v[188:191], v[72:75]
  ds_read_b128 v[132:135], v2 offset:29696
  s_waitcnt vmcnt(8) lgkmcnt(5)
  v_mfma_f32_16x16x32_bf16 v[56:59], v[96:99], v[192:195], v[56:59]
  ds_read_b128 v[76:79], v2 offset:30720
  buffer_load_dwordx4 v[228:231], v1, s[8:11], s32 offen offset:1024 sc1
  v_mfma_f32_16x16x32_bf16 v[60:63], v[100:103], v[192:195], v[60:63]
  ds_read_b128 v[80:83], v2 offset:31744
  v_mfma_f32_16x16x32_bf16 v[64:67], v[104:107], v[192:195], v[64:67]
  ds_read_b128 v[84:87], v2 offset:32768
  v_mfma_f32_16x16x32_bf16 v[68:71], v[108:111], v[192:195], v[68:71]
  ds_read_b128 v[88:91], v2 offset:33792
  v_mfma_f32_16x16x32_bf16 v[72:75], v[112:115], v[192:195], v[72:75]
  ds_read_b128 v[92:95], v2 offset:34816
  s_waitcnt vmcnt(8) lgkmcnt(5)
  v_mfma_f32_16x16x32_bf16 v[56:59], v[116:119], v[196:199], v[56:59]
  ds_read_b128 v[96:99], v2 offset:35840
  buffer_load_dwordx4 v[232:235], v1, s[8:11], s32 offen offset:2048 sc1
  v_mfma_f32_16x16x32_bf16 v[60:63], v[120:123], v[196:199], v[60:63]
  ds_read_b128 v[100:103], v2 offset:36864
  buffer_load_dwordx4 v[236:239], v1, s[8:11], s32 offen offset:3072 sc1
  v_mfma_f32_16x16x32_bf16 v[64:67], v[124:127], v[196:199], v[64:67]
  ds_read_b128 v[104:107], v2 offset:37888
  s_add_u32 s32, s32, 4096
  v_mfma_f32_16x16x32_bf16 v[68:71], v[128:131], v[196:199], v[68:71]
  ds_read_b128 v[108:111], v2 offset:38912
  v_mfma_f32_16x16x32_bf16 v[72:75], v[132:135], v[196:199], v[72:75]
  ds_read_b128 v[112:115], v2 offset:39936
  s_waitcnt vmcnt(9) lgkmcnt(5)
  v_mfma_f32_16x16x32_bf16 v[56:59], v[76:79], v[200:203], v[56:59]
  ds_read_b128 v[116:119], v2 offset:40960
  buffer_load_dwordx4 v[240:243], v1, s[8:11], s32 offen offset:0 sc1
  v_mfma_f32_16x16x32_bf16 v[60:63], v[80:83], v[200:203], v[60:63]
  ds_read_b128 v[120:123], v2 offset:41984
  v_mfma_f32_16x16x32_bf16 v[64:67], v[84:87], v[200:203], v[64:67]
  ds_read_b128 v[124:127], v2 offset:43008
  v_mfma_f32_16x16x32_bf16 v[68:71], v[88:91], v[200:203], v[68:71]
  ds_read_b128 v[128:131], v2 offset:44032
  v_mfma_f32_16x16x32_bf16 v[72:75], v[92:95], v[200:203], v[72:75]
  ds_read_b128 v[132:135], v2 offset:45056
  s_waitcnt vmcnt(9) lgkmcnt(5)
  v_mfma_f32_16x16x32_bf16 v[56:59], v[96:99], v[204:207], v[56:59]
  ds_read_b128 v[76:79], v2 offset:46080
  buffer_load_dwordx4 v[244:247], v1, s[8:11], s32 offen offset:1024 sc1
  v_mfma_f32_16x16x32_bf16 v[60:63], v[100:103], v[204:207], v[60:63]
  ds_read_b128 v[80:83], v2 offset:47104
  v_mfma_f32_16x16x32_bf16 v[64:67], v[104:107], v[204:207], v[64:67]
  ds_read_b128 v[84:87], v2 offset:48128
  v_mfma_f32_16x16x32_bf16 v[68:71], v[108:111], v[204:207], v[68:71]
  ds_read_b128 v[88:91], v2 offset:49152
  v_mfma_f32_16x16x32_bf16 v[72:75], v[112:115], v[204:207], v[72:75]
  ds_read_b128 v[92:95], v2 offset:50176
  s_waitcnt vmcnt(9) lgkmcnt(5)
  v_mfma_f32_16x16x32_bf16 v[56:59], v[116:119], v[208:211], v[56:59]
  ds_read_b128 v[96:99], v2 offset:51200
  s_add_u32 s33, s33, 16384
  v_mfma_f32_16x16x32_bf16 v[60:63], v[120:123], v[208:211], v[60:63]
  ds_read_b128 v[100:103], v2 offset:52224
  v_mfma_f32_16x16x32_bf16 v[64:67], v[124:127], v[208:211], v[64:67]
  ds_read_b128 v[104:107], v2 offset:53248
  v_mfma_f32_16x16x32_bf16 v[68:71], v[128:131], v[208:211], v[68:71]
  ds_read_b128 v[108:111], v2 offset:54272
  v_mfma_f32_16x16x32_bf16 v[72:75], v[132:135], v[208:211], v[72:75]
  ds_read_b128 v[112:115], v2 offset:55296
  s_waitcnt vmcnt(8) lgkmcnt(5)
  v_mfma_f32_16x16x32_bf16 v[56:59], v[76:79], v[212:215], v[56:59]
  ds_read_b128 v[116:119], v2 offset:56320
  v_mfma_f32_16x16x32_bf16 v[60:63], v[80:83], v[212:215], v[60:63]
  ds_read_b128 v[120:123], v2 offset:57344
  v_mfma_f32_16x16x32_bf16 v[64:67], v[84:87], v[212:215], v[64:67]
  ds_read_b128 v[124:127], v2 offset:58368
  v_mfma_f32_16x16x32_bf16 v[68:71], v[88:91], v[212:215], v[68:71]
  ds_read_b128 v[128:131], v2 offset:59392
  v_mfma_f32_16x16x32_bf16 v[72:75], v[92:95], v[212:215], v[72:75]
  ds_read_b128 v[132:135], v2 offset:60416
  s_waitcnt vmcnt(7) lgkmcnt(5)
  v_mfma_f32_16x16x32_bf16 v[56:59], v[96:99], v[216:219], v[56:59]
  ds_read_b128 v[76:79], v2 offset:61440
  buffer_load_dwordx4 a[160:163], v1, s[8:11], s33 offen offset:0 sc1
  v_mfma_f32_16x16x32_bf16 v[60:63], v[100:103], v[216:219], v[60:63]
  ds_read_b128 v[80:83], v2 offset:62464
  buffer_load_dwordx4 a[164:167], v1, s[8:11], s33 offen offset:1024 sc1
  v_mfma_f32_16x16x32_bf16 v[64:67], v[104:107], v[216:219], v[64:67]
  ds_read_b128 v[84:87], v2 offset:63488
  v_mfma_f32_16x16x32_bf16 v[68:71], v[108:111], v[216:219], v[68:71]
  ds_read_b128 v[88:91], v2 offset:64512
  v_mfma_f32_16x16x32_bf16 v[72:75], v[112:115], v[216:219], v[72:75]
  ds_read_b128 v[92:95], v18 offset:0
  s_waitcnt vmcnt(8) lgkmcnt(5)
  v_mfma_f32_16x16x32_bf16 v[56:59], v[116:119], v[220:223], v[56:59]
  ds_read_b128 v[96:99], v18 offset:1024
  buffer_load_dwordx4 a[168:171], v1, s[8:11], s33 offen offset:2048 sc1
  v_mfma_f32_16x16x32_bf16 v[60:63], v[120:123], v[220:223], v[60:63]
  ds_read_b128 v[100:103], v18 offset:2048
  buffer_load_dwordx4 a[172:175], v1, s[8:11], s33 offen offset:3072 sc1
  v_mfma_f32_16x16x32_bf16 v[64:67], v[124:127], v[220:223], v[64:67]
  ds_read_b128 v[104:107], v18 offset:3072
  buffer_load_dword v165, v47, s[28:31], 0 offen sc1
  v_mfma_f32_16x16x32_bf16 v[68:71], v[128:131], v[220:223], v[68:71]
  ds_read_b128 v[108:111], v18 offset:4096
  v_mfma_f32_16x16x32_bf16 v[72:75], v[132:135], v[220:223], v[72:75]
  ds_read_b128 v[112:115], v18 offset:5120
  s_waitcnt vmcnt(10) lgkmcnt(5)
  v_mfma_f32_16x16x32_bf16 v[56:59], v[76:79], v[224:227], v[56:59]
  ds_read_b128 v[116:119], v18 offset:6144
  v_mfma_f32_16x16x32_bf16 v[60:63], v[80:83], v[224:227], v[60:63]
  ds_read_b128 v[120:123], v18 offset:7168
  v_mfma_f32_16x16x32_bf16 v[64:67], v[84:87], v[224:227], v[64:67]
  ds_read_b128 v[124:127], v18 offset:8192
  v_mfma_f32_16x16x32_bf16 v[68:71], v[88:91], v[224:227], v[68:71]
  ds_read_b128 v[128:131], v18 offset:9216
  v_mfma_f32_16x16x32_bf16 v[72:75], v[92:95], v[224:227], v[72:75]
  ds_read_b128 v[132:135], v18 offset:10240
  s_waitcnt vmcnt(9) lgkmcnt(5)
  v_mfma_f32_16x16x32_bf16 v[56:59], v[96:99], v[228:231], v[56:59]
  ds_read_b128 v[76:79], v18 offset:11264
  v_mfma_f32_16x16x32_bf16 v[60:63], v[100:103], v[228:231], v[60:63]
  ds_read_b128 v[80:83], v18 offset:12288
  v_mfma_f32_16x16x32_bf16 v[64:67], v[104:107], v[228:231], v[64:67]
  ds_read_b128 v[84:87], v18 offset:13312
  v_mfma_f32_16x16x32_bf16 v[68:71], v[108:111], v[228:231], v[68:71]
  ds_read_b128 v[88:91], v18 offset:14336
  v_mfma_f32_16x16x32_bf16 v[72:75], v[112:115], v[228:231], v[72:75]
  ds_read_b128 v[92:95], v18 offset:15360
  s_waitcnt vmcnt(8) lgkmcnt(5)
  v_mfma_f32_16x16x32_bf16 v[56:59], v[116:119], v[232:235], v[56:59]
  ds_read_b128 v[96:99], v18 offset:16384
  v_mfma_f32_16x16x32_bf16 v[60:63], v[120:123], v[232:235], v[60:63]
  ds_read_b128 v[100:103], v18 offset:17408
  v_mfma_f32_16x16x32_bf16 v[64:67], v[124:127], v[232:235], v[64:67]
  ds_read_b128 v[104:107], v18 offset:18432
  v_mfma_f32_16x16x32_bf16 v[68:71], v[128:131], v[232:235], v[68:71]
  ds_read_b128 v[108:111], v18 offset:19456
  v_mfma_f32_16x16x32_bf16 v[72:75], v[132:135], v[232:235], v[72:75]
  ds_read_b128 v[112:115], v18 offset:20480
  s_waitcnt vmcnt(7) lgkmcnt(5)
  v_mfma_f32_16x16x32_bf16 v[56:59], v[76:79], v[236:239], v[56:59]
  ds_read_b128 v[116:119], v18 offset:21504
  v_mfma_f32_16x16x32_bf16 v[60:63], v[80:83], v[236:239], v[60:63]
  ds_read_b128 v[120:123], v18 offset:22528
  v_mfma_f32_16x16x32_bf16 v[64:67], v[84:87], v[236:239], v[64:67]
  ds_read_b128 v[124:127], v18 offset:23552
  v_mfma_f32_16x16x32_bf16 v[68:71], v[88:91], v[236:239], v[68:71]
  ds_read_b128 v[128:131], v18 offset:24576
  v_mfma_f32_16x16x32_bf16 v[72:75], v[92:95], v[236:239], v[72:75]
  ds_read_b128 v[132:135], v18 offset:25600
  s_waitcnt vmcnt(6) lgkmcnt(5)
  v_mfma_f32_16x16x32_bf16 v[56:59], v[96:99], v[240:243], v[56:59]
  v_mfma_f32_16x16x32_bf16 v[60:63], v[100:103], v[240:243], v[60:63]
  v_mfma_f32_16x16x32_bf16 v[64:67], v[104:107], v[240:243], v[64:67]
  v_mfma_f32_16x16x32_bf16 v[68:71], v[108:111], v[240:243], v[68:71]
  v_mfma_f32_16x16x32_bf16 v[72:75], v[112:115], v[240:243], v[72:75]
  s_waitcnt vmcnt(5) lgkmcnt(0)
  v_mfma_f32_16x16x32_bf16 v[56:59], v[116:119], v[244:247], v[56:59]
  v_mfma_f32_16x16x32_bf16 v[60:63], v[120:123], v[244:247], v[60:63]
  v_mfma_f32_16x16x32_bf16 v[64:67], v[124:127], v[244:247], v[64:67]
  v_mfma_f32_16x16x32_bf16 v[68:71], v[128:131], v[244:247], v[68:71]
  v_mfma_f32_16x16x32_bf16 v[72:75], v[132:135], v[244:247], v[72:75]
  s_add_u32 s55, s55, 1
  v_mov_b32 v17, s55
  s_nop 1
  v_cvt_pk_bf16_f32 v22, v56, v57
  v_cvt_pk_bf16_f32 v23, v58, v59
  v_cvt_pk_bf16_f32 v24, v60, v61
  v_cvt_pk_bf16_f32 v25, v62, v63
  v_cvt_pk_bf16_f32 v26, v64, v65
  v_cvt_pk_bf16_f32 v27, v66, v67
  v_cvt_pk_bf16_f32 v28, v68, v69
  v_cvt_pk_bf16_f32 v29, v70, v71
  v_cvt_pk_bf16_f32 v30, v72, v73
  v_cvt_pk_bf16_f32 v31, v74, v75
  s_cmp_lg_u32 s56, 0
  s_cbranch_scc1 Lsafe_28
  buffer_store_dwordx4 v[22:25], v1, s[28:31], s64 offen
  buffer_store_dwordx4 v[26:29], v1, s[28:31], s64 offen offset:2048
  buffer_store_dwordx2 v[30:31], v5, s[28:31], s65 offen
Lback_29:
  s_add_u32 s33, s33, 16384
  buffer_load_dwordx4 a[176:179], v1, s[8:11], s33 offen offset:0 sc1
  buffer_load_dwordx4 a[180:183], v1, s[8:11], s33 offen offset:1024 sc1
  buffer_load_dwordx4 a[184:187], v1, s[8:11], s33 offen offset:2048 sc1
  buffer_load_dwordx4 a[188:191], v1, s[8:11], s33 offen offset:3072 sc1
  v_mov_b32 v52, 0
  v_mov_b32 v53, 0
  v_mov_b32 v54, 0x3f803f80
  v_dot2c_f32_bf16 v52, v22, v54
  v_dot2c_f32_bf16 v53, v22, v22
  v_dot2c_f32_bf16 v52, v23, v54
  v_dot2c_f32_bf16 v53, v23, v23
  v_dot2c_f32_bf16 v52, v24, v54
  v_dot2c_f32_bf16 v53, v24, v24
  v_dot2c_f32_bf16 v52, v25, v54
  v_dot2c_f32_bf16 v53, v25, v25
  v_dot2c_f32_bf16 v52, v26, v54
  v_dot2c_f32_bf16 v53, v26, v26
  v_dot2c_f32_bf16 v52, v27, v54
  v_dot2c_f32_bf16 v53, v27, v27
  v_dot2c_f32_bf16 v52, v28, v54
  v_dot2c_f32_bf16 v53, v28, v28
  v_dot2c_f32_bf16 v52, v29, v54
  v_dot2c_f32_bf16 v53, v29, v29
  v_dot2c_f32_bf16 v52, v30, v54
  v_dot2c_f32_bf16 v53, v30, v30
  v_dot2c_f32_bf16 v52, v31, v54
  v_dot2c_f32_bf16 v53, v31, v31
  s_nop 2
  v_mov_b32 v54, v52
  v_mov_b32 v55, v53
  s_nop 0
  v_permlane32_swap_b32 v54, v52
  v_permlane32_swap_b32 v55, v53
  v_add_f32 v52, v52, v54
  v_add_f32 v53, v53, v55
  v_mov_b32 v54, v52
  v_mov_b32 v55, v53
  s_nop 0
  v_permlane16_swap_b32 v54, v52
  v_permlane16_swap_b32 v55, v53
  v_add_f32 v52, v52, v54
  v_add_f32 v53, v53, v55
  v_mov_b32 v54, s55
  s_waitcnt vmcnt(4)
  s_cmp_lg_u32 s56, 0
  s_cbranch_scc1 Lsafe_30
  buffer_store_dwordx4 v[52:55], v6, s[8:11], s66 offen
Lback_31:
  s_barrier
  ds_read2st64_b32 v[112:113], v44 offset0:0 offset1:1
  ds_read2st64_b32 v[114:115], v44 offset0:2 offset1:3
  ds_read2st64_b32 v[116:117], v44 offset0:4 offset1:5
  ds_read2st64_b32 v[118:119], v44 offset0:6 offset1:7
  ds_read2st64_b32 v[120:121], v44 offset0:8 offset1:9
  ds_read2st64_b32 v[122:123], v44 offset0:10 offset1:11
  ds_read2st64_b32 v[124:125], v44 offset0:12 offset1:13
  ds_read2st64_b32 v[126:127], v44 offset0:14 offset1:15
  ds_read2st64_b32 v[128:129], v44 offset0:16 offset1:17
  ds_read2st64_b32 v[130:131], v44 offset0:18 offset1:19
  s_waitcnt vmcnt(39)
  ds_write_b128 v38, a[144:147] offset:49152
  buffer_load_dwordx4 v[96:99], v4, s[8:11], s63 offen offset:0 sc1
  buffer_load_dwordx4 v[100:103], v4, s[8:11], s63 offen offset:2048 sc1
  buffer_load_dwordx4 v[104:107], v4, s[8:11], s63 offen offset:256 sc1
  buffer_load_dwordx4 v[108:111], v4, s[8:11], s63 offen offset:2304 sc1
  s_waitcnt vmcnt(38)
  ds_write_b128 v38, a[148:151] offset:50176
  s_waitcnt vmcnt(34)
  ds_write_b128 v38, a[152:155] offset:51200
  s_waitcnt vmcnt(33)
  ds_write_b128 v38, a[156:159] offset:52224
  s_waitcnt vmcnt(12)
  ds_write_b128 v42, a[160:163] offset:0
  s_waitcnt vmcnt(11)
  ds_write_b128 v42, a[164:167] offset:1024
  s_waitcnt vmcnt(10)
  ds_write_b128 v42, a[168:171] offset:2048
  s_waitcnt vmcnt(9)
  ds_write_b128 v42, a[172:175] offset:3072
  s_mov_b32 s32, s62
Lpoll_32:
  s_waitcnt vmcnt(0)
  v_cmp_ne_u32 s[86:87], s55, v98
  v_cmp_ne_u32 s[88:89], s55, v102
  v_cmp_ne_u32 s[90:91], s55, v106
  v_cmp_ne_u32 s[92:93], s55, v110
  s_or_b64 s[86:87], s[86:87], s[88:89]
  s_or_b64 s[90:91], s[90:91], s[92:93]
  s_or_b64 s[86:87], s[86:87], s[90:91]
  s_cbranch_scc0 Lpdone_34
  s_cmp_eq_u32 s57, 0
  s_cbranch_scc1 Lpdone_34
  s_sub_u32 s57, s57, 1
  buffer_load_dwordx4 v[96:99], v4, s[8:11], s63 offen offset:0 sc1
  buffer_load_dwordx4 v[100:103], v4, s[8:11], s63 offen offset:2048 sc1
  buffer_load_dwordx4 v[104:107], v4, s[8:11], s63 offen offset:256 sc1
  buffer_load_dwordx4 v[108:111], v4, s[8:11], s63 offen offset:2304 sc1
  s_branch Lpoll_32
Lpdone_34:
  buffer_load_dwordx4 v[176:179], v1, s[28:31], s32 offen offset:0 sc1
  v_add_f32 v96, v96, v100
  v_add_f32 v97, v97, v101
  v_add_f32 v104, v104, v108
  v_add_f32 v105, v105, v109
  v_mov_b32 v98, v96
  v_mov_b32 v99, v104
  s_nop 0
  v_permlane32_swap_b32 v98, v96
  v_permlane32_swap_b32 v99, v104
  v_add_f32 v96, v96, v98
  buffer_load_dwordx4 v[180:183], v1, s[28:31], s32 offen offset:1024 sc1
  v_add_f32 v104, v104, v99
  v_mov_b32 v98, v96
  v_mov_b32 v99, v104
  s_nop 0
  v_permlane16_swap_b32 v98, v96
  v_permlane16_swap_b32 v99, v104
  v_add_f32 v96, v96, v98
  v_add_f32 v104, v104, v99
  v_mul_f32 v96, 0xbae38e39, v96
  v_mul_f32 v104, 0xbae38e39, v104
  buffer_load_dwordx4 v[184:187], v1, s[28:31], s32 offen offset:2048 sc1
  v_cvt_pk_bf16_f32 v156, v96, v96
  v_cvt_pk_bf16_f32 v160, v104, v104
  v_cndmask_b32 v157, 0, v156, s[46:47]
  v_cndmask_b32 v158, 0, v156, s[46:47]
  v_cndmask_b32 v159, 0, v156, s[46:47]
  v_cndmask_b32 v156, 0, v156, s[46:47]
  v_cndmask_b32 v161, 0, v160, s[46:47]
  v_cndmask_b32 v162, 0, v160, s[46:47]
  v_cndmask_b32 v163, 0, v160, s[46:47]
  v_cndmask_b32 v160, 0, v160, s[46:47]
  buffer_load_dwordx4 v[188:191], v1, s[28:31], s32 offen offset:3072 sc1
  ds_read_b128 v[132:135], v1 offset:5120
  s_waitcnt lgkmcnt(15)
  v_mfma_f32_16x16x32_bf16 v[56:59], v[112:115], v[156:159], 0
  s_add_u32 s32, s32, 4096
  v_mfma_f32_16x16x32_bf16 v[60:63], v[112:115], v[160:163], 0
  ds_read_b128 v[112:115], v1 offset:6144
  s_waitcnt lgkmcnt(15)
  v_mfma_f32_16x16x32_bf16 v[64:67], v[116:119], v[156:159], 0
  buffer_load_dwordx4 v[192:195], v1, s[28:31], s32 offen offset:0 sc1
  v_mfma_f32_16x16x32_bf16 v[68:71], v[116:119], v[160:163], 0
  ds_read_b128 v[116:119], v1 offset:7168
  s_waitcnt lgkmcnt(15)
  v_mfma_f32_16x16x32_bf16 v[72:75], v[120:123], v[156:159], 0
  buffer_load_dwordx4 v[196:199], v1, s[28:31], s32 offen offset:1024 sc1
  v_mfma_f32_16x16x32_bf16 v[76:79], v[120:123], v[160:163], 0
  ds_read_b128 v[120:123], v1 offset:8192
  s_waitcnt lgkmcnt(14)
  v_mfma_f32_16x16x32_bf16 v[80:83], v[124:127], v[156:159], 0
  v_mfma_f32_16x16x32_bf16 v[84:87], v[124:127], v[160:163], 0
  ds_read_b128 v[124:127], v1 offset:9216
  s_waitcnt lgkmcnt(13)
  v_mfma_f32_16x16x32_bf16 v[88:91], v[128:131], v[156:159], 0
  buffer_load_dwordx4 v[200:203], v1, s[28:31], s32 offen offset:2048 sc1
  v_mfma_f32_16x16x32_bf16 v[92:95], v[128:131], v[160:163], 0
  ds_read_b128 v[128:131], v1 offset:10240
  s_waitcnt vmcnt(5) lgkmcnt(5)
  v_mfma_f32_16x16x32_bf16 v[56:59], v[132:135], v[176:179], v[56:59]
  v_mfma_f32_16x16x32_bf16 v[60:63], v[132:135], v[180:183], v[60:63]
  ds_read_b128 v[132:135], v1 offset:11264
  s_waitcnt lgkmcnt(5)
  v_mfma_f32_16x16x32_bf16 v[64:67], v[112:115], v[176:179], v[64:67]
  buffer_load_dwordx4 v[204:207], v1, s[28:31], s32 offen offset:3072 sc1
  s_add_u32 s32, s32, 4096
  v_mfma_f32_16x16x32_bf16 v[68:71], v[112:115], v[180:183], v[68:71]
  ds_read_b128 v[112:115], v1 offset:12288
  s_waitcnt lgkmcnt(5)
  v_mfma_f32_16x16x32_bf16 v[72:75], v[116:119], v[176:179], v[72:75]
  buffer_load_dwordx4 v[208:211], v1, s[28:31], s32 offen offset:0 sc1
  v_mfma_f32_16x16x32_bf16 v[76:79], v[116:119], v[180:183], v[76:79]
  ds_read_b128 v[116:119], v1 offset:13312
  s_waitcnt lgkmcnt(5)
  v_mfma_f32_16x16x32_bf16 v[80:83], v[120:123], v[176:179], v[80:83]
  ds_write_b128 v42, a[176:179] offset:16384
  v_mfma_f32_16x16x32_bf16 v[84:87], v[120:123], v[180:183], v[84:87]
  ds_read_b128 v[120:123], v1 offset:14336
  s_waitcnt lgkmcnt(6)
  v_mfma_f32_16x16x32_bf16 v[88:91], v[124:127], v[176:179], v[88:91]
  buffer_load_dwordx4 v[212:215], v1, s[28:31], s32 offen offset:1024 sc1
  v_mfma_f32_16x16x32_bf16 v[92:95], v[124:127], v[180:183], v[92:95]
  ds_read_b128 v[124:127], v1 offset:15360
  s_waitcnt vmcnt(6) lgkmcnt(6)
  v_mfma_f32_16x16x32_bf16 v[56:59], v[128:131], v[184:187], v[56:59]
  v_mfma_f32_16x16x32_bf16 v[60:63], v[128:131], v[188:191], v[60:63]
  ds_read_b128 v[128:131], v1 offset:16384
  s_waitcnt lgkmcnt(6)
  v_mfma_f32_16x16x32_bf16 v[64:67], v[132:135], v[184:187], v[64:67]
  buffer_load_dwordx4 v[216:219], v1, s[28:31], s32 offen offset:2048 sc1
  v_mfma_f32_16x16x32_bf16 v[68:71], v[132:135], v[188:191], v[68:71]
  ds_read_b128 v[132:135], v1 offset:17408
  s_waitcnt lgkmcnt(6)
  v_mfma_f32_16x16x32_bf16 v[72:75], v[112:115], v[184:187], v[72:75]
  buffer_load_dwordx4 v[220:223], v1, s[28:31], s32 offen offset:3072 sc1
  s_add_u32 s32, s32, 4096
  v_mfma_f32_16x16x32_bf16 v[76:79], v[112:115], v[188:191], v[76:79]
  ds_read_b128 v[112:115], v1 offset:18432
  s_waitcnt lgkmcnt(6)
  v_mfma_f32_16x16x32_bf16 v[80:83], v[116:119], v[184:187], v[80:83]
  ds_write_b128 v42, a[180:183] offset:17408
  v_mfma_f32_16x16x32_bf16 v[84:87], v[116:119], v[188:191], v[84:87]
  ds_read_b128 v[116:119], v1 offset:19456
  s_waitcnt lgkmcnt(6)
  v_mfma_f32_16x16x32_bf16 v[88:91], v[120:123], v[184:187], v[88:91]
  buffer_load_dwordx4 v[224:227], v1, s[28:31], s32 offen offset:0 sc1
  v_mfma_f32_16x16x32_bf16 v[92:95], v[120:123], v[188:191], v[92:95]
  ds_read_b128 v[120:123], v1 offset:20480
  s_waitcnt vmcnt(7) lgkmcnt(6)
  v_mfma_f32_16x16x32_bf16 v[56:59], v[124:127], v[192:195], v[56:59]
  v_mfma_f32_16x16x32_bf16 v[60:63], v[124:127], v[196:199], v[60:63]
  ds_read_b128 v[124:127], v1 offset:21504
  s_waitcnt lgkmcnt(6)
  v_mfma_f32_16x16x32_bf16 v[64:67], v[128:131], v[192:195], v[64:67]
  buffer_load_dwordx4 v[228:231], v1, s[28:31], s32 offen offset:1024 sc1
  v_mfma_f32_16x16x32_bf16 v[68:71], v[128:131], v[196:199], v[68:71]
  ds_read_b128 v[128:131], v1 offset:22528
  s_waitcnt lgkmcnt(6)
  v_mfma_f32_16x16x32_bf16 v[72:75], v[132:135], v[192:195], v[72:75]
  ds_write_b128 v42, a[184:187] offset:18432
  v_mfma_f32_16x16x32_bf16 v[76:79], v[132:135], v[196:199], v[76:79]
  ds_read_b128 v[132:135], v1 offset:23552
  s_waitcnt lgkmcnt(7)
  v_mfma_f32_16x16x32_bf16 v[80:83], v[112:115], v[192:195], v[80:83]
  buffer_load_dwordx4 v[232:235], v1, s[28:31], s32 offen offset:2048 sc1
  v_mfma_f32_16x16x32_bf16 v[84:87], v[112:115], v[196:199], v[84:87]
  ds_read_b128 v[112:115], v1 offset:24576
  s_waitcnt lgkmcnt(6)
  v_mfma_f32_16x16x32_bf16 v[88:91], v[116:119], v[192:195], v[88:91]
  buffer_load_dwordx4 v[236:239], v1, s[28:31], s32 offen offset:3072 sc1
  s_add_u32 s32, s32, 4096
  v_mfma_f32_16x16x32_bf16 v[92:95], v[116:119], v[196:199], v[92:95]
  ds_read_b128 v[116:119], v1 offset:25600
  s_waitcnt vmcnt(8) lgkmcnt(6)
  v_mfma_f32_16x16x32_bf16 v[56:59], v[120:123], v[200:203], v[56:59]
  v_mfma_f32_16x16x32_bf16 v[60:63], v[120:123], v[204:207], v[60:63]
  ds_read_b128 v[120:123], v1 offset:26624
  s_waitcnt lgkmcnt(6)
  v_mfma_f32_16x16x32_bf16 v[64:67], v[124:127], v[200:203], v[64:67]
  buffer_load_dwordx4 v[240:243], v1, s[28:31], s32 offen offset:0 sc1
  v_mfma_f32_16x16x32_bf16 v[68:71], v[124:127], v[204:207], v[68:71]
  ds_read_b128 v[124:127], v1 offset:27648
  s_waitcnt lgkmcnt(6)
  v_mfma_f32_16x16x32_bf16 v[72:75], v[128:131], v[200:203], v[72:75]
  ds_write_b128 v42, a[188:191] offset:19456
  v_mfma_f32_16x16x32_bf16 v[76:79], v[128:131], v[204:207], v[76:79]
  ds_read_b128 v[128:131], v1 offset:28672
  s_waitcnt lgkmcnt(6)
  v_mfma_f32_16x16x32_bf16 v[80:83], v[132:135], v[200:203], v[80:83]
  buffer_load_dwordx4 v[244:247], v1, s[28:31], s32 offen offset:1024 sc1
  v_mov_b32 v98, v97
  v_mfma_f32_16x16x32_bf16 v[84:87], v[132:135], v[204:207], v[84:87]
  ds_read_b128 v[132:135], v1 offset:29696
  s_waitcnt lgkmcnt(6)
  v_mfma_f32_16x16x32_bf16 v[88:91], v[112:115], v[200:203], v[88:91]
  buffer_load_dwordx4 v[248:251], v1, s[28:31], s32 offen offset:2048 sc1
  v_mov_b32 v99, v105
  v_mfma_f32_16x16x32_bf16 v[92:95], v[112:115], v[204:207], v[92:95]
  ds_read_b128 v[112:115], v1 offset:30720
  s_waitcnt vmcnt(9) lgkmcnt(6)
  v_mfma_f32_16x16x32_bf16 v[56:59], v[116:119], v[208:211], v[56:59]
  v_permlane32_swap_b32 v98, v97
  v_mfma_f32_16x16x32_bf16 v[60:63], v[116:119], v[212:215], v[60:63]
  ds_read_b128 v[116:119], v1 offset:31744
  s_waitcnt lgkmcnt(6)
  v_mfma_f32_16x16x32_bf16 v[64:67], v[120:123], v[208:211], v[64:67]
  buffer_load_dwordx4 v[252:255], v1, s[28:31], s32 offen offset:3072 sc1
  s_add_u32 s32, s32, 4096
  v_mfma_f32_16x16x32_bf16 v[68:71], v[120:123], v[212:215], v[68:71]
  ds_read_b128 v[120:123], v1 offset:32768
  s_waitcnt lgkmcnt(6)
  v_mfma_f32_16x16x32_bf16 v[72:75], v[124:127], v[208:211], v[72:75]
  v_permlane32_swap_b32 v99, v105
  v_mfma_f32_16x16x32_bf16 v[76:79], v[124:127], v[212:215], v[76:79]
  ds_read_b128 v[124:127], v1 offset:33792
  s_waitcnt lgkmcnt(5)
  v_mfma_f32_16x16x32_bf16 v[80:83], v[128:131], v[208:211], v[80:83]
  buffer_load_dwordx4 a[192:195], v1, s[28:31], s32 offen offset:0 sc1
  v_add_f32 v97, v97, v98
  v_mfma_f32_16x16x32_bf16 v[84:87], v[128:131], v[212:215], v[84:87]
  ds_read_b128 v[128:131], v1 offset:34816
  s_waitcnt lgkmcnt(5)
  v_mfma_f32_16x16x32_bf16 v[88:91], v[132:135], v[208:211], v[88:91]
  buffer_load_dwordx4 a[196:199], v1, s[28:31], s32 offen offset:1024 sc1
  v_add_f32 v105, v105, v99
  v_mfma_f32_16x16x32_bf16 v[92:95], v[132:135], v[212:215], v[92:95]
  ds_read_b128 v[132:135], v1 offset:35840
  s_waitcnt vmcnt(10) lgkmcnt(5)
  v_mfma_f32_16x16x32_bf16 v[56:59], v[112:115], v[216:219], v[56:59]
  v_mov_b32 v98, v97
  v_mov_b32 v99, v105
  v_mfma_f32_16x16x32_bf16 v[60:63], v[112:115], v[220:223], v[60:63]
  ds_read_b128 v[112:115], v1 offset:36864
  s_waitcnt lgkmcnt(5)
  v_mfma_f32_16x16x32_bf16 v[64:67], v[116:119], v[216:219], v[64:67]
  buffer_load_dwordx4 a[200:203], v1, s[28:31], s32 offen offset:2048 sc1
  v_mfma_f32_16x16x32_bf16 v[68:71], v[116:119], v[220:223], v[68:71]
  ds_read_b128 v[116:119], v1 offset:37888
  s_waitcnt lgkmcnt(5)
  v_mfma_f32_16x16x32_bf16 v[72:75], v[120:123], v[216:219], v[72:75]
  v_permlane16_swap_b32 v98, v97
  v_mfma_f32_16x16x32_bf16 v[76:79], v[120:123], v[220:223], v[76:79]
  ds_read_b128 v[120:123], v1 offset:38912
  s_waitcnt lgkmcnt(5)
  v_mfma_f32_16x16x32_bf16 v[80:83], v[124:127], v[216:219], v[80:83]
  buffer_load_dwordx4 a[204:207], v1, s[28:31], s32 offen offset:3072 sc1
  s_add_u32 s32, s32, 4096
  v_mfma_f32_16x16x32_bf16 v[84:87], v[124:127], v[220:223], v[84:87]
  ds_read_b128 v[124:127], v1 offset:39936
  s_waitcnt lgkmcnt(5)
  v_mfma_f32_16x16x32_bf16 v[88:91], v[128:131], v[216:219], v[88:91]
  v_permlane16_swap_b32 v99, v105
  v_mfma_f32_16x16x32_bf16 v[92:95], v[128:131], v[220:223], v[92:95]
  ds_read_b128 v[128:131], v1 offset:40960
  s_waitcnt vmcnt(10) lgkmcnt(5)
  v_mfma_f32_16x16x32_bf16 v[56:59], v[132:135], v[224:227], v[56:59]
  buffer_load_dwordx4 a[208:211], v1, s[28:31], s32 offen offset:0 sc1
  v_add_f32 v97, v97, v98
  v_mfma_f32_16x16x32_bf16 v[60:63], v[132:135], v[228:231], v[60:63]
  ds_read_b128 v[132:135], v1 offset:41984
  s_waitcnt lgkmcnt(5)
  v_mfma_f32_16x16x32_bf16 v[64:67], v[112:115], v[224:227], v[64:67]
  buffer_load_dwordx4 a[212:215], v1, s[28:31], s32 offen offset:1024 sc1
  v_add_f32 v105, v105, v99
  v_mfma_f32_16x16x32_bf16 v[68:71], v[112:115], v[228:231], v[68:71]
  ds_read_b128 v[112:115], v1 offset:43008
  s_waitcnt lgkmcnt(5)
  v_mfma_f32_16x16x32_bf16 v[72:75], v[116:119], v[224:227], v[72:75]
  v_mul_f32 v97, 0x3ae38e39, v97
  v_mul_f32 v105, 0x3ae38e39, v105
  v_mfma_f32_16x16x32_bf16 v[76:79], v[116:119], v[228:231], v[76:79]
  ds_read_b128 v[116:119], v1 offset:44032
  s_waitcnt lgkmcnt(5)
  v_mfma_f32_16x16x32_bf16 v[80:83], v[120:123], v[224:227], v[80:83]
  buffer_load_dwordx4 a[216:219], v1, s[28:31], s32 offen offset:2048 sc1
  v_fma_f32 v97, -v96, v96, v97
  v_mfma_f32_16x16x32_bf16 v[84:87], v[120:123], v[228:231], v[84:87]
  ds_read_b128 v[120:123], v1 offset:45056
  s_waitcnt lgkmcnt(5)
  v_mfma_f32_16x16x32_bf16 v[88:91], v[124:127], v[224:227], v[88:91]
  v_fma_f32 v105, -v104, v104, v105
  v_max_f32 v97, 0, v97
  v_mfma_f32_16x16x32_bf16 v[92:95], v[124:127], v[228:231], v[92:95]
  ds_read_b128 v[124:127], v1 offset:46080
  s_waitcnt vmcnt(11) lgkmcnt(5)
  v_mfma_f32_16x16x32_bf16 v[56:59], v[128:131], v[232:235], v[56:59]
  buffer_load_dwordx4 a[220:223], v1, s[28:31], s32 offen offset:3072 sc1
  s_add_u32 s32, s32, 4096
  v_mfma_f32_16x16x32_bf16 v[60:63], v[128:131], v[236:239], v[60:63]
  ds_read_b128 v[128:131], v1 offset:47104
  s_waitcnt lgkmcnt(5)
  v_mfma_f32_16x16x32_bf16 v[64:67], v[132:135], v[232:235], v[64:67]
  buffer_load_dwordx4 a[224:227], v1, s[28:31], s32 offen offset:0 sc1
  v_max_f32 v105, 0, v105
  v_mfma_f32_16x16x32_bf16 v[68:71], v[132:135], v[236:239], v[68:71]
  ds_read_b128 v[132:135], v1 offset:48128
  s_waitcnt lgkmcnt(5)
  v_mfma_f32_16x16x32_bf16 v[72:75], v[112:115], v[232:235], v[72:75]
  v_add_f32 v97, 0x3727c5ac, v97
  v_add_f32 v105, 0x3727c5ac, v105
  v_mfma_f32_16x16x32_bf16 v[76:79], v[112:115], v[236:239], v[76:79]
  s_waitcnt lgkmcnt(15)
  s_barrier
  ds_read_b128 v[112:115], v1 offset:49152
  s_waitcnt lgkmcnt(5)
  v_mfma_f32_16x16x32_bf16 v[80:83], v[116:119], v[232:235], v[80:83]
  buffer_load_dwordx4 a[228:231], v1, s[28:31], s32 offen offset:1024 sc1
  v_mfma_f32_16x16x32_bf16 v[84:87], v[116:119], v[236:239], v[84:87]
  ds_read_b128 v[116:119], v1 offset:50176
  s_waitcnt lgkmcnt(5)
  v_mfma_f32_16x16x32_bf16 v[88:91], v[120:123], v[232:235], v[88:91]
  v_rsq_f32 v152, v97
  v_mfma_f32_16x16x32_bf16 v[92:95], v[120:123], v[236:239], v[92:95]
  ds_read_b128 v[120:123], v1 offset:51200
  s_waitcnt vmcnt(12) lgkmcnt(5)
  v_mfma_f32_16x16x32_bf16 v[56:59], v[124:127], v[240:243], v[56:59]
  buffer_load_dwordx4 a[232:235], v1, s[28:31], s32 offen offset:2048 sc1
  v_mfma_f32_16x16x32_bf16 v[60:63], v[124:127], v[244:247], v[60:63]
  ds_read_b128 v[124:127], v1 offset:52224
  s_waitcnt lgkmcnt(5)
  v_mfma_f32_16x16x32_bf16 v[64:67], v[128:131], v[240:243], v[64:67]
  buffer_load_dwordx4 a[236:239], v1, s[28:31], s32 offen offset:3072 sc1
  s_add_u32 s32, s32, 4096
  v_mfma_f32_16x16x32_bf16 v[68:71], v[128:131], v[244:247], v[68:71]
  ds_read_b128 v[128:131], v1 offset:53248
  s_waitcnt lgkmcnt(5)
  v_mfma_f32_16x16x32_bf16 v[72:75], v[132:135], v[240:243], v[72:75]
  v_rsq_f32 v153, v105
  v_mfma_f32_16x16x32_bf16 v[76:79], v[132:135], v[244:247], v[76:79]
  ds_read_b128 v[132:135], v1 offset:54272
  s_waitcnt lgkmcnt(5)
  v_mfma_f32_16x16x32_bf16 v[80:83], v[112:115], v[240:243], v[80:83]
  buffer_load_dwordx4 a[240:243], v1, s[28:31], s32 offen offset:0 sc1
  v_mul_f32 v154, 0x3eae1a93, v152
  v_mfma_f32_16x16x32_bf16 v[84:87], v[112:115], v[244:247], v[84:87]
  ds_read_b128 v[112:115], v1 offset:55296
  s_waitcnt lgkmcnt(5)
  v_mfma_f32_16x16x32_bf16 v[88:91], v[116:119], v[240:243], v[88:91]
  v_mul_f32 v155, 0x3eae1a93, v153
  v_mfma_f32_16x16x32_bf16 v[92:95], v[116:119], v[244:247], v[92:95]
  ds_read_b128 v[116:119], v1 offset:56320
  s_waitcnt vmcnt(13) lgkmcnt(5)
  v_mfma_f32_16x16x32_bf16 v[56:59], v[120:123], v[248:251], v[56:59]
  buffer_load_dwordx4 a[244:247], v1, s[28:31], s32 offen offset:1024 sc1
  v_mfma_f32_16x16x32_bf16 v[60:63], v[120:123], v[252:255], v[60:63]
  ds_read_b128 v[120:123], v1 offset:57344
  s_waitcnt lgkmcnt(5)
  v_mfma_f32_16x16x32_bf16 v[64:67], v[124:127], v[248:251], v[64:67]
  s_cmp_ge_u32 s52, 1
  s_cselect_b32 s43, s55, 0
  v_mfma_f32_16x16x32_bf16 v[68:71], v[124:127], v[252:255], v[68:71]
  ds_read_b128 v[124:127], v1 offset:58368
  s_waitcnt lgkmcnt(5)
  v_mfma_f32_16x16x32_bf16 v[72:75], v[128:131], v[248:251], v[72:75]
  buffer_load_dwordx4 a[248:251], v1, s[28:31], s32 offen offset:2048 sc1
  v_mfma_f32_16x16x32_bf16 v[76:79], v[128:131], v[252:255], v[76:79]
  ds_read_b128 v[128:131], v1 offset:59392
  s_waitcnt lgkmcnt(5)
  v_mfma_f32_16x16x32_bf16 v[80:83], v[132:135], v[248:251], v[80:83]
  buffer_load_dwordx4 a[252:255], v1, s[28:31], s32 offen offset:3072 sc1
  v_mfma_f32_16x16x32_bf16 v[84:87], v[132:135], v[252:255], v[84:87]
  ds_read_b128 v[132:135], v1 offset:60416
  s_waitcnt lgkmcnt(5)
  v_mfma_f32_16x16x32_bf16 v[88:91], v[112:115], v[248:251], v[88:91]
  s_add_u32 m0, s35, 0
  v_mfma_f32_16x16x32_bf16 v[92:95], v[112:115], v[252:255], v[92:95]
  ds_read_b128 v[112:115], v1 offset:61440
  s_waitcnt vmcnt(14) lgkmcnt(5)
  v_mfma_f32_16x16x32_bf16 v[56:59], v[116:119], a[192:195], v[56:59]
  buffer_load_dwordx4 v1, s[8:11], s34 offen offset:0 sc1 lds
  v_mfma_f32_16x16x32_bf16 v[60:63], v[116:119], a[196:199], v[60:63]
  ds_read_b128 v[116:119], v1 offset:62464
  s_waitcnt lgkmcnt(5)
  v_mfma_f32_16x16x32_bf16 v[64:67], v[120:123], a[192:195], v[64:67]
  s_cmp_ge_u32 s52, 2
  s_cselect_b32 s44, s55, 0
  v_mfma_f32_16x16x32_bf16 v[68:71], v[120:123], a[196:199], v[68:71]
  ds_read_b128 v[120:123], v1 offset:63488
  s_waitcnt lgkmcnt(5)
  v_mfma_f32_16x16x32_bf16 v[72:75], v[124:127], a[192:195], v[72:75]
  s_mul_i32 s21, s54, 23552
  s_min_u32 s21, s21, 68608
  v_mfma_f32_16x16x32_bf16 v[76:79], v[124:127], a[196:199], v[76:79]
  ds_read_b128 v[124:127], v1 offset:64512
  s_waitcnt lgkmcnt(5)
  v_mfma_f32_16x16x32_bf16 v[80:83], v[128:131], a[192:195], v[80:83]
  buffer_load_dwordx4 v1, s[8:11], s34 offen offset:1024 sc1 lds
  s_add_u32 s21, s21, 65536
  v_mfma_f32_16x16x32_bf16 v[84:87], v[128:131], a[196:199], v[84:87]
  ds_read_b128 v[128:131], v2 offset:0
  s_waitcnt lgkmcnt(5)
  v_mfma_f32_16x16x32_bf16 v[88:91], v[132:135], a[192:195], v[88:91]
  s_add_u32 s22, s39, 671744
  v_add_u32 v174, s22, v1
  v_mfma_f32_16x16x32_bf16 v[92:95], v[132:135], a[196:199], v[92:95]
  ds_read_b128 v[132:135], v2 offset:1024
  s_waitcnt vmcnt(14) lgkmcnt(5)
  v_mfma_f32_16x16x32_bf16 v[56:59], v[112:115], a[200:203], v[56:59]
  v_add_u32 v172, 65536, v19
  v_add_u32 v173, 65536, v9
  v_mfma_f32_16x16x32_bf16 v[60:63], v[112:115], a[204:207], v[60:63]
  ds_read_b128 v[112:115], v2 offset:2048
  s_waitcnt lgkmcnt(5)
  v_mfma_f32_16x16x32_bf16 v[64:67], v[116:119], a[200:203], v[64:67]
  buffer_load_dwordx4 v1, s[8:11], s34 offen offset:2048 sc1 lds
  v_lshl_add_u32 v52, s54, 8, v12
  v_mfma_f32_16x16x32_bf16 v[68:71], v[116:119], a[204:207], v[68:71]
  ds_read_b128 v[116:119], v2 offset:3072
  s_waitcnt lgkmcnt(5)
  v_mfma_f32_16x16x32_bf16 v[72:75], v[120:123], a[200:203], v[72:75]
  v_add_u32 v52, 157696, v52
  s_and_b32 s81, s54, 2
  v_mfma_f32_16x16x32_bf16 v[76:79], v[120:123], a[204:207], v[76:79]
  ds_read_b128 v[120:123], v2 offset:4096
  s_waitcnt lgkmcnt(5)
  v_mfma_f32_16x16x32_bf16 v[80:83], v[124:127], a[200:203], v[80:83]
  s_add_u32 s81, s81, s54
  s_lshl_b32 s81, s81, 7
  v_mfma_f32_16x16x32_bf16 v[84:87], v[124:127], a[204:207], v[84:87]
  ds_read_b128 v[124:127], v2 offset:5120
  s_waitcnt lgkmcnt(5)
  v_mfma_f32_16x16x32_bf16 v[88:91], v[128:131], a[200:203], v[88:91]
  buffer_load_dwordx4 v1, s[8:11], s34 offen offset:3072 sc1 lds
  s_add_u32 s81, s81, 157696
  v_mfma_f32_16x16x32_bf16 v[92:95], v[128:131], a[204:207], v[92:95]
  ds_read_b128 v[128:131], v2 offset:6144
  s_waitcnt vmcnt(14) lgkmcnt(5)
  v_mfma_f32_16x16x32_bf16 v[56:59], v[132:135], a[208:211], v[56:59]
  s_add_u32 s34, s34, 4096
  v_add_u32 v53, s81, v39
  v_mfma_f32_16x16x32_bf16 v[60:63], v[132:135], a[212:215], v[60:63]
  ds_read_b128 v[132:135], v2 offset:7168
  s_waitcnt lgkmcnt(5)
  v_mfma_f32_16x16x32_bf16 v[64:67], v[112:115], a[208:211], v[64:67]
  s_add_u32 m0, s35, 4096
  v_mov_b32 v55, 0xff800000
  v_mfma_f32_16x16x32_bf16 v[68:71], v[112:115], a[212:215], v[68:71]
  ds_read_b128 v[112:115], v2 offset:8192
  s_waitcnt lgkmcnt(5)
  v_mfma_f32_16x16x32_bf16 v[72:75], v[116:119], a[208:211], v[72:75]
  buffer_load_dwordx4 v1, s[8:11], s34 offen offset:0 sc1 lds
  v_mov_b32 v169, 0
  v_mfma_f32_16x16x32_bf16 v[76:79], v[116:119], a[212:215], v[76:79]
  ds_read_b128 v[116:119], v2 offset:9216
  s_waitcnt lgkmcnt(5)
  v_mfma_f32_16x16x32_bf16 v[80:83], v[120:123], a[208:211], v[80:83]
  v_mov_b32 v171, 0
  v_mov_b32 v149, 0x3f803f80
  v_mfma_f32_16x16x32_bf16 v[84:87], v[120:123], a[212:215], v[84:87]
  ds_read_b128 v[120:123], v2 offset:10240
  s_waitcnt lgkmcnt(5)
  v_mfma_f32_16x16x32_bf16 v[88:91], v[124:127], a[208:211], v[88:91]
  s_add_u32 s80, s55, 0x3f803f80
  v_mul_f32 v50, v21, v152
  v_mfma_f32_16x16x32_bf16 v[92:95], v[124:127], a[212:215], v[92:95]
  ds_read_b128 v[124:127], v2 offset:11264
  s_waitcnt vmcnt(13) lgkmcnt(5)
  v_mfma_f32_16x16x32_bf16 v[56:59], v[128:131], a[216:219], v[56:59]
  buffer_load_dwordx4 v1, s[8:11], s34 offen offset:1024 sc1 lds
  v_mul_f32 v51, v21, v153
  v_mfma_f32_16x16x32_bf16 v[60:63], v[128:131], a[220:223], v[60:63]
  ds_read_b128 v[128:131], v2 offset:12288
  s_waitcnt lgkmcnt(5)
  v_mfma_f32_16x16x32_bf16 v[64:67], v[132:135], a[216:219], v[64:67]
  v_mfma_f32_16x16x32_bf16 v[68:71], v[132:135], a[220:223], v[68:71]
  ds_read_b128 v[132:135], v2 offset:13312
  s_waitcnt lgkmcnt(5)
  v_mfma_f32_16x16x32_bf16 v[72:75], v[112:115], a[216:219], v[72:75]
  v_mfma_f32_16x16x32_bf16 v[76:79], v[112:115], a[220:223], v[76:79]
  ds_read_b128 v[112:115], v2 offset:14336
  s_waitcnt lgkmcnt(5)
  v_mfma_f32_16x16x32_bf16 v[80:83], v[116:119], a[216:219], v[80:83]
  buffer_load_dwordx4 v1, s[8:11], s34 offen offset:2048 sc1 lds
  v_mfma_f32_16x16x32_bf16 v[84:87], v[116:119], a[220:223], v[84:87]
  ds_read_b128 v[116:119], v2 offset:15360
  s_waitcnt lgkmcnt(5)
  v_mfma_f32_16x16x32_bf16 v[88:91], v[120:123], a[216:219], v[88:91]
  v_mfma_f32_16x16x32_bf16 v[92:95], v[120:123], a[220:223], v[92:95]
  ds_read_b128 v[120:123], v2 offset:16384
  s_waitcnt vmcnt(13) lgkmcnt(5)
  v_mfma_f32_16x16x32_bf16 v[56:59], v[124:127], a[224:227], v[56:59]
  v_mfma_f32_16x16x32_bf16 v[60:63], v[124:127], a[228:231], v[60:63]
  ds_read_b128 v[124:127], v2 offset:17408
  s_waitcnt lgkmcnt(5)
  v_mfma_f32_16x16x32_bf16 v[64:67], v[128:131], a[224:227], v[64:67]
  buffer_load_dwordx4 v1, s[8:11], s34 offen offset:3072 sc1 lds
  v_mfma_f32_16x16x32_bf16 v[68:71], v[128:131], a[228:231], v[68:71]
  ds_read_b128 v[128:131], v2 offset:18432
  s_waitcnt lgkmcnt(5)
  v_mfma_f32_16x16x32_bf16 v[72:75], v[132:135], a[224:227], v[72:75]
  s_add_u32 s34, s34, 4096
  v_mfma_f32_16x16x32_bf16 v[76:79], v[132:135], a[228:231], v[76:79]
  ds_read_b128 v[132:135], v2 offset:19456
  s_waitcnt lgkmcnt(5)
  v_mfma_f32_16x16x32_bf16 v[80:83], v[112:115], a[224:227], v[80:83]
  s_add_u32 m0, s35, 8192
  v_mfma_f32_16x16x32_bf16 v[84:87], v[112:115], a[228:231], v[84:87]
  ds_read_b128 v[112:115], v2 offset:20480
  s_waitcnt lgkmcnt(5)
  v_mfma_f32_16x16x32_bf16 v[88:91], v[116:119], a[224:227], v[88:91]
  buffer_load_dwordx4 v1, s[8:11], s34 offen offset:0 sc1 lds
  v_mfma_f32_16x16x32_bf16 v[92:95], v[116:119], a[228:231], v[92:95]
  ds_read_b128 v[116:119], v2 offset:21504
  s_waitcnt vmcnt(13) lgkmcnt(5)
  v_mfma_f32_16x16x32_bf16 v[56:59], v[120:123], a[232:235], v[56:59]
  v_mfma_f32_16x16x32_bf16 v[60:63], v[120:123], a[236:239], v[60:63]
  ds_read_b128 v[120:123], v2 offset:22528
  s_waitcnt lgkmcnt(5)
  v_mfma_f32_16x16x32_bf16 v[64:67], v[124:127], a[232:235], v[64:67]
  v_mfma_f32_16x16x32_bf16 v[68:71], v[124:127], a[236:239], v[68:71]
  ds_read_b128 v[124:127], v2 offset:23552
  s_waitcnt lgkmcnt(5)
  v_mfma_f32_16x16x32_bf16 v[72:75], v[128:131], a[232:235], v[72:75]
  buffer_load_dwordx4 v1, s[8:11], s34 offen offset:1024 sc1 lds
  v_mfma_f32_16x16x32_bf16 v[76:79], v[128:131], a[236:239], v[76:79]
  ds_read_b128 v[128:131], v2 offset:24576
  s_waitcnt lgkmcnt(5)
  v_mfma_f32_16x16x32_bf16 v[80:83], v[132:135], a[232:235], v[80:83]
  v_mfma_f32_16x16x32_bf16 v[84:87], v[132:135], a[236:239], v[84:87]
  ds_read_b128 v[132:135], v2 offset:25600
  s_waitcnt lgkmcnt(5)
  v_mfma_f32_16x16x32_bf16 v[88:91], v[112:115], a[232:235], v[88:91]
  v_mfma_f32_16x16x32_bf16 v[92:95], v[112:115], a[236:239], v[92:95]
  ds_read_b128 v[112:115], v2 offset:26624
  s_waitcnt vmcnt(12) lgkmcnt(5)
  v_mfma_f32_16x16x32_bf16 v[56:59], v[116:119], a[240:243], v[56:59]
  v_mfma_f32_16x16x32_bf16 v[60:63], v[116:119], a[244:247], v[60:63]
  ds_read_b128 v[116:119], v2 offset:27648
  s_waitcnt lgkmcnt(5)
  v_mfma_f32_16x16x32_bf16 v[64:67], v[120:123], a[240:243], v[64:67]
  v_mfma_f32_16x16x32_bf16 v[68:71], v[120:123], a[244:247], v[68:71]
  ds_read_b128 v[120:123], v2 offset:28672
  s_waitcnt lgkmcnt(5)
  v_mfma_f32_16x16x32_bf16 v[72:75], v[124:127], a[240:243], v[72:75]
  v_mfma_f32_16x16x32_bf16 v[76:79], v[124:127], a[244:247], v[76:79]
  ds_read_b128 v[124:127], v2 offset:29696
  s_waitcnt lgkmcnt(5)
  v_mfma_f32_16x16x32_bf16 v[80:83], v[128:131], a[240:243], v[80:83]
  v_mfma_f32_16x16x32_bf16 v[84:87], v[128:131], a[244:247], v[84:87]
  ds_read_b128 v[128:131], v2 offset:30720
  s_waitcnt lgkmcnt(5)
  v_mfma_f32_16x16x32_bf16 v[88:91], v[132:135], a[240:243], v[88:91]
  v_mfma_f32_16x16x32_bf16 v[92:95], v[132:135], a[244:247], v[92:95]
  s_waitcnt vmcnt(10) lgkmcnt(4)
  v_mfma_f32_16x16x32_bf16 v[56:59], v[112:115], a[248:251], v[56:59]
  v_mfma_f32_16x16x32_bf16 v[60:63], v[112:115], a[252:255], v[60:63]
  s_waitcnt lgkmcnt(3)
  v_mfma_f32_16x16x32_bf16 v[64:67], v[116:119], a[248:251], v[64:67]
  v_mfma_f32_16x16x32_bf16 v[68:71], v[116:119], a[252:255], v[68:71]
  s_waitcnt lgkmcnt(2)
  v_mfma_f32_16x16x32_bf16 v[72:75], v[120:123], a[248:251], v[72:75]
  v_mfma_f32_16x16x32_bf16 v[76:79], v[120:123], a[252:255], v[76:79]
  s_waitcnt lgkmcnt(1)
  v_mfma_f32_16x16x32_bf16 v[80:83], v[124:127], a[248:251], v[80:83]
  v_mfma_f32_16x16x32_bf16 v[84:87], v[124:127], a[252:255], v[84:87]
  s_waitcnt lgkmcnt(0)
  v_mfma_f32_16x16x32_bf16 v[88:91], v[128:131], a[248:251], v[88:91]
  v_mfma_f32_16x16x32_bf16 v[92:95], v[128:131], a[252:255], v[92:95]
  v_pk_mul_f32 v[56:57], v[56:57], v[152:153] op_sel_hi:[1,0]
  v_pk_mul_f32 v[58:59], v[58:59], v[152:153] op_sel_hi:[1,0]
  v_pk_mul_f32 v[60:61], v[60:61], v[152:153] op_sel:[0,1] op_sel_hi:[1,1]
  v_pk_mul_f32 v[62:63], v[62:63], v[152:153] op_sel:[0,1] op_sel_hi:[1,1]
  v_pk_mul_f32 v[64:65], v[64:65], v[152:153] op_sel_hi:[1,0]
  v_pk_mul_f32 v[66:67], v[66:67], v[152:153] op_sel_hi:[1,0]
  v_pk_mul_f32 v[68:69], v[68:69], v[152:153] op_sel:[0,1] op_sel_hi:[1,1]
  v_pk_mul_f32 v[70:71], v[70:71], v[152:153] op_sel:[0,1] op_sel_hi:[1,1]
  v_cvt_pk_bf16_f32 v132, v56, v57
  v_cvt_pk_bf16_f32 v133, v58, v59
  v_cvt_pk_bf16_f32 v134, v64, v65
  v_cvt_pk_bf16_f32 v135, v66, v67
  v_cvt_pk_bf16_f32 v136, v60, v61
  v_cvt_pk_bf16_f32 v137, v62, v63
  v_cvt_pk_bf16_f32 v138, v68, v69
  v_cvt_pk_bf16_f32 v139, v70, v71
  buffer_store_dwordx4 v[132:135], v3, s[8:11], s72 offen offset:0 sc1
  buffer_store_dwordx4 v[136:139], v3, s[8:11], s72 offen offset:256 sc1
  v_pk_mul_f32 v[72:73], v[72:73], v[152:153] op_sel_hi:[1,0]
  v_pk_mul_f32 v[74:75], v[74:75], v[152:153] op_sel_hi:[1,0]
  v_pk_mul_f32 v[76:77], v[76:77], v[152:153] op_sel:[0,1] op_sel_hi:[1,1]
  v_pk_mul_f32 v[78:79], v[78:79], v[152:153] op_sel:[0,1] op_sel_hi:[1,1]
  v_pk_mul_f32 v[80:81], v[80:81], v[152:153] op_sel_hi:[1,0]
  v_pk_mul_f32 v[82:83], v[82:83], v[152:153] op_sel_hi:[1,0]
  v_pk_mul_f32 v[84:85], v[84:85], v[152:153] op_sel:[0,1] op_sel_hi:[1,1]
  v_pk_mul_f32 v[86:87], v[86:87], v[152:153] op_sel:[0,1] op_sel_hi:[1,1]
  v_cvt_pk_bf16_f32 v140, v72, v73
  v_cvt_pk_bf16_f32 v141, v74, v75
  v_cvt_pk_bf16_f32 v142, v80, v81
  v_cvt_pk_bf16_f32 v143, v82, v83
  v_cvt_pk_bf16_f32 v144, v76, v77
  v_cvt_pk_bf16_f32 v145, v78, v79
  v_cvt_pk_bf16_f32 v146, v84, v85
  v_cvt_pk_bf16_f32 v147, v86, v87
  buffer_store_dwordx4 v[140:143], v3, s[8:11], s72 offen offset:1024 sc1
  buffer_store_dwordx4 v[144:147], v3, s[8:11], s72 offen offset:1280 sc1
  s_waitcnt vmcnt(4)
  s_barrier
  v_add_u32 v54, 97280, v44
  ds_read2st64_b32 v[112:113], v54 offset0:0 offset1:1
  ds_read2st64_b32 v[114:115], v54 offset0:2 offset1:3
  ds_read2st64_b32 v[116:117], v54 offset0:4 offset1:5
  ds_read2st64_b32 v[118:119], v54 offset0:6 offset1:7
  v_pk_mul_f32 v[88:89], v[88:89], v[152:153] op_sel_hi:[1,0]
  v_pk_mul_f32 v[90:91], v[90:91], v[50:51] op_sel_hi:[1,0]
  v_pk_mul_f32 v[92:93], v[92:93], v[152:153] op_sel:[0,1] op_sel_hi:[1,1]
  v_pk_mul_f32 v[94:95], v[94:95], v[50:51] op_sel:[0,1] op_sel_hi:[1,1]
  v_cvt_pk_bf16_f32 v148, v88, v89
  v_cvt_pk_bf16_f32 v48, v92, v93
  v_cvt_pk_bf16_f32 v150, v90, v91
  v_cvt_pk_bf16_f32 v164, v94, v95
  v_add3_u32 v151, v132, v133, s80
  v_add3_u32 v151, v134, v135, v151
  v_add3_u32 v151, v136, v137, v151
  v_add3_u32 v151, v138, v139, v151
  v_add3_u32 v151, v140, v141, v151
  v_add3_u32 v151, v142, v143, v151
  v_add3_u32 v151, v144, v145, v151
  v_add3_u32 v151, v146, v147, v151
  v_permlane16_swap_b32 v148, v48
  v_permlane16_swap_b32 v150, v164
  v_add3_u32 v151, v148, v150, v151
  buffer_store_dwordx4 v[148:151], v20, s[8:11], s72 offen offset:0 sc1
  ds_read_b128 v[120:123], v2 offset:33792
  ds_read_b128 v[124:127], v2 offset:34816
  ds_read_b128 v[128:131], v2 offset:35840
  s_waitcnt lgkmcnt(5)
  v_mfma_f32_16x16x32_bf16 v[96:99], v[112:115], v[156:159], 0
  ds_write_b128 v19, v[132:135] offset:0
  v_mfma_f32_16x16x32_bf16 v[100:103], v[112:115], v[160:163], 0
  ds_read_b128 v[112:115], v2 offset:37888
  s_waitcnt lgkmcnt(5)
  v_mfma_f32_16x16x32_bf16 v[104:107], v[116:119], v[156:159], 0
  v_mfma_f32_16x16x32_bf16 v[108:111], v[116:119], v[160:163], 0
  ds_read_b128 v[116:119], v2 offset:36864
  s_waitcnt lgkmcnt(5)
  v_mfma_f32_16x16x32_bf16 v[96:99], v[120:123], v[176:179], v[96:99]
  ds_write_b128 v19, v[140:143] offset:1024
  v_mfma_f32_16x16x32_bf16 v[100:103], v[120:123], v[180:183], v[100:103]
  ds_read_b128 v[120:123], v2 offset:39936
  s_waitcnt lgkmcnt(6)
  v_mfma_f32_16x16x32_bf16 v[104:107], v[124:127], v[176:179], v[104:107]
  v_mfma_f32_16x16x32_bf16 v[108:111], v[124:127], v[180:183], v[108:111]
  ds_read_b128 v[124:127], v2 offset:41984
  s_waitcnt lgkmcnt(6)
  v_mfma_f32_16x16x32_bf16 v[96:99], v[128:131], v[184:187], v[96:99]
  ds_write_b128 v19, v[136:139] offset:256
  v_mfma_f32_16x16x32_bf16 v[100:103], v[128:131], v[188:191], v[100:103]
  ds_read_b128 v[128:131], v2 offset:38912
  s_waitcnt lgkmcnt(6)
  v_mfma_f32_16x16x32_bf16 v[96:99], v[112:115], v[192:195], v[96:99]
  v_mfma_f32_16x16x32_bf16 v[100:103], v[112:115], v[196:199], v[100:103]
  ds_read_b128 v[112:115], v2 offset:44032
  s_waitcnt lgkmcnt(6)
  v_mfma_f32_16x16x32_bf16 v[104:107], v[116:119], v[184:187], v[104:107]
  ds_write_b128 v19, v[144:147] offset:1280
  v_mfma_f32_16x16x32_bf16 v[108:111], v[116:119], v[188:191], v[108:111]
  ds_read_b128 v[116:119], v2 offset:40960
  s_waitcnt lgkmcnt(6)
  v_mfma_f32_16x16x32_bf16 v[96:99], v[120:123], v[200:203], v[96:99]
  ds_read_b128 v[176:179], v18 offset:28672
  v_mfma_f32_16x16x32_bf16 v[100:103], v[120:123], v[204:207], v[100:103]
  ds_read_b128 v[120:123], v2 offset:46080
  s_waitcnt lgkmcnt(7)
  v_mfma_f32_16x16x32_bf16 v[96:99], v[124:127], v[208:211], v[96:99]
  ds_write_b128 v43, v[148:151]
  v_mfma_f32_16x16x32_bf16 v[100:103], v[124:127], v[212:215], v[100:103]
  ds_read_b128 v[124:127], v2 offset:48128
  s_waitcnt lgkmcnt(7)
  v_mfma_f32_16x16x32_bf16 v[104:107], v[128:131], v[192:195], v[104:107]
  ds_write_b32 v52, v164
  ds_read_b128 v[180:183], v18 offset:29696
  v_mfma_f32_16x16x32_bf16 v[108:111], v[128:131], v[196:199], v[108:111]
  ds_read_b128 v[128:131], v2 offset:43008
  s_waitcnt lgkmcnt(9)
  v_mfma_f32_16x16x32_bf16 v[96:99], v[112:115], v[216:219], v[96:99]
  ds_read_b128 v[184:187], v18 offset:30720
  v_mfma_f32_16x16x32_bf16 v[100:103], v[112:115], v[220:223], v[100:103]
  ds_read_b128 v[112:115], v2 offset:50176
  s_waitcnt lgkmcnt(9)
  v_mfma_f32_16x16x32_bf16 v[104:107], v[116:119], v[200:203], v[104:107]
  ds_read_b128 v[188:191], v18 offset:31744
  v_mfma_f32_16x16x32_bf16 v[108:111], v[116:119], v[204:207], v[108:111]
  ds_read_b128 v[116:119], v2 offset:52224
  s_waitcnt lgkmcnt(9)
  v_mfma_f32_16x16x32_bf16 v[96:99], v[120:123], v[224:227], v[96:99]
  v_mfma_f32_16x16x32_bf16 v[100:103], v[120:123], v[228:231], v[100:103]
  ds_read_b128 v[120:123], v2 offset:45056
  s_waitcnt lgkmcnt(8)
  v_mfma_f32_16x16x32_bf16 v[96:99], v[124:127], v[232:235], v[96:99]
  v_mfma_f32_16x16x32_bf16 v[100:103], v[124:127], v[236:239], v[100:103]
  ds_read_b128 v[124:127], v2 offset:54272
  s_waitcnt lgkmcnt(6)
  v_mfma_f32_16x16x32_bf16 v[104:107], v[128:131], v[208:211], v[104:107]
  v_mfma_f32_16x16x32_bf16 v[108:111], v[128:131], v[212:215], v[108:111]
  ds_read_b128 v[128:131], v2 offset:56320
  s_waitcnt lgkmcnt(5)
  v_mfma_f32_16x16x32_bf16 v[96:99], v[112:115], v[240:243], v[96:99]
  v_mfma_f32_16x16x32_bf16 v[100:103], v[112:115], v[244:247], v[100:103]
  ds_read_b128 v[112:115], v2 offset:47104
  s_waitcnt lgkmcnt(4)
  v_mfma_f32_16x16x32_bf16 v[96:99], v[116:119], v[248:251], v[96:99]
  v_mfma_f32_16x16x32_bf16 v[100:103], v[116:119], v[252:255], v[100:103]
  ds_read_b128 v[116:119], v2 offset:58368
  s_waitcnt lgkmcnt(4)
  v_mfma_f32_16x16x32_bf16 v[104:107], v[120:123], v[216:219], v[104:107]
  s_waitcnt lgkmcnt(11)
  s_barrier
  v_mfma_f32_16x16x32_bf16 v[108:111], v[120:123], v[220:223], v[108:111]
  ds_read_b128 v[120:123], v2 offset:49152
  s_waitcnt lgkmcnt(4)
  v_mfma_f32_16x16x32_bf16 v[96:99], v[124:127], a[192:195], v[96:99]
  ds_read_b32 v168, v53 offset:0
  ds_read_b32 v170, v53 offset:256
  v_mfma_f32_16x16x32_bf16 v[100:103], v[124:127], a[196:199], v[100:103]
  ds_read_b128 v[124:127], v2 offset:60416
  s_waitcnt lgkmcnt(6)
  v_mfma_f32_16x16x32_bf16 v[96:99], v[128:131], a[200:203], v[96:99]
  v_cmp_gt_u32 vcc, 32, v16
  s_waitcnt lgkmcnt(10)
  v_mfma_f32_16x16x32_bf16 v[100:103], v[128:131], a[204:207], v[100:103]
  ds_read_b128 v[128:131], v2 offset:62464
  s_waitcnt lgkmcnt(6)
  v_mfma_f32_16x16x32_bf16 v[104:107], v[112:115], v[224:227], v[104:107]
  v_xor_b32 v192, v55, v176
  v_xor_b32 v193, v55, v177
  v_mfma_f32_16x16x32_bf16 v[108:111], v[112:115], v[228:231], v[108:111]
  ds_read_b128 v[112:115], v2 offset:51200
  s_waitcnt lgkmcnt(6)
  v_mfma_f32_16x16x32_bf16 v[96:99], v[116:119], a[208:211], v[96:99]
  v_xor_b32 v194, v55, v178
  v_xor_b32 v195, v55, v179
  v_mfma_f32_16x16x32_bf16 v[100:103], v[116:119], a[212:215], v[100:103]
  ds_read_b128 v[116:119], v2 offset:64512
  s_waitcnt lgkmcnt(6)
  v_mfma_f32_16x16x32_bf16 v[104:107], v[120:123], v[232:235], v[104:107]
  v_xor_b32 v196, v55, v180
  v_xor_b32 v197, v55, v181
  v_mfma_f32_16x16x32_bf16 v[108:111], v[120:123], v[236:239], v[108:111]
  ds_read_b128 v[120:123], v18 offset:1024
  s_waitcnt lgkmcnt(4)
  v_mfma_f32_16x16x32_bf16 v[96:99], v[124:127], a[216:219], v[96:99]
  s_waitcnt lgkmcnt(5)
  v_cndmask_b32 v168, 0, v168, vcc
  v_mfma_f32_16x16x32_bf16 v[100:103], v[124:127], a[220:223], v[100:103]
  ds_read_b128 v[124:127], v2 offset:53248
  s_waitcnt lgkmcnt(4)
  v_mfma_f32_16x16x32_bf16 v[96:99], v[128:131], a[224:227], v[96:99]
  v_cndmask_b32 v170, 0, v170, vcc
  v_xor_b32 v198, v55, v182
  v_mfma_f32_16x16x32_bf16 v[100:103], v[128:131], a[228:231], v[100:103]
  ds_read_b128 v[128:131], v18 offset:3072
  s_waitcnt lgkmcnt(4)
  v_mfma_f32_16x16x32_bf16 v[104:107], v[112:115], v[240:243], v[104:107]
  s_add_u32 m0, s45, 20480
  v_xor_b32 v199, v55, v183
  v_mfma_f32_16x16x32_bf16 v[108:111], v[112:115], v[244:247], v[108:111]
  ds_read_b128 v[112:115], v2 offset:55296
  s_waitcnt lgkmcnt(4)
  v_mfma_f32_16x16x32_bf16 v[96:99], v[116:119], a[232:235], v[96:99]
  buffer_load_dwordx4 v1, s[8:11], s41 offen offset:0 sc1 lds
  v_xor_b32 v200, v55, v184
  v_mfma_f32_16x16x32_bf16 v[100:103], v[116:119], a[236:239], v[100:103]
  ds_read_b128 v[116:119], v2 offset:57344
  s_waitcnt lgkmcnt(4)
  v_mfma_f32_16x16x32_bf16 v[96:99], v[120:123], a[240:243], v[96:99]
  buffer_load_dwordx4 v1, s[8:11], s41 offen offset:1024 sc1 lds
  v_xor_b32 v201, v55, v185
  v_mfma_f32_16x16x32_bf16 v[100:103], v[120:123], a[244:247], v[100:103]
  ds_read_b128 v[120:123], v2 offset:59392
  s_waitcnt lgkmcnt(4)
  v_mfma_f32_16x16x32_bf16 v[104:107], v[124:127], v[248:251], v[104:107]
  buffer_load_dwordx4 v1, s[8:11], s41 offen offset:2048 sc1 lds
  v_xor_b32 v202, v55, v186
  v_mfma_f32_16x16x32_bf16 v[108:111], v[124:127], v[252:255], v[108:111]
  ds_read_b128 v[124:127], v2 offset:61440
  s_waitcnt lgkmcnt(4)
  v_mfma_f32_16x16x32_bf16 v[96:99], v[128:131], a[248:251], v[96:99]
  buffer_load_dwordx4 v1, s[8:11], s41 offen offset:3072 sc1 lds
  v_xor_b32 v203, v55, v187
  v_mfma_f32_16x16x32_bf16 v[100:103], v[128:131], a[252:255], v[100:103]
  ds_read_b128 v[128:131], v2 offset:63488
  s_waitcnt lgkmcnt(4)
  v_mfma_f32_16x16x32_bf16 v[104:107], v[112:115], a[192:195], v[104:107]
  s_add_u32 s84, s41, 4096
  v_xor_b32 v204, v55, v188
  v_mfma_f32_16x16x32_bf16 v[108:111], v[112:115], a[196:199], v[108:111]
  ds_read_b128 v[112:115], v18 offset:0
  s_waitcnt lgkmcnt(4)
  v_mfma_f32_16x16x32_bf16 v[104:107], v[116:119], a[200:203], v[104:107]
  s_add_u32 m0, s45, 24576
  v_xor_b32 v205, v55, v189
  v_mfma_f32_16x16x32_bf16 v[108:111], v[116:119], a[204:207], v[108:111]
  ds_read_b128 v[116:119], v18 offset:2048
  s_waitcnt lgkmcnt(4)
  v_mfma_f32_16x16x32_bf16 v[104:107], v[120:123], a[208:211], v[104:107]
  buffer_load_dwordx4 v1, s[8:11], s84 offen sc1 lds
  v_mul_f32 v96, v96, v154
  v_mfma_f32_16x16x32_bf16 v[108:111], v[120:123], a[212:215], v[108:111]
  ds_read_b128 v[120:123], v18 offset:4096
  s_waitcnt lgkmcnt(4)
  v_mfma_f32_16x16x32_bf16 v[104:107], v[124:127], a[216:219], v[104:107]
  v_mul_f32 v97, v97, v154
  v_mul_f32 v98, v98, v154
  v_mfma_f32_16x16x32_bf16 v[108:111], v[124:127], a[220:223], v[108:111]
  s_waitcnt lgkmcnt(3)
  v_mfma_f32_16x16x32_bf16 v[104:107], v[128:131], a[224:227], v[104:107]
  v_mul_f32 v99, v99, v154
  v_mul_f32 v100, v100, v155
  v_mfma_f32_16x16x32_bf16 v[108:111], v[128:131], a[228:231], v[108:111]
  s_waitcnt lgkmcnt(2)
  v_mfma_f32_16x16x32_bf16 v[104:107], v[112:115], a[232:235], v[104:107]
  v_mul_f32 v101, v101, v155
  v_mul_f32 v102, v102, v155
  v_mfma_f32_16x16x32_bf16 v[108:111], v[112:115], a[236:239], v[108:111]
  s_waitcnt lgkmcnt(1)
  v_mfma_f32_16x16x32_bf16 v[104:107], v[116:119], a[240:243], v[104:107]
  v_mul_f32 v103, v103, v155
  v_cvt_pk_bf16_f32 v156, v96, v97
  v_mfma_f32_16x16x32_bf16 v[108:111], v[116:119], a[244:247], v[108:111]
  s_waitcnt lgkmcnt(0)
  v_mfma_f32_16x16x32_bf16 v[104:107], v[120:123], a[248:251], v[104:107]
  v_cvt_pk_bf16_f32 v157, v98, v99
  v_cvt_pk_bf16_f32 v160, v100, v101
  v_mfma_f32_16x16x32_bf16 v[108:111], v[120:123], a[252:255], v[108:111]
  v_xor_b32 v206, v55, v190
  v_xor_b32 v207, v55, v191
  v_cvt_pk_bf16_f32 v161, v102, v103
  v_accvgpr_write_b32 a197, 0
  v_accvgpr_write_b32 a205, 0
  ds_read_b128 a[192:195], v9 offset:0
  ds_read_b32 a196, v10 offset:0
  ds_read_b128 a[200:203], v9 offset:5120
  ds_read_b32 a204, v10 offset:5120
  ds_read_b64_tr_b16 a[208:209], v11 offset:0
  ds_read_b64_tr_b16 a[210:211], v11 offset:128
  ds_read_b64_tr_b16 a[212:213], v11 offset:256
  ds_read_b64_tr_b16 a[214:215], v11 offset:384
  v_pk_mul_f32 v[104:105], v[104:105], v[154:155] op_sel_hi:[1,0]
  v_pk_mul_f32 v[106:107], v[106:107], v[154:155] op_sel_hi:[1,0]
  v_cvt_pk_bf16_f32 v158, v104, v105
  v_cvt_pk_bf16_f32 v159, v106, v107
  ds_write_b128 v172, v[156:159] offset:0
  v_pk_mul_f32 v[108:109], v[108:109], v[154:155] op_sel:[0,1] op_sel_hi:[1,1]
  v_pk_mul_f32 v[110:111], v[110:111], v[154:155] op_sel:[0,1] op_sel_hi:[1,1]
  v_cvt_pk_bf16_f32 v162, v108, v109
  v_cvt_pk_bf16_f32 v163, v110, v111
  ds_write_b128 v172, v[160:163] offset:256
  s_waitcnt lgkmcnt(0)
  s_barrier
  ds_read_b128 v[160:163], v173
  ds_read_b128 v[156:159], v173 offset:5120
  ds_read_b64_tr_b16 a[216:217], v11 offset:5120
  ds_read_b64_tr_b16 a[218:219], v11 offset:5248
  ds_read_b64_tr_b16 a[220:221], v11 offset:5376
  ds_read_b64_tr_b16 a[222:223], v11 offset:5504
  s_waitcnt lgkmcnt(4)
  v_mfma_f32_32x32x16_bf16 v[112:127], a[192:195], v[160:163], v[176:191]
  v_mfma_f32_32x32x8_bf16 v[112:127], a[196:197], v[170:171], v[112:127]
  v_mfma_f32_32x32x16_bf16 v[128:143], a[200:203], v[160:163], 0
  s_nop 10
  v_exp_f32 v112, v112
  v_exp_f32 v113, v113
  v_exp_f32 v114, v114
  v_exp_f32 v115, v115
  v_cvt_pk_bf16_f32 v144, v112, v113
  v_exp_f32 v116, v116
  v_cvt_pk_bf16_f32 v145, v114, v115
  v_exp_f32 v117, v117
  v_exp_f32 v118, v118
  v_mfma_f32_32x32x8_bf16 v[128:143], a[204:205], v[170:171], v[128:143]
  v_exp_f32 v119, v119
  v_cvt_pk_bf16_f32 v146, v116, v117
  v_exp_f32 v120, v120
  v_cvt_pk_bf16_f32 v147, v118, v119
  v_exp_f32 v121, v121
  v_exp_f32 v122, v122
  v_mfma_f32_32x32x16_bf16 v[224:239], a[208:211], v[144:147], 0
  v_exp_f32 v123, v123
  v_cvt_pk_bf16_f32 v148, v120, v121
  v_exp_f32 v124, v124
  v_cvt_pk_bf16_f32 v149, v122, v123
  v_exp_f32 v125, v125
  v_exp_f32 v126, v126
  v_exp_f32 v127, v127
  v_cvt_pk_bf16_f32 v150, v124, v125
  v_cvt_pk_bf16_f32 v151, v126, v127
  s_waitcnt lgkmcnt(0)
  v_mfma_f32_32x32x16_bf16 v[112:127], a[200:203], v[156:159], v[176:191]
  s_add_u32 m0, s45, 40960
  v_exp_f32 v128, v128
  v_exp_f32 v129, v129
  v_exp_f32 v130, v130
  v_exp_f32 v131, v131
  v_mfma_f32_32x32x16_bf16 v[224:239], a[212:215], v[148:151], v[224:239]
  v_cvt_pk_bf16_f32 v144, v128, v129
  v_exp_f32 v132, v132
  v_cvt_pk_bf16_f32 v145, v130, v131
  v_exp_f32 v133, v133
  v_exp_f32 v134, v134
  v_mfma_f32_32x32x8_bf16 v[112:127], a[204:205], v[168:169], v[112:127]
  buffer_load_dwordx4 v1, s[8:11], s42 offen offset:0 sc1 lds
  v_exp_f32 v135, v135
  v_cvt_pk_bf16_f32 v146, v132, v133
  v_exp_f32 v136, v136
  v_cvt_pk_bf16_f32 v147, v134, v135
  v_exp_f32 v137, v137
  v_exp_f32 v138, v138
  v_mfma_f32_32x32x16_bf16 v[224:239], a[216:219], v[144:147], v[224:239]
  buffer_load_dwordx4 v1, s[8:11], s42 offen offset:1024 sc1 lds
  buffer_load_dwordx4 v1, s[8:11], s42 offen offset:2048 sc1 lds
  v_exp_f32 v139, v139
  v_cvt_pk_bf16_f32 v148, v136, v137
  v_exp_f32 v140, v140
  v_cvt_pk_bf16_f32 v149, v138, v139
  v_exp_f32 v141, v141
  v_exp_f32 v142, v142
  v_exp_f32 v143, v143
  v_cvt_pk_bf16_f32 v150, v140, v141
  v_cvt_pk_bf16_f32 v151, v142, v143
  v_exp_f32 v112, v112
  v_exp_f32 v113, v113
  v_exp_f32 v114, v114
  v_exp_f32 v115, v115
  v_mfma_f32_32x32x16_bf16 v[224:239], a[220:223], v[148:151], v[224:239]
  v_cvt_pk_bf16_f32 v144, v112, v113
  v_exp_f32 v116, v116
  v_cvt_pk_bf16_f32 v145, v114, v115
  v_exp_f32 v117, v117
  v_exp_f32 v118, v118
  v_exp_f32 v119, v119
  v_cvt_pk_bf16_f32 v146, v116, v117
  s_waitcnt vmcnt(3)
  ds_read_b128 v[56:59], v19 offset:20480
  ds_read_b128 v[60:63], v19 offset:20736
  ds_read_b128 v[64:67], v19 offset:21504
  ds_read_b128 v[68:71], v19 offset:21760
  ds_read_b128 v[72:75], v43 offset:20480
  v_exp_f32 v120, v120
  v_cvt_pk_bf16_f32 v147, v118, v119
  v_exp_f32 v121, v121
  v_exp_f32 v122, v122
  v_mfma_f32_32x32x16_bf16 v[208:223], a[216:219], v[144:147], 0
  v_exp_f32 v123, v123
  v_cvt_pk_bf16_f32 v148, v120, v121
  v_exp_f32 v124, v124
  v_cvt_pk_bf16_f32 v149, v122, v123
  s_waitcnt lgkmcnt(0)
Lnbchk_36:
  v_add3_u32 v48, v56, v57, s43
  v_add3_u32 v49, v58, v59, v72
  v_add3_u32 v48, v60, v61, v48
  v_add3_u32 v49, v62, v63, v49
  v_add3_u32 v48, v64, v65, v48
  v_add3_u32 v49, v66, v67, v49
  v_add3_u32 v48, v68, v69, v48
  v_add3_u32 v49, v70, v71, v49
  v_add3_u32 v48, v48, v73, v74
  v_add_u32 v48, v48, v49
  v_cmp_ne_u32 vcc, v48, v75
  s_cbranch_vccz Lnbok_37
  s_cmp_eq_u32 s57, 0
  s_cbranch_scc1 Lnbok_37
  s_sub_u32 s57, s57, 1
  s_mov_b32 s83, m0
  s_add_u32 m0, s45, 20480
  s_nop 0
  buffer_load_dwordx4 v1, s[8:11], s41 offen offset:0 sc1 lds
  buffer_load_dwordx4 v1, s[8:11], s41 offen offset:1024 sc1 lds
  buffer_load_dwordx4 v1, s[8:11], s41 offen offset:2048 sc1 lds
  buffer_load_dwordx4 v1, s[8:11], s41 offen offset:3072 sc1 lds
  s_add_u32 s84, s41, 4096
  s_add_u32 m0, s45, 24576
  s_nop 0
  buffer_load_dwordx4 v1, s[8:11], s84 offen sc1 lds
  s_mov_b32 m0, s83
  s_waitcnt vmcnt(0)
  ds_read_b128 v[56:59], v19 offset:20480
  ds_read_b128 v[60:63], v19 offset:20736
  ds_read_b128 v[64:67], v19 offset:21504
  ds_read_b128 v[68:71], v19 offset:21760
  ds_read_b128 v[72:75], v43 offset:20480
  s_waitcnt lgkmcnt(0)
  s_branch Lnbchk_36
Lnbok_37:
  s_barrier
  ds_read_b128 a[192:195], v9 offset:10240
  ds_read_b32 a196, v10 offset:10240
  ds_read_b64_tr_b16 a[208:209], v11 offset:10240
  ds_read_b64_tr_b16 a[210:211], v11 offset:10368
  ds_read_b64_tr_b16 a[212:213], v11 offset:10496
  ds_read_b64_tr_b16 a[214:215], v11 offset:10624
  v_exp_f32 v125, v125
  v_exp_f32 v126, v126
  v_exp_f32 v127, v127
  v_cvt_pk_bf16_f32 v150, v124, v125
  v_cvt_pk_bf16_f32 v151, v126, v127
  buffer_load_dwordx4 v1, s[8:11], s42 offen offset:3072 sc1 lds
  s_add_u32 s84, s42, 4096
  s_add_u32 m0, s45, 45056
  s_waitcnt lgkmcnt(4)
  v_mfma_f32_32x32x16_bf16 v[128:143], a[192:195], v[160:163], 0
  buffer_load_dwordx4 v1, s[8:11], s84 offen sc1 lds
  v_mfma_f32_32x32x8_bf16 v[128:143], a[196:197], v[170:171], v[128:143]
  s_waitcnt lgkmcnt(0)
  v_mfma_f32_32x32x16_bf16 v[112:127], a[192:195], v[156:159], 0
  ds_read_b128 a[200:203], v9 offset:15360
  ds_read_b32 a204, v10 offset:15360
  s_nop 7
  v_exp_f32 v128, v128
  v_exp_f32 v129, v129
  v_exp_f32 v130, v130
  v_exp_f32 v131, v131
  v_mfma_f32_32x32x16_bf16 v[208:223], a[220:223], v[148:151], v[208:223]
  ds_read_b64_tr_b16 a[216:217], v11 offset:15360
  ds_read_b64_tr_b16 a[218:219], v11 offset:15488
  ds_read_b64_tr_b16 a[220:221], v11 offset:15616
  ds_read_b64_tr_b16 a[222:223], v11 offset:15744
  v_cvt_pk_bf16_f32 v144, v128, v129
  v_exp_f32 v132, v132
  v_cvt_pk_bf16_f32 v145, v130, v131
  v_exp_f32 v133, v133
  v_exp_f32 v134, v134
  v_mfma_f32_32x32x8_bf16 v[112:127], a[196:197], v[168:169], v[112:127]
  v_exp_f32 v135, v135
  v_cvt_pk_bf16_f32 v146, v132, v133
  v_exp_f32 v136, v136
  v_cvt_pk_bf16_f32 v147, v134, v135
  v_exp_f32 v137, v137
  v_exp_f32 v138, v138
  v_mfma_f32_32x32x16_bf16 v[224:239], a[208:211], v[144:147], v[224:239]
  v_exp_f32 v139, v139
  v_cvt_pk_bf16_f32 v148, v136, v137
  v_exp_f32 v140, v140
  v_cvt_pk_bf16_f32 v149, v138, v139
  v_exp_f32 v141, v141
  v_exp_f32 v142, v142
  v_exp_f32 v143, v143
  v_cvt_pk_bf16_f32 v150, v140, v141
  v_cvt_pk_bf16_f32 v151, v142, v143
  s_waitcnt lgkmcnt(0)
  v_mfma_f32_32x32x16_bf16 v[128:143], a[200:203], v[160:163], 0
  s_add_u32 m0, s21, 0
  v_exp_f32 v112, v112
  v_exp_f32 v113, v113
  v_exp_f32 v114, v114
  v_exp_f32 v115, v115
  v_mfma_f32_32x32x16_bf16 v[224:239], a[212:215], v[148:151], v[224:239]
  v_cvt_pk_bf16_f32 v144, v112, v113
  v_exp_f32 v116, v116
  v_cvt_pk_bf16_f32 v145, v114, v115
  v_exp_f32 v117, v117
  v_exp_f32 v118, v118
  v_mfma_f32_32x32x8_bf16 v[128:143], a[204:205], v[170:171], v[128:143]
  v_exp_f32 v119, v119
  v_cvt_pk_bf16_f32 v146, v116, v117
  v_exp_f32 v120, v120
  v_cvt_pk_bf16_f32 v147, v118, v119
  v_exp_f32 v121, v121
  v_exp_f32 v122, v122
  v_mfma_f32_32x32x16_bf16 v[208:223], a[208:211], v[144:147], v[208:223]
  buffer_load_dwordx4 v174, s[8:11], m0 offen offset:0 sc1 lds
  buffer_load_dwordx4 v174, s[8:11], m0 offen offset:1024 sc1 lds
  buffer_load_dwordx4 v174, s[8:11], m0 offen offset:2048 sc1 lds
  buffer_load_dwordx4 v174, s[8:11], m0 offen offset:3072 sc1 lds
  v_exp_f32 v123, v123
  v_cvt_pk_bf16_f32 v148, v120, v121
  v_exp_f32 v124, v124
  v_cvt_pk_bf16_f32 v149, v122, v123
  v_exp_f32 v125, v125
  v_exp_f32 v126, v126
  v_exp_f32 v127, v127
  v_cvt_pk_bf16_f32 v150, v124, v125
  v_cvt_pk_bf16_f32 v151, v126, v127
  v_mfma_f32_32x32x16_bf16 v[112:127], a[200:203], v[156:159], 0
  ds_read_b128 a[192:195], v9 offset:20480
  ds_read_b32 a196, v10 offset:20480
  v_exp_f32 v128, v128
  v_exp_f32 v129, v129
  v_exp_f32 v130, v130
  v_exp_f32 v131, v131
  v_mfma_f32_32x32x16_bf16 v[208:223], a[212:215], v[148:151], v[208:223]
  ds_read_b64_tr_b16 a[208:209], v11 offset:20480
  ds_read_b64_tr_b16 a[210:211], v11 offset:20608
  ds_read_b64_tr_b16 a[212:213], v11 offset:20736
  ds_read_b64_tr_b16 a[214:215], v11 offset:20864
  v_cvt_pk_bf16_f32 v144, v128, v129
  v_exp_f32 v132, v132
  v_cvt_pk_bf16_f32 v145, v130, v131
  v_exp_f32 v133, v133
  v_exp_f32 v134, v134
  v_mfma_f32_32x32x8_bf16 v[112:127], a[204:205], v[168:169], v[112:127]
  s_waitcnt vmcnt(4)
  ds_read_b128 v[76:79], v19 offset:40960
  ds_read_b128 v[80:83], v19 offset:41216
  ds_read_b128 v[84:87], v19 offset:41984
  ds_read_b128 v[88:91], v19 offset:42240
  ds_read_b128 v[92:95], v43 offset:40960
  v_exp_f32 v135, v135
  v_cvt_pk_bf16_f32 v146, v132, v133
  v_exp_f32 v136, v136
  v_cvt_pk_bf16_f32 v147, v134, v135
  v_exp_f32 v137, v137
  v_exp_f32 v138, v138
  v_mfma_f32_32x32x16_bf16 v[224:239], a[216:219], v[144:147], v[224:239]
  v_exp_f32 v139, v139
  v_cvt_pk_bf16_f32 v148, v136, v137
  v_exp_f32 v140, v140
  v_cvt_pk_bf16_f32 v149, v138, v139
  v_exp_f32 v141, v141
  v_exp_f32 v142, v142
  v_exp_f32 v143, v143
  v_cvt_pk_bf16_f32 v150, v140, v141
  v_cvt_pk_bf16_f32 v151, v142, v143
  s_waitcnt lgkmcnt(0)
  v_add3_u32 v48, v76, v77, s44
  v_add3_u32 v49, v78, v79, v92
  v_add3_u32 v48, v80, v81, v48
  v_add3_u32 v49, v82, v83, v49
  v_add3_u32 v48, v84, v85, v48
  v_add3_u32 v49, v86, v87, v49
  v_add3_u32 v48, v88, v89, v48
  v_add3_u32 v49, v90, v91, v49
  v_add3_u32 v48, v48, v93, v94
  v_add_u32 v48, v48, v49
  v_cmp_ne_u32 vcc, v48, v95
  s_nop 0
  s_mov_b64 s[92:93], vcc
  s_cbranch_vccnz Lnbe_39
Lnbed_40:
  v_mfma_f32_32x32x16_bf16 v[128:143], a[192:195], v[160:163], 0
  s_add_u32 m0, s21, 4096
  v_exp_f32 v112, v112
  v_exp_f32 v113, v113
  v_exp_f32 v114, v114
  v_exp_f32 v115, v115
  v_mfma_f32_32x32x16_bf16 v[224:239], a[220:223], v[148:151], v[224:239]
  v_cvt_pk_bf16_f32 v144, v112, v113
  v_exp_f32 v116, v116
  v_cvt_pk_bf16_f32 v145, v114, v115
  v_exp_f32 v117, v117
  v_exp_f32 v118, v118
  v_mfma_f32_32x32x8_bf16 v[128:143], a[196:197], v[170:171], v[128:143]
  v_exp_f32 v119, v119
  v_cvt_pk_bf16_f32 v146, v116, v117
  v_exp_f32 v120, v120
  v_cvt_pk_bf16_f32 v147, v118, v119
  v_exp_f32 v121, v121
  v_exp_f32 v122, v122
  v_mfma_f32_32x32x16_bf16 v[208:223], a[216:219], v[144:147], v[208:223]
  buffer_load_dwordx4 v174, s[8:11], m0 offen offset:0 sc1 lds
  buffer_load_dwordx4 v174, s[8:11], m0 offen offset:1024 sc1 lds
  buffer_load_dwordx4 v174, s[8:11], m0 offen offset:2048 sc1 lds
  buffer_load_dwordx4 v174, s[8:11], m0 offen offset:3072 sc1 lds
  v_exp_f32 v123, v123
  v_cvt_pk_bf16_f32 v148, v120, v121
  v_exp_f32 v124, v124
  v_cvt_pk_bf16_f32 v149, v122, v123
  v_exp_f32 v125, v125
  v_exp_f32 v126, v126
  v_exp_f32 v127, v127
  v_cvt_pk_bf16_f32 v150, v124, v125
  v_cvt_pk_bf16_f32 v151, v126, v127
  v_mfma_f32_32x32x16_bf16 v[112:127], a[192:195], v[156:159], 0
  ds_read_b128 a[200:203], v9 offset:25600
  ds_read_b32 a204, v10 offset:25600
  v_exp_f32 v128, v128
  v_exp_f32 v129, v129
  v_exp_f32 v130, v130
  v_exp_f32 v131, v131
  v_mfma_f32_32x32x16_bf16 v[208:223], a[220:223], v[148:151], v[208:223]
  ds_read_b64_tr_b16 a[216:217], v11 offset:25600
  ds_read_b64_tr_b16 a[218:219], v11 offset:25728
  ds_read_b64_tr_b16 a[220:221], v11 offset:25856
  ds_read_b64_tr_b16 a[222:223], v11 offset:25984
  v_cvt_pk_bf16_f32 v144, v128, v129
  v_exp_f32 v132, v132
  v_cvt_pk_bf16_f32 v145, v130, v131
  v_exp_f32 v133, v133
  v_exp_f32 v134, v134
  v_mfma_f32_32x32x8_bf16 v[112:127], a[196:197], v[168:169], v[112:127]
  v_exp_f32 v135, v135
  v_cvt_pk_bf16_f32 v146, v132, v133
  v_exp_f32 v136, v136
  v_cvt_pk_bf16_f32 v147, v134, v135
  v_exp_f32 v137, v137
  v_exp_f32 v138, v138
  v_mfma_f32_32x32x16_bf16 v[224:239], a[208:211], v[144:147], v[224:239]
  v_exp_f32 v139, v139
  v_cvt_pk_bf16_f32 v148, v136, v137
  v_exp_f32 v140, v140
  v_cvt_pk_bf16_f32 v149, v138, v139
  v_exp_f32 v141, v141
  v_exp_f32 v142, v142
  v_exp_f32 v143, v143
  v_cvt_pk_bf16_f32 v150, v140, v141
  v_cvt_pk_bf16_f32 v151, v142, v143
  s_waitcnt lgkmcnt(0)
  v_mfma_f32_32x32x16_bf16 v[128:143], a[200:203], v[160:163], 0
  s_add_u32 m0, s21, 8192
  v_exp_f32 v112, v112
  v_exp_f32 v113, v113
  v_exp_f32 v114, v114
  v_exp_f32 v115, v115
  v_mfma_f32_32x32x16_bf16 v[224:239], a[212:215], v[148:151], v[224:239]
  v_cvt_pk_bf16_f32 v144, v112, v113
  v_exp_f32 v116, v116
  v_cvt_pk_bf16_f32 v145, v114, v115
  v_exp_f32 v117, v117
  v_exp_f32 v118, v118
  v_mfma_f32_32x32x8_bf16 v[128:143], a[204:205], v[170:171], v[128:143]
  v_exp_f32 v119, v119
  v_cvt_pk_bf16_f32 v146, v116, v117
  v_exp_f32 v120, v120
  v_cvt_pk_bf16_f32 v147, v118, v119
  v_exp_f32 v121, v121
  v_exp_f32 v122, v122
  v_mfma_f32_32x32x16_bf16 v[208:223], a[208:211], v[144:147], v[208:223]
  buffer_load_dwordx4 v174, s[8:11], m0 offen offset:0 sc1 lds
  buffer_load_dwordx4 v174, s[8:11], m0 offen offset:1024 sc1 lds
  buffer_load_dwordx4 v174, s[8:11], m0 offen offset:2048 sc1 lds
  buffer_load_dwordx4 v174, s[8:11], m0 offen offset:3072 sc1 lds
  v_exp_f32 v123, v123
  v_cvt_pk_bf16_f32 v148, v120, v121
  v_exp_f32 v124, v124
  v_cvt_pk_bf16_f32 v149, v122, v123
  v_exp_f32 v125, v125
  v_exp_f32 v126, v126
  v_exp_f32 v127, v127
  v_cvt_pk_bf16_f32 v150, v124, v125
  v_cvt_pk_bf16_f32 v151, v126, v127
  s_cmp_lg_u64 s[92:93], 0
  s_cbranch_scc1 Lnbl_41
Lnbld_43:
  s_barrier
  v_mfma_f32_32x32x16_bf16 v[112:127], a[200:203], v[156:159], 0
  ds_read_b128 a[192:195], v9 offset:30720
  ds_read_b32 a196, v10 offset:30720
  v_exp_f32 v128, v128
  v_exp_f32 v129, v129
  v_exp_f32 v130, v130
  v_exp_f32 v131, v131
  v_mfma_f32_32x32x16_bf16 v[208:223], a[212:215], v[148:151], v[208:223]
  ds_read_b64_tr_b16 a[208:209], v11 offset:30720
  ds_read_b64_tr_b16 a[210:211], v11 offset:30848
  ds_read_b64_tr_b16 a[212:213], v11 offset:30976
  ds_read_b64_tr_b16 a[214:215], v11 offset:31104
  v_cvt_pk_bf16_f32 v144, v128, v129
  v_exp_f32 v132, v132
  v_cvt_pk_bf16_f32 v145, v130, v131
  v_exp_f32 v133, v133
  v_exp_f32 v134, v134
  v_mfma_f32_32x32x8_bf16 v[112:127], a[204:205], v[168:169], v[112:127]
  v_exp_f32 v135, v135
  v_cvt_pk_bf16_f32 v146, v132, v133
  v_exp_f32 v136, v136
  v_cvt_pk_bf16_f32 v147, v134, v135
  v_exp_f32 v137, v137
  v_exp_f32 v138, v138
  v_mfma_f32_32x32x16_bf16 v[224:239], a[216:219], v[144:147], v[224:239]
  v_exp_f32 v139, v139
  v_cvt_pk_bf16_f32 v148, v136, v137
  v_exp_f32 v140, v140
  v_cvt_pk_bf16_f32 v149, v138, v139
  v_exp_f32 v141, v141
  v_exp_f32 v142, v142
  v_exp_f32 v143, v143
  v_cvt_pk_bf16_f32 v150, v140, v141
  v_cvt_pk_bf16_f32 v151, v142, v143
  s_waitcnt lgkmcnt(0)
  v_mfma_f32_32x32x16_bf16 v[128:143], a[192:195], v[160:163], 0
  s_add_u32 m0, s21, 12288
  v_exp_f32 v112, v112
  v_exp_f32 v113, v113
  v_exp_f32 v114, v114
  v_exp_f32 v115, v115
  v_mfma_f32_32x32x16_bf16 v[224:239], a[220:223], v[148:151], v[224:239]
  v_cvt_pk_bf16_f32 v144, v112, v113
  v_exp_f32 v116, v116
  v_cvt_pk_bf16_f32 v145, v114, v115
  v_exp_f32 v117, v117
  v_exp_f32 v118, v118
  v_mfma_f32_32x32x8_bf16 v[128:143], a[196:197], v[170:171], v[128:143]
  v_exp_f32 v119, v119
  v_cvt_pk_bf16_f32 v146, v116, v117
  v_exp_f32 v120, v120
  v_cvt_pk_bf16_f32 v147, v118, v119
  v_exp_f32 v121, v121
  v_exp_f32 v122, v122
  v_mfma_f32_32x32x16_bf16 v[208:223], a[216:219], v[144:147], v[208:223]
  buffer_load_dwordx4 v174, s[8:11], m0 offen offset:0 sc1 lds
  buffer_load_dwordx4 v174, s[8:11], m0 offen offset:1024 sc1 lds
  buffer_load_dwordx4 v174, s[8:11], m0 offen offset:2048 sc1 lds
  buffer_load_dwordx4 v174, s[8:11], m0 offen offset:3072 sc1 lds
  v_exp_f32 v123, v123
  v_cvt_pk_bf16_f32 v148, v120, v121
  v_exp_f32 v124, v124
  v_cvt_pk_bf16_f32 v149, v122, v123
  v_exp_f32 v125, v125
  v_exp_f32 v126, v126
  v_exp_f32 v127, v127
  v_cvt_pk_bf16_f32 v150, v124, v125
  v_cvt_pk_bf16_f32 v151, v126, v127
  v_mfma_f32_32x32x16_bf16 v[112:127], a[192:195], v[156:159], 0
  ds_read_b128 a[200:203], v9 offset:35840
  ds_read_b32 a204, v10 offset:35840
  v_exp_f32 v128, v128
  v_exp_f32 v129, v129
  v_exp_f32 v130, v130
  v_exp_f32 v131, v131
  v_mfma_f32_32x32x16_bf16 v[208:223], a[220:223], v[148:151], v[208:223]
  ds_read_b64_tr_b16 a[216:217], v11 offset:35840
  ds_read_b64_tr_b16 a[218:219], v11 offset:35968
  ds_read_b64_tr_b16 a[220:221], v11 offset:36096
  ds_read_b64_tr_b16 a[222:223], v11 offset:36224
  v_cvt_pk_bf16_f32 v144, v128, v129
  v_exp_f32 v132, v132
  v_cvt_pk_bf16_f32 v145, v130, v131
  v_exp_f32 v133, v133
  v_exp_f32 v134, v134
  v_mfma_f32_32x32x8_bf16 v[112:127], a[196:197], v[168:169], v[112:127]
  v_exp_f32 v135, v135
  v_cvt_pk_bf16_f32 v146, v132, v133
  v_exp_f32 v136, v136
  v_cvt_pk_bf16_f32 v147, v134, v135
  v_exp_f32 v137, v137
  v_exp_f32 v138, v138
  v_mfma_f32_32x32x16_bf16 v[224:239], a[208:211], v[144:147], v[224:239]
  v_exp_f32 v139, v139
  v_cvt_pk_bf16_f32 v148, v136, v137
  v_exp_f32 v140, v140
  v_cvt_pk_bf16_f32 v149, v138, v139
  v_exp_f32 v141, v141
  v_exp_f32 v142, v142
  v_exp_f32 v143, v143
  v_cvt_pk_bf16_f32 v150, v140, v141
  v_cvt_pk_bf16_f32 v151, v142, v143
  s_waitcnt lgkmcnt(0)
  v_mfma_f32_32x32x16_bf16 v[128:143], a[200:203], v[160:163], 0
  s_add_u32 m0, s21, 16384
  v_exp_f32 v112, v112
  v_exp_f32 v113, v113
  v_exp_f32 v114, v114
  v_exp_f32 v115, v115
  v_mfma_f32_32x32x16_bf16 v[224:239], a[212:215], v[148:151], v[224:239]
  v_cvt_pk_bf16_f32 v144, v112, v113
  v_exp_f32 v116, v116
  v_cvt_pk_bf16_f32 v145, v114, v115
  v_exp_f32 v117, v117
  v_exp_f32 v118, v118
  v_mfma_f32_32x32x8_bf16 v[128:143], a[204:205], v[170:171], v[128:143]
  v_exp_f32 v119, v119
  v_cvt_pk_bf16_f32 v146, v116, v117
  v_exp_f32 v120, v120
  v_cvt_pk_bf16_f32 v147, v118, v119
  v_exp_f32 v121, v121
  v_exp_f32 v122, v122
  v_mfma_f32_32x32x16_bf16 v[208:223], a[208:211], v[144:147], v[208:223]
  buffer_load_dwordx4 v174, s[8:11], m0 offen offset:0 sc1 lds
  buffer_load_dwordx4 v174, s[8:11], m0 offen offset:1024 sc1 lds
  buffer_load_dwordx4 v174, s[8:11], m0 offen offset:2048 sc1 lds
  buffer_load_dwordx4 v174, s[8:11], m0 offen offset:3072 sc1 lds
  v_exp_f32 v123, v123
  v_cvt_pk_bf16_f32 v148, v120, v121
  v_exp_f32 v124, v124
  v_cvt_pk_bf16_f32 v149, v122, v123
  v_exp_f32 v125, v125
  v_exp_f32 v126, v126
  v_exp_f32 v127, v127
  v_cvt_pk_bf16_f32 v150, v124, v125
  v_cvt_pk_bf16_f32 v151, v126, v127
  v_mfma_f32_32x32x16_bf16 v[112:127], a[200:203], v[156:159], 0
  ds_read_b128 a[192:195], v9 offset:40960
  ds_read_b32 a196, v10 offset:40960
  v_exp_f32 v128, v128
  v_exp_f32 v129, v129
  v_exp_f32 v130, v130
  v_exp_f32 v131, v131
  v_mfma_f32_32x32x16_bf16 v[208:223], a[212:215], v[148:151], v[208:223]
  ds_read_b64_tr_b16 a[208:209], v11 offset:40960
  ds_read_b64_tr_b16 a[210:211], v11 offset:41088
  ds_read_b64_tr_b16 a[212:213], v11 offset:41216
  ds_read_b64_tr_b16 a[214:215], v11 offset:41344
  v_cvt_pk_bf16_f32 v144, v128, v129
  v_exp_f32 v132, v132
  v_cvt_pk_bf16_f32 v145, v130, v131
  v_exp_f32 v133, v133
  v_exp_f32 v134, v134
  v_mfma_f32_32x32x8_bf16 v[112:127], a[204:205], v[168:169], v[112:127]
  v_exp_f32 v135, v135
  v_cvt_pk_bf16_f32 v146, v132, v133
  v_exp_f32 v136, v136
  v_cvt_pk_bf16_f32 v147, v134, v135
  v_exp_f32 v137, v137
  v_exp_f32 v138, v138
  v_mfma_f32_32x32x16_bf16 v[224:239], a[216:219], v[144:147], v[224:239]
  v_exp_f32 v139, v139
  v_cvt_pk_bf16_f32 v148, v136, v137
  v_exp_f32 v140, v140
  v_cvt_pk_bf16_f32 v149, v138, v139
  v_exp_f32 v141, v141
  v_exp_f32 v142, v142
  v_exp_f32 v143, v143
  v_cvt_pk_bf16_f32 v150, v140, v141
  v_cvt_pk_bf16_f32 v151, v142, v143
  s_waitcnt lgkmcnt(0)
  v_mfma_f32_32x32x16_bf16 v[128:143], a[192:195], v[160:163], v[192:207]
  s_add_u32 m0, s21, 20480
  v_exp_f32 v112, v112
  v_exp_f32 v113, v113
  v_exp_f32 v114, v114
  v_exp_f32 v115, v115
  v_mfma_f32_32x32x16_bf16 v[224:239], a[220:223], v[148:151], v[224:239]
  v_cvt_pk_bf16_f32 v144, v112, v113
  v_exp_f32 v116, v116
  v_cvt_pk_bf16_f32 v145, v114, v115
  v_exp_f32 v117, v117
  v_exp_f32 v118, v118
  v_mfma_f32_32x32x8_bf16 v[128:143], a[196:197], v[170:171], v[128:143]
  v_exp_f32 v119, v119
  v_cvt_pk_bf16_f32 v146, v116, v117
  v_exp_f32 v120, v120
  v_cvt_pk_bf16_f32 v147, v118, v119
  v_exp_f32 v121, v121
  v_exp_f32 v122, v122
  v_mfma_f32_32x32x16_bf16 v[208:223], a[216:219], v[144:147], v[208:223]
  buffer_load_dwordx4 v174, s[8:11], m0 offen offset:0 sc1 lds
  buffer_load_dwordx4 v174, s[8:11], m0 offen offset:1024 sc1 lds
  buffer_load_dwordx4 v174, s[8:11], m0 offen offset:2048 sc1 lds
  buffer_load_dword v165, v46, s[8:11], 0 offen sc1
  buffer_load_dword v165, v47, s[28:31], 0 offen sc1
  v_exp_f32 v123, v123
  v_cvt_pk_bf16_f32 v148, v120, v121
  v_exp_f32 v124, v124
  v_cvt_pk_bf16_f32 v149, v122, v123
  v_exp_f32 v125, v125
  v_exp_f32 v126, v126
  v_exp_f32 v127, v127
  v_cvt_pk_bf16_f32 v150, v124, v125
  v_cvt_pk_bf16_f32 v151, v126, v127
  v_mfma_f32_32x32x16_bf16 v[112:127], a[192:195], v[156:159], 0
  ds_read_b128 a[200:203], v9 offset:46080
  ds_read_b32 a204, v10 offset:46080
  v_exp_f32 v128, v128
  v_exp_f32 v129, v129
  v_exp_f32 v130, v130
  v_exp_f32 v131, v131
  v_mfma_f32_32x32x16_bf16 v[208:223], a[220:223], v[148:151], v[208:223]
  ds_read_b64_tr_b16 a[216:217], v11 offset:46080
  ds_read_b64_tr_b16 a[218:219], v11 offset:46208
  ds_read_b64_tr_b16 a[220:221], v11 offset:46336
  ds_read_b64_tr_b16 a[222:223], v11 offset:46464
  v_cvt_pk_bf16_f32 v144, v128, v129
  v_exp_f32 v132, v132
  v_cvt_pk_bf16_f32 v145, v130, v131
  v_exp_f32 v133, v133
  v_exp_f32 v134, v134
  v_mfma_f32_32x32x8_bf16 v[112:127], a[196:197], v[168:169], v[112:127]
  global_load_dword v165, v[166:167], off sc1
  v_exp_f32 v135, v135
  v_cvt_pk_bf16_f32 v146, v132, v133
  v_exp_f32 v136, v136
  v_cvt_pk_bf16_f32 v147, v134, v135
  v_exp_f32 v137, v137
  v_exp_f32 v138, v138
  v_mfma_f32_32x32x16_bf16 v[224:239], a[208:211], v[144:147], v[224:239]
  v_exp_f32 v139, v139
  v_cvt_pk_bf16_f32 v148, v136, v137
  v_exp_f32 v140, v140
  v_cvt_pk_bf16_f32 v149, v138, v139
  v_exp_f32 v141, v141
  v_exp_f32 v142, v142
  v_exp_f32 v143, v143
  v_cvt_pk_bf16_f32 v150, v140, v141
  v_cvt_pk_bf16_f32 v151, v142, v143
  s_waitcnt lgkmcnt(0)
  v_mfma_f32_32x32x16_bf16 v[128:143], a[200:203], v[156:159], v[192:207]
  v_exp_f32 v112, v112
  v_exp_f32 v113, v113
  v_exp_f32 v114, v114
  v_exp_f32 v115, v115
  v_mfma_f32_32x32x16_bf16 v[224:239], a[212:215], v[148:151], v[224:239]
  v_cvt_pk_bf16_f32 v144, v112, v113
  v_exp_f32 v116, v116
  v_cvt_pk_bf16_f32 v145, v114, v115
  v_exp_f32 v117, v117
  v_exp_f32 v118, v118
  v_mfma_f32_32x32x8_bf16 v[128:143], a[204:205], v[168:169], v[128:143]
  v_exp_f32 v119, v119
  v_cvt_pk_bf16_f32 v146, v116, v117
  v_exp_f32 v120, v120
  v_cvt_pk_bf16_f32 v147, v118, v119
  v_exp_f32 v121, v121
  v_exp_f32 v122, v122
  v_mfma_f32_32x32x16_bf16 v[208:223], a[208:211], v[144:147], v[208:223]
  v_exp_f32 v123, v123
  v_cvt_pk_bf16_f32 v148, v120, v121
  v_exp_f32 v124, v124
  v_cvt_pk_bf16_f32 v149, v122, v123
  v_exp_f32 v125, v125
  v_exp_f32 v126, v126
  v_exp_f32 v127, v127
  v_cvt_pk_bf16_f32 v150, v124, v125
  v_cvt_pk_bf16_f32 v151, v126, v127
  v_rcp_f32 v236, v234
  s_nop 0
  v_pk_mul_f32 v[224:225], v[224:225], v[236:237] op_sel_hi:[1,0]
  v_pk_mul_f32 v[226:227], v[226:227], v[236:237] op_sel_hi:[1,0]
  v_pk_mul_f32 v[228:229], v[228:229], v[236:237] op_sel_hi:[1,0]
  v_pk_mul_f32 v[230:231], v[230:231], v[236:237] op_sel_hi:[1,0]
  v_pk_mul_f32 v[232:233], v[232:233], v[236:237] op_sel_hi:[1,0]
  v_cvt_pk_bf16_f32 v244, v224, v225
  v_cvt_pk_bf16_f32 v245, v226, v227
  v_cvt_pk_bf16_f32 v246, v228, v229
  v_cvt_pk_bf16_f32 v247, v230, v231
  s_cmp_lg_u32 s56, 0
  s_cbranch_scc1 Lsafe_44
  buffer_store_dwordx4 v[244:247], v7, s[8:11], s17 offen
Lback_45:
  v_cvt_pk_bf16_f32 v249, v232, v233
  v_exp_f32 v128, v128
  v_exp_f32 v129, v129
  v_exp_f32 v130, v130
  v_exp_f32 v131, v131
  v_mfma_f32_32x32x16_bf16 v[208:223], a[212:215], v[148:151], v[208:223]
  v_cvt_pk_bf16_f32 v144, v128, v129
  v_exp_f32 v132, v132
  v_cvt_pk_bf16_f32 v145, v130, v131
  v_exp_f32 v133, v133
  v_exp_f32 v134, v134
  v_exp_f32 v135, v135
  v_cvt_pk_bf16_f32 v146, v132, v133
  v_exp_f32 v136, v136
  v_cvt_pk_bf16_f32 v147, v134, v135
  v_exp_f32 v137, v137
  v_exp_f32 v138, v138
  v_mfma_f32_32x32x16_bf16 v[208:223], a[216:219], v[144:147], v[208:223]
  v_exp_f32 v139, v139
  v_cvt_pk_bf16_f32 v148, v136, v137
  v_exp_f32 v140, v140
  v_cvt_pk_bf16_f32 v149, v138, v139
  v_exp_f32 v141, v141
  v_exp_f32 v142, v142
  v_exp_f32 v143, v143
  v_cvt_pk_bf16_f32 v150, v140, v141
  v_cvt_pk_bf16_f32 v151, v142, v143
  s_nop 1
  v_mfma_f32_32x32x16_bf16 v[208:223], a[220:223], v[148:151], v[208:223]
  s_mov_b32 s80, 1509949440
Lslowback_47:
  s_mov_b32 vcc_lo, 0
  s_mov_b32 vcc_hi, -1
  v_lshlrev_b32 v56, 16, v22
  v_and_b32 v57, 0xffff0000, v22
  v_lshlrev_b32 v58, 16, v23
  v_and_b32 v59, 0xffff0000, v23
  v_lshlrev_b32 v60, 16, v24
  v_and_b32 v61, 0xffff0000, v24
  v_lshlrev_b32 v62, 16, v25
  v_and_b32 v63, 0xffff0000, v25
  v_lshlrev_b32 v64, 16, v26
  v_and_b32 v65, 0xffff0000, v26
  v_lshlrev_b32 v66, 16, v27
  v_and_b32 v67, 0xffff0000, v27
  v_lshlrev_b32 v68, 16, v28
  v_and_b32 v69, 0xffff0000, v28
  v_lshlrev_b32 v70, 16, v29
  v_and_b32 v71, 0xffff0000, v29
  v_lshlrev_b32 v72, 16, v30
  v_and_b32 v73, 0xffff0000, v30
  v_lshlrev_b32 v74, 16, v31
  v_and_b32 v75, 0xffff0000, v31
  v_rcp_f32 v220, v218
  s_nop 0
  v_pk_mul_f32 v[208:209], v[208:209], v[220:221] op_sel_hi:[1,0]
  v_pk_mul_f32 v[210:211], v[210:211], v[220:221] op_sel_hi:[1,0]
  v_pk_mul_f32 v[212:213], v[212:213], v[220:221] op_sel_hi:[1,0]
  v_pk_mul_f32 v[214:215], v[214:215], v[220:221] op_sel_hi:[1,0]
  v_pk_mul_f32 v[216:217], v[216:217], v[220:221] op_sel_hi:[1,0]
  v_cvt_pk_bf16_f32 v240, v208, v209
  v_cvt_pk_bf16_f32 v241, v210, v211
  v_cvt_pk_bf16_f32 v242, v212, v213
  v_cvt_pk_bf16_f32 v243, v214, v215
  v_cvt_pk_bf16_f32 v248, v216, v217
  v_cndmask_b32 v248, v248, v249, vcc
  s_cmp_lg_u32 s56, 0
  s_cbranch_scc1 Lsafe_50
  buffer_store_dwordx4 v[240:243], v7, s[8:11], s16 offen
  buffer_store_dword v248, v175, s[8:11], s18 offen
Lback_51:
  v_subrev_u32 v48, 310378496, v218
  v_subrev_u32 v49, 310378496, v234
  v_max_u32 v48, v48, v49
  v_cmp_lt_u32 vcc, s80, v48
  s_cbranch_vccnz Lslow_46
  s_add_u32 s72, s72, 5242880
  s_add_u32 s41, s41, 5242880
  s_add_u32 s42, s42, 5242880
  s_waitcnt vmcnt(6)
  s_barrier
  ds_write_b128 v38, a[0:3] offset:38912
  ds_write_b128 v38, a[4:7] offset:39936
  ds_write_b128 v38, a[8:11] offset:40960
  ds_write_b128 v38, a[12:15] offset:41984
  v_lshlrev_b32 v48, 7, v16
  s_mov_b64 exec, 3
  s_waitcnt vmcnt(0)
  s_cmp_lg_u32 s56, 0
  s_cbranch_scc1 Lsafe_52
  buffer_store_dword v17, v48, s[8:11], s20 offen
Lback_53:
  s_mov_b64 exec, -1
  ds_read_b128 v[76:79], v2 offset:0
  ds_read_b128 v[80:83], v2 offset:1024
  ds_read_b128 v[84:87], v2 offset:2048
  ds_read_b128 v[88:91], v2 offset:3072
  ds_read_b128 v[92:95], v2 offset:4096
  ds_read_b128 v[96:99], v2 offset:5120
  ds_read_b128 v[100:103], v2 offset:6144
  ds_read_b128 v[104:107], v2 offset:7168
  ds_read_b128 v[108:111], v2 offset:8192
  ds_read_b128 v[112:115], v2 offset:9216
  s_mul_i32 s34, s54, 10240
  s_min_u32 s34, s34, 28672
  s_add_u32 s35, s34, 0
  s_add_u32 s34, s34, s38
  s_add_u32 s34, s34, 97280
  s_mov_b32 s32, s70
  buffer_load_dword v165, v39, s[8:11], s71 offen sc1
Lpoll_54:
  s_waitcnt vmcnt(0)
  v_cmp_ne_u32 vcc, s55, v165
  s_nop 0
  s_cmp_lg_u64 vcc, 0
  s_cbranch_scc0 Lpdone_56
  s_cmp_eq_u32 s57, 0
  s_cbranch_scc1 Lpdone_56
  s_sub_u32 s57, s57, 1
  buffer_load_dword v165, v39, s[8:11], s71 offen sc1
  s_branch Lpoll_54
Lpdone_56:
  buffer_load_dwordx4 v[176:179], v1, s[8:11], s32 offen offset:0 sc1
  buffer_load_dwordx4 v[180:183], v1, s[8:11], s32 offen offset:1024 sc1
  buffer_load_dwordx4 v[184:187], v1, s[8:11], s32 offen offset:2048 sc1
  buffer_load_dwordx4 v[188:191], v1, s[8:11], s32 offen offset:3072 sc1
  s_add_u32 s32, s32, 4096
  buffer_load_dwordx4 v[192:195], v1, s[8:11], s32 offen offset:0 sc1
  buffer_load_dwordx4 v[196:199], v1, s[8:11], s32 offen offset:1024 sc1
  s_waitcnt vmcnt(5) lgkmcnt(5)
  v_mfma_f32_16x16x32_bf16 v[56:59], v[76:79], v[176:179], v[56:59]
  ds_read_b128 v[116:119], v2 offset:10240
  buffer_load_dwordx4 v[200:203], v1, s[8:11], s32 offen offset:2048 sc1
  v_mfma_f32_16x16x32_bf16 v[60:63], v[80:83], v[176:179], v[60:63]
  ds_read_b128 v[120:123], v2 offset:11264
  buffer_load_dwordx4 v[204:207], v1, s[8:11], s32 offen offset:3072 sc1
  v_mfma_f32_16x16x32_bf16 v[64:67], v[84:87], v[176:179], v[64:67]
  ds_read_b128 v[124:127], v2 offset:12288
  s_add_u32 s32, s32, 4096
  v_mfma_f32_16x16x32_bf16 v[68:71], v[88:91], v[176:179], v[68:71]
  ds_read_b128 v[128:131], v2 offset:13312
  v_mfma_f32_16x16x32_bf16 v[72:75], v[92:95], v[176:179], v[72:75]
  ds_read_b128 v[132:135], v2 offset:14336
  s_waitcnt vmcnt(6) lgkmcnt(5)
  v_mfma_f32_16x16x32_bf16 v[56:59], v[96:99], v[180:183], v[56:59]
  ds_read_b128 v[76:79], v2 offset:15360
  buffer_load_dwordx4 v[208:211], v1, s[8:11], s32 offen offset:0 sc1
  v_mfma_f32_16x16x32_bf16 v[60:63], v[100:103], v[180:183], v[60:63]
  ds_read_b128 v[80:83], v2 offset:16384
  buffer_load_dwordx4 v[212:215], v1, s[8:11], s32 offen offset:1024 sc1
  v_mfma_f32_16x16x32_bf16 v[64:67], v[104:107], v[180:183], v[64:67]
  ds_read_b128 v[84:87], v2 offset:17408
  v_mfma_f32_16x16x32_bf16 v[68:71], v[108:111], v[180:183], v[68:71]
  ds_read_b128 v[88:91], v2 offset:18432
  v_mfma_f32_16x16x32_bf16 v[72:75], v[112:115], v[180:183], v[72:75]
  ds_read_b128 v[92:95], v2 offset:19456
  s_waitcnt vmcnt(7) lgkmcnt(5)
  v_mfma_f32_16x16x32_bf16 v[56:59], v[116:119], v[184:187], v[56:59]
  ds_read_b128 v[96:99], v2 offset:20480
  buffer_load_dwordx4 v[216:219], v1, s[8:11], s32 offen offset:2048 sc1
  v_mfma_f32_16x16x32_bf16 v[60:63], v[120:123], v[184:187], v[60:63]
  ds_read_b128 v[100:103], v2 offset:21504
  v_mfma_f32_16x16x32_bf16 v[64:67], v[124:127], v[184:187], v[64:67]
  ds_read_b128 v[104:107], v2 offset:22528
  v_mfma_f32_16x16x32_bf16 v[68:71], v[128:131], v[184:187], v[68:71]
  ds_read_b128 v[108:111], v2 offset:23552
  v_mfma_f32_16x16x32_bf16 v[72:75], v[132:135], v[184:187], v[72:75]
  ds_read_b128 v[112:115], v2 offset:24576
  s_waitcnt vmcnt(7) lgkmcnt(5)
  v_mfma_f32_16x16x32_bf16 v[56:59], v[76:79], v[188:191], v[56:59]
  ds_read_b128 v[116:119], v2 offset:25600
  buffer_load_dwordx4 v[220:223], v1, s[8:11], s32 offen offset:3072 sc1
  v_mfma_f32_16x16x32_bf16 v[60:63], v[80:83], v[188:191], v[60:63]
  ds_read_b128 v[120:123], v2 offset:26624
  s_add_u32 s32, s32, 4096
  v_mfma_f32_16x16x32_bf16 v[64:67], v[84:87], v[188:191], v[64:67]
  ds_read_b128 v[124:127], v2 offset:27648
  buffer_load_dwordx4 v[224:227], v1, s[8:11], s32 offen offset:0 sc1
  v_mfma_f32_16x16x32_bf16 v[68:71], v[88:91], v[188:191], v[68:71]
  ds_read_b128 v[128:131], v2 offset:28672
  v_mfma_f32_16x16x32_bf16 v[72:75], v[92:95], v[188:191], v[72:75]
  ds_read_b128 v[132:135], v2 offset:29696
  s_waitcnt vmcnt(8) lgkmcnt(5)
  v_mfma_f32_16x16x32_bf16 v[56:59], v[96:99], v[192:195], v[56:59]
  ds_read_b128 v[76:79], v2 offset:30720
  buffer_load_dwordx4 v[228:231], v1, s[8:11], s32 offen offset:1024 sc1
  v_mfma_f32_16x16x32_bf16 v[60:63], v[100:103], v[192:195], v[60:63]
  ds_read_b128 v[80:83], v2 offset:31744
  v_mfma_f32_16x16x32_bf16 v[64:67], v[104:107], v[192:195], v[64:67]
  ds_read_b128 v[84:87], v2 offset:32768
  v_mfma_f32_16x16x32_bf16 v[68:71], v[108:111], v[192:195], v[68:71]
  ds_read_b128 v[88:91], v2 offset:33792
  v_mfma_f32_16x16x32_bf16 v[72:75], v[112:115], v[192:195], v[72:75]
  ds_read_b128 v[92:95], v2 offset:34816
  s_waitcnt vmcnt(8) lgkmcnt(5)
  v_mfma_f32_16x16x32_bf16 v[56:59], v[116:119], v[196:199], v[56:59]
  ds_read_b128 v[96:99], v2 offset:35840
  buffer_load_dwordx4 v[232:235], v1, s[8:11], s32 offen offset:2048 sc1
  v_mfma_f32_16x16x32_bf16 v[60:63], v[120:123], v[196:199], v[60:63]
  ds_read_b128 v[100:103], v2 offset:36864
  buffer_load_dwordx4 v[236:239], v1, s[8:11], s32 offen offset:3072 sc1
  v_mfma_f32_16x16x32_bf16 v[64:67], v[124:127], v[196:199], v[64:67]
  ds_read_b128 v[104:107], v2 offset:37888
  s_add_u32 s32, s32, 4096
  v_mfma_f32_16x16x32_bf16 v[68:71], v[128:131], v[196:199], v[68:71]
  ds_read_b128 v[108:111], v2 offset:38912
  v_mfma_f32_16x16x32_bf16 v[72:75], v[132:135], v[196:199], v[72:75]
  ds_read_b128 v[112:115], v2 offset:39936
  s_waitcnt vmcnt(9) lgkmcnt(5)
  v_mfma_f32_16x16x32_bf16 v[56:59], v[76:79], v[200:203], v[56:59]
  ds_read_b128 v[116:119], v2 offset:40960
  buffer_load_dwordx4 v[240:243], v1, s[8:11], s32 offen offset:0 sc1
  v_mfma_f32_16x16x32_bf16 v[60:63], v[80:83], v[200:203], v[60:63]
  ds_read_b128 v[120:123], v2 offset:41984
  v_mfma_f32_16x16x32_bf16 v[64:67], v[84:87], v[200:203], v[64:67]
  ds_read_b128 v[124:127], v2 offset:43008
  v_mfma_f32_16x16x32_bf16 v[68:71], v[88:91], v[200:203], v[68:71]
  ds_read_b128 v[128:131], v2 offset:44032
  v_mfma_f32_16x16x32_bf16 v[72:75], v[92:95], v[200:203], v[72:75]
  ds_read_b128 v[132:135], v2 offset:45056
  s_waitcnt vmcnt(9) lgkmcnt(5)
  v_mfma_f32_16x16x32_bf16 v[56:59], v[96:99], v[204:207], v[56:59]
  ds_read_b128 v[76:79], v2 offset:46080
  buffer_load_dwordx4 v[244:247], v1, s[8:11], s32 offen offset:1024 sc1
  v_mfma_f32_16x16x32_bf16 v[60:63], v[100:103], v[204:207], v[60:63]
  ds_read_b128 v[80:83], v2 offset:47104
  v_mfma_f32_16x16x32_bf16 v[64:67], v[104:107], v[204:207], v[64:67]
  ds_read_b128 v[84:87], v2 offset:48128
  v_mfma_f32_16x16x32_bf16 v[68:71], v[108:111], v[204:207], v[68:71]
  ds_read_b128 v[88:91], v2 offset:49152
  v_mfma_f32_16x16x32_bf16 v[72:75], v[112:115], v[204:207], v[72:75]
  ds_read_b128 v[92:95], v2 offset:50176
  s_waitcnt vmcnt(9) lgkmcnt(5)
  v_mfma_f32_16x16x32_bf16 v[56:59], v[116:119], v[208:211], v[56:59]
  ds_read_b128 v[96:99], v2 offset:51200
  v_mfma_f32_16x16x32_bf16 v[60:63], v[120:123], v[208:211], v[60:63]
  ds_read_b128 v[100:103], v2 offset:52224
  v_mfma_f32_16x16x32_bf16 v[64:67], v[124:127], v[208:211], v[64:67]
  ds_read_b128 v[104:107], v2 offset:53248
  v_mfma_f32_16x16x32_bf16 v[68:71], v[128:131], v[208:211], v[68:71]
  ds_read_b128 v[108:111], v2 offset:54272
  v_mfma_f32_16x16x32_bf16 v[72:75], v[132:135], v[208:211], v[72:75]
  ds_read_b128 v[112:115], v2 offset:55296
  s_waitcnt vmcnt(8) lgkmcnt(5)
  v_mfma_f32_16x16x32_bf16 v[56:59], v[76:79], v[212:215], v[56:59]
  ds_read_b128 v[116:119], v2 offset:56320
  s_add_u32 m0, s35, 0
  v_mfma_f32_16x16x32_bf16 v[60:63], v[80:83], v[212:215], v[60:63]
  ds_read_b128 v[120:123], v2 offset:57344
  v_mfma_f32_16x16x32_bf16 v[64:67], v[84:87], v[212:215], v[64:67]
  ds_read_b128 v[124:127], v2 offset:58368
  v_mfma_f32_16x16x32_bf16 v[68:71], v[88:91], v[212:215], v[68:71]
  ds_read_b128 v[128:131], v2 offset:59392
  v_mfma_f32_16x16x32_bf16 v[72:75], v[92:95], v[212:215], v[72:75]
  ds_read_b128 v[132:135], v2 offset:60416
  s_waitcnt vmcnt(7) lgkmcnt(5)
  v_mfma_f32_16x16x32_bf16 v[56:59], v[96:99], v[216:219], v[56:59]
  ds_read_b128 v[76:79], v2 offset:61440
  buffer_load_dwordx4 v1, s[8:11], s34 offen offset:0 sc1 lds
  v_mfma_f32_16x16x32_bf16 v[60:63], v[100:103], v[216:219], v[60:63]
  ds_read_b128 v[80:83], v2 offset:62464
  buffer_load_dwordx4 v1, s[8:11], s34 offen offset:1024 sc1 lds
  v_mfma_f32_16x16x32_bf16 v[64:67], v[104:107], v[216:219], v[64:67]
  ds_read_b128 v[84:87], v2 offset:63488
  v_mfma_f32_16x16x32_bf16 v[68:71], v[108:111], v[216:219], v[68:71]
  ds_read_b128 v[88:91], v2 offset:64512
  v_mfma_f32_16x16x32_bf16 v[72:75], v[112:115], v[216:219], v[72:75]
  ds_read_b128 v[92:95], v18 offset:0
  s_waitcnt vmcnt(8) lgkmcnt(5)
  v_mfma_f32_16x16x32_bf16 v[56:59], v[116:119], v[220:223], v[56:59]
  ds_read_b128 v[96:99], v18 offset:1024
  buffer_load_dwordx4 v1, s[8:11], s34 offen offset:2048 sc1 lds
  v_mfma_f32_16x16x32_bf16 v[60:63], v[120:123], v[220:223], v[60:63]
  ds_read_b128 v[100:103], v18 offset:2048
  buffer_load_dwordx4 v1, s[8:11], s34 offen offset:3072 sc1 lds
  v_mfma_f32_16x16x32_bf16 v[64:67], v[124:127], v[220:223], v[64:67]
  ds_read_b128 v[104:107], v18 offset:3072
  s_add_u32 s34, s34, 4096
  v_mfma_f32_16x16x32_bf16 v[68:71], v[128:131], v[220:223], v[68:71]
  ds_read_b128 v[108:111], v18 offset:4096
  s_add_u32 m0, s35, 4096
  v_mfma_f32_16x16x32_bf16 v[72:75], v[132:135], v[220:223], v[72:75]
  ds_read_b128 v[112:115], v18 offset:5120
  s_waitcnt vmcnt(9) lgkmcnt(5)
  v_mfma_f32_16x16x32_bf16 v[56:59], v[76:79], v[224:227], v[56:59]
  ds_read_b128 v[116:119], v18 offset:6144
  buffer_load_dwordx4 v1, s[8:11], s34 offen offset:0 sc1 lds
  v_mfma_f32_16x16x32_bf16 v[60:63], v[80:83], v[224:227], v[60:63]
  ds_read_b128 v[120:123], v18 offset:7168
  buffer_load_dwordx4 v1, s[8:11], s34 offen offset:1024 sc1 lds
  v_mfma_f32_16x16x32_bf16 v[64:67], v[84:87], v[224:227], v[64:67]
  ds_read_b128 v[124:127], v18 offset:8192
  v_mfma_f32_16x16x32_bf16 v[68:71], v[88:91], v[224:227], v[68:71]
  ds_read_b128 v[128:131], v18 offset:9216
  v_mfma_f32_16x16x32_bf16 v[72:75], v[92:95], v[224:227], v[72:75]
  ds_read_b128 v[132:135], v18 offset:10240
  s_waitcnt vmcnt(10) lgkmcnt(5)
  v_mfma_f32_16x16x32_bf16 v[56:59], v[96:99], v[228:231], v[56:59]
  ds_read_b128 v[76:79], v18 offset:11264
  v_mfma_f32_16x16x32_bf16 v[60:63], v[100:103], v[228:231], v[60:63]
  ds_read_b128 v[80:83], v18 offset:12288
  v_mfma_f32_16x16x32_bf16 v[64:67], v[104:107], v[228:231], v[64:67]
  ds_read_b128 v[84:87], v18 offset:13312
  v_mfma_f32_16x16x32_bf16 v[68:71], v[108:111], v[228:231], v[68:71]
  ds_read_b128 v[88:91], v18 offset:14336
  v_mfma_f32_16x16x32_bf16 v[72:75], v[112:115], v[228:231], v[72:75]
  ds_read_b128 v[92:95], v18 offset:15360
  s_waitcnt vmcnt(9) lgkmcnt(5)
  v_mfma_f32_16x16x32_bf16 v[56:59], v[116:119], v[232:235], v[56:59]
  ds_read_b128 v[96:99], v18 offset:16384
  v_mfma_f32_16x16x32_bf16 v[60:63], v[120:123], v[232:235], v[60:63]
  ds_read_b128 v[100:103], v18 offset:17408
  v_mfma_f32_16x16x32_bf16 v[64:67], v[124:127], v[232:235], v[64:67]
  ds_read_b128 v[104:107], v18 offset:18432
  v_mfma_f32_16x16x32_bf16 v[68:71], v[128:131], v[232:235], v[68:71]
  ds_read_b128 v[108:111], v18 offset:19456
  v_mfma_f32_16x16x32_bf16 v[72:75], v[132:135], v[232:235], v[72:75]
  ds_read_b128 v[112:115], v18 offset:20480
  s_waitcnt vmcnt(8) lgkmcnt(5)
  v_mfma_f32_16x16x32_bf16 v[56:59], v[76:79], v[236:239], v[56:59]
  ds_read_b128 v[116:119], v18 offset:21504
  v_mfma_f32_16x16x32_bf16 v[60:63], v[80:83], v[236:239], v[60:63]
  ds_read_b128 v[120:123], v18 offset:22528
  v_mfma_f32_16x16x32_bf16 v[64:67], v[84:87], v[236:239], v[64:67]
  ds_read_b128 v[124:127], v18 offset:23552
  v_mfma_f32_16x16x32_bf16 v[68:71], v[88:91], v[236:239], v[68:71]
  ds_read_b128 v[128:131], v18 offset:24576
  v_mfma_f32_16x16x32_bf16 v[72:75], v[92:95], v[236:239], v[72:75]
  ds_read_b128 v[132:135], v18 offset:25600
  s_waitcnt vmcnt(7) lgkmcnt(5)
  v_mfma_f32_16x16x32_bf16 v[56:59], v[96:99], v[240:243], v[56:59]
  v_mfma_f32_16x16x32_bf16 v[60:63], v[100:103], v[240:243], v[60:63]
  v_mfma_f32_16x16x32_bf16 v[64:67], v[104:107], v[240:243], v[64:67]
  v_mfma_f32_16x16x32_bf16 v[68:71], v[108:111], v[240:243], v[68:71]
  v_mfma_f32_16x16x32_bf16 v[72:75], v[112:115], v[240:243], v[72:75]
  s_waitcnt vmcnt(6) lgkmcnt(0)
  v_mfma_f32_16x16x32_bf16 v[56:59], v[116:119], v[244:247], v[56:59]
  v_mfma_f32_16x16x32_bf16 v[60:63], v[120:123], v[244:247], v[60:63]
  v_mfma_f32_16x16x32_bf16 v[64:67], v[124:127], v[244:247], v[64:67]
  v_mfma_f32_16x16x32_bf16 v[68:71], v[128:131], v[244:247], v[68:71]
  v_mfma_f32_16x16x32_bf16 v[72:75], v[132:135], v[244:247], v[72:75]
  s_add_u32 s55, s55, 1
  v_mov_b32 v17, s55
  s_nop 1
  v_cvt_pk_bf16_f32 v22, v56, v57
  v_cvt_pk_bf16_f32 v23, v58, v59
  v_cvt_pk_bf16_f32 v24, v60, v61
  v_cvt_pk_bf16_f32 v25, v62, v63
  v_cvt_pk_bf16_f32 v26, v64, v65
  v_cvt_pk_bf16_f32 v27, v66, v67
  v_cvt_pk_bf16_f32 v28, v68, v69
  v_cvt_pk_bf16_f32 v29, v70, v71
  v_cvt_pk_bf16_f32 v30, v72, v73
  v_cvt_pk_bf16_f32 v31, v74, v75
  s_cmp_lg_u32 s56, 0
  s_cbranch_scc1 Lsafe_58
  buffer_store_dwordx4 v[22:25], v1, s[28:31], s64 offen
  buffer_store_dwordx4 v[26:29], v1, s[28:31], s64 offen offset:2048
  buffer_store_dwordx2 v[30:31], v5, s[28:31], s65 offen
Lback_59:
  v_mov_b32 v52, 0
  v_mov_b32 v53, 0
  v_mov_b32 v54, 0x3f803f80
  v_dot2c_f32_bf16 v52, v22, v54
  v_dot2c_f32_bf16 v53, v22, v22
  v_dot2c_f32_bf16 v52, v23, v54
  v_dot2c_f32_bf16 v53, v23, v23
  v_dot2c_f32_bf16 v52, v24, v54
  v_dot2c_f32_bf16 v53, v24, v24
  v_dot2c_f32_bf16 v52, v25, v54
  v_dot2c_f32_bf16 v53, v25, v25
  v_dot2c_f32_bf16 v52, v26, v54
  v_dot2c_f32_bf16 v53, v26, v26
  v_dot2c_f32_bf16 v52, v27, v54
  v_dot2c_f32_bf16 v53, v27, v27
  v_dot2c_f32_bf16 v52, v28, v54
  v_dot2c_f32_bf16 v53, v28, v28
  v_dot2c_f32_bf16 v52, v29, v54
  v_dot2c_f32_bf16 v53, v29, v29
  v_dot2c_f32_bf16 v52, v30, v54
  v_dot2c_f32_bf16 v53, v30, v30
  v_dot2c_f32_bf16 v52, v31, v54
  v_dot2c_f32_bf16 v53, v31, v31
  s_nop 2
  v_mov_b32 v54, v52
  v_mov_b32 v55, v53
  s_nop 0
  v_permlane32_swap_b32 v54, v52
  v_permlane32_swap_b32 v55, v53
  v_add_f32 v52, v52, v54
  v_add_f32 v53, v53, v55
  v_mov_b32 v54, v52
  v_mov_b32 v55, v53
  s_nop 0
  v_permlane16_swap_b32 v54, v52
  v_permlane16_swap_b32 v55, v53
  v_add_f32 v52, v52, v54
  v_add_f32 v53, v53, v55
  v_mov_b32 v54, s55
  s_waitcnt vmcnt(0)
  s_cmp_lg_u32 s56, 0
  s_cbranch_scc1 Lsafe_60
  buffer_store_dwordx4 v[52:55], v6, s[8:11], s66 offen
Lback_61:
  s_barrier
  ds_read2st64_b32 v[112:113], v44 offset0:152 offset1:153
  ds_read2st64_b32 v[114:115], v44 offset0:154 offset1:155
  ds_read2st64_b32 v[116:117], v44 offset0:156 offset1:157
  ds_read2st64_b32 v[118:119], v44 offset0:158 offset1:159
  ds_read2st64_b32 v[120:121], v44 offset0:160 offset1:161
  ds_read2st64_b32 v[122:123], v44 offset0:162 offset1:163
  ds_read2st64_b32 v[124:125], v44 offset0:164 offset1:165
  ds_read2st64_b32 v[126:127], v44 offset0:166 offset1:167
  ds_read2st64_b32 v[128:129], v44 offset0:168 offset1:169
  ds_read2st64_b32 v[130:131], v44 offset0:170 offset1:171
  ds_write_b128 v38, a[16:19] offset:55296
  buffer_load_dwordx4 v[96:99], v4, s[8:11], s63 offen offset:0 sc1
  buffer_load_dwordx4 v[100:103], v4, s[8:11], s63 offen offset:2048 sc1
  buffer_load_dwordx4 v[104:107], v4, s[8:11], s63 offen offset:256 sc1
  buffer_load_dwordx4 v[108:111], v4, s[8:11], s63 offen offset:2304 sc1
  ds_write_b128 v38, a[20:23] offset:56320
  ds_write_b128 v38, a[24:27] offset:57344
  ds_write_b128 v38, a[28:31] offset:58368
  ds_write_b128 v42, a[32:35] offset:6144
  ds_write_b128 v42, a[36:39] offset:7168
  ds_write_b128 v42, a[40:43] offset:8192
  ds_write_b128 v42, a[44:47] offset:9216
  s_mul_i32 s36, s54, 5120
  s_min_u32 s36, s36, 15360
  s_add_u32 s37, s36, 137216
  s_add_u32 s36, s36, s39
  s_add_u32 s36, s36, 71680
  s_mov_b32 s32, s62
  s_waitcnt lgkmcnt(0)
  s_barrier
Lpoll_62:
  s_waitcnt vmcnt(0)
  v_cmp_ne_u32 s[86:87], s55, v98
  v_cmp_ne_u32 s[88:89], s55, v102
  v_cmp_ne_u32 s[90:91], s55, v106
  v_cmp_ne_u32 s[92:93], s55, v110
  s_or_b64 s[86:87], s[86:87], s[88:89]
  s_or_b64 s[90:91], s[90:91], s[92:93]
  s_or_b64 s[86:87], s[86:87], s[90:91]
  s_cbranch_scc0 Lpdone_64
  s_cmp_eq_u32 s57, 0
  s_cbranch_scc1 Lpdone_64
  s_sub_u32 s57, s57, 1
  buffer_load_dwordx4 v[96:99], v4, s[8:11], s63 offen offset:0 sc1
  buffer_load_dwordx4 v[100:103], v4, s[8:11], s63 offen offset:2048 sc1
  buffer_load_dwordx4 v[104:107], v4, s[8:11], s63 offen offset:256 sc1
  buffer_load_dwordx4 v[108:111], v4, s[8:11], s63 offen offset:2304 sc1
  s_branch Lpoll_62
Lpdone_64:
  buffer_load_dwordx4 v[176:179], v1, s[28:31], s32 offen offset:0 sc1
  v_add_f32 v96, v96, v100
  v_add_f32 v97, v97, v101
  v_add_f32 v104, v104, v108
  v_add_f32 v105, v105, v109
  v_mov_b32 v98, v96
  v_mov_b32 v99, v104
  s_nop 0
  v_permlane32_swap_b32 v98, v96
  v_permlane32_swap_b32 v99, v104
  v_add_f32 v96, v96, v98
  buffer_load_dwordx4 v[180:183], v1, s[28:31], s32 offen offset:1024 sc1
  v_add_f32 v104, v104, v99
  v_mov_b32 v98, v96
  v_mov_b32 v99, v104
  s_nop 0
  v_permlane16_swap_b32 v98, v96
  v_permlane16_swap_b32 v99, v104
  v_add_f32 v96, v96, v98
  v_add_f32 v104, v104, v99
  v_mul_f32 v96, 0xbae38e39, v96
  v_mul_f32 v104, 0xbae38e39, v104
  buffer_load_dwordx4 v[184:187], v1, s[28:31], s32 offen offset:2048 sc1
  v_cvt_pk_bf16_f32 v156, v96, v96
  v_cvt_pk_bf16_f32 v160, v104, v104
  v_cndmask_b32 v157, 0, v156, s[46:47]
  v_cndmask_b32 v158, 0, v156, s[46:47]
  v_cndmask_b32 v159, 0, v156, s[46:47]
  v_cndmask_b32 v156, 0, v156, s[46:47]
  v_cndmask_b32 v161, 0, v160, s[46:47]
  v_cndmask_b32 v162, 0, v160, s[46:47]
  v_cndmask_b32 v163, 0, v160, s[46:47]
  v_cndmask_b32 v160, 0, v160, s[46:47]
  buffer_load_dwordx4 v[188:191], v1, s[28:31], s32 offen offset:3072 sc1
  ds_read_b128 v[132:135], v1 offset:44032
  s_waitcnt lgkmcnt(15)
  v_mfma_f32_16x16x32_bf16 v[56:59], v[112:115], v[156:159], 0
  s_add_u32 s32, s32, 4096
  v_mfma_f32_16x16x32_bf16 v[60:63], v[112:115], v[160:163], 0
  ds_read_b128 v[112:115], v1 offset:45056
  s_waitcnt lgkmcnt(15)
  v_mfma_f32_16x16x32_bf16 v[64:67], v[116:119], v[156:159], 0
  buffer_load_dwordx4 v[192:195], v1, s[28:31], s32 offen offset:0 sc1
  v_mfma_f32_16x16x32_bf16 v[68:71], v[116:119], v[160:163], 0
  ds_read_b128 v[116:119], v1 offset:46080
  s_waitcnt lgkmcnt(15)
  v_mfma_f32_16x16x32_bf16 v[72:75], v[120:123], v[156:159], 0
  buffer_load_dwordx4 v[196:199], v1, s[28:31], s32 offen offset:1024 sc1
  v_mfma_f32_16x16x32_bf16 v[76:79], v[120:123], v[160:163], 0
  ds_read_b128 v[120:123], v1 offset:47104
  s_waitcnt lgkmcnt(14)
  v_mfma_f32_16x16x32_bf16 v[80:83], v[124:127], v[156:159], 0
  v_mfma_f32_16x16x32_bf16 v[84:87], v[124:127], v[160:163], 0
  ds_read_b128 v[124:127], v1 offset:48128
  s_waitcnt lgkmcnt(13)
  v_mfma_f32_16x16x32_bf16 v[88:91], v[128:131], v[156:159], 0
  buffer_load_dwordx4 v[200:203], v1, s[28:31], s32 offen offset:2048 sc1
  v_mfma_f32_16x16x32_bf16 v[92:95], v[128:131], v[160:163], 0
  ds_read_b128 v[128:131], v1 offset:49152
  s_waitcnt vmcnt(5) lgkmcnt(5)
  v_mfma_f32_16x16x32_bf16 v[56:59], v[132:135], v[176:179], v[56:59]
  v_mfma_f32_16x16x32_bf16 v[60:63], v[132:135], v[180:183], v[60:63]
  ds_read_b128 v[132:135], v1 offset:50176
  s_waitcnt lgkmcnt(5)
  v_mfma_f32_16x16x32_bf16 v[64:67], v[112:115], v[176:179], v[64:67]
  buffer_load_dwordx4 v[204:207], v1, s[28:31], s32 offen offset:3072 sc1
  s_add_u32 s32, s32, 4096
  v_mfma_f32_16x16x32_bf16 v[68:71], v[112:115], v[180:183], v[68:71]
  ds_read_b128 v[112:115], v1 offset:51200
  s_waitcnt lgkmcnt(5)
  v_mfma_f32_16x16x32_bf16 v[72:75], v[116:119], v[176:179], v[72:75]
  buffer_load_dwordx4 v[208:211], v1, s[28:31], s32 offen offset:0 sc1
  v_mfma_f32_16x16x32_bf16 v[76:79], v[116:119], v[180:183], v[76:79]
  ds_read_b128 v[116:119], v1 offset:52224
  s_waitcnt lgkmcnt(5)
  v_mfma_f32_16x16x32_bf16 v[80:83], v[120:123], v[176:179], v[80:83]
  ds_write_b128 v42, a[48:51] offset:22528
  v_mfma_f32_16x16x32_bf16 v[84:87], v[120:123], v[180:183], v[84:87]
  ds_read_b128 v[120:123], v1 offset:53248
  s_waitcnt lgkmcnt(6)
  v_mfma_f32_16x16x32_bf16 v[88:91], v[124:127], v[176:179], v[88:91]
  buffer_load_dwordx4 v[212:215], v1, s[28:31], s32 offen offset:1024 sc1
  v_mfma_f32_16x16x32_bf16 v[92:95], v[124:127], v[180:183], v[92:95]
  ds_read_b128 v[124:127], v1 offset:54272
  s_waitcnt vmcnt(6) lgkmcnt(6)
  v_mfma_f32_16x16x32_bf16 v[56:59], v[128:131], v[184:187], v[56:59]
  ds_write_b128 v42, a[52:55] offset:23552
  v_mfma_f32_16x16x32_bf16 v[60:63], v[128:131], v[188:191], v[60:63]
  ds_read_b128 v[128:131], v1 offset:55296
  s_waitcnt lgkmcnt(7)
  v_mfma_f32_16x16x32_bf16 v[64:67], v[132:135], v[184:187], v[64:67]
  buffer_load_dwordx4 v[216:219], v1, s[28:31], s32 offen offset:2048 sc1
  v_mfma_f32_16x16x32_bf16 v[68:71], v[132:135], v[188:191], v[68:71]
  ds_read_b128 v[132:135], v1 offset:56320
  s_waitcnt lgkmcnt(7)
  v_mfma_f32_16x16x32_bf16 v[72:75], v[112:115], v[184:187], v[72:75]
  buffer_load_dwordx4 v[220:223], v1, s[28:31], s32 offen offset:3072 sc1
  s_add_u32 s32, s32, 4096
  v_mfma_f32_16x16x32_bf16 v[76:79], v[112:115], v[188:191], v[76:79]
  ds_read_b128 v[112:115], v1 offset:57344
  s_waitcnt lgkmcnt(7)
  v_mfma_f32_16x16x32_bf16 v[80:83], v[116:119], v[184:187], v[80:83]
  ds_write_b128 v42, a[56:59] offset:24576
  v_mfma_f32_16x16x32_bf16 v[84:87], v[116:119], v[188:191], v[84:87]
  ds_read_b128 v[116:119], v1 offset:58368
  s_waitcnt lgkmcnt(7)
  v_mfma_f32_16x16x32_bf16 v[88:91], v[120:123], v[184:187], v[88:91]
  buffer_load_dwordx4 v[224:227], v1, s[28:31], s32 offen offset:0 sc1
  v_mfma_f32_16x16x32_bf16 v[92:95], v[120:123], v[188:191], v[92:95]
  ds_read_b128 v[120:123], v1 offset:59392
  s_waitcnt vmcnt(7) lgkmcnt(7)
  v_mfma_f32_16x16x32_bf16 v[56:59], v[124:127], v[192:195], v[56:59]
  ds_write_b128 v42, a[60:63] offset:25600
  v_mfma_f32_16x16x32_bf16 v[60:63], v[124:127], v[196:199], v[60:63]
  ds_read_b128 v[124:127], v1 offset:60416
  s_waitcnt lgkmcnt(7)
  v_mfma_f32_16x16x32_bf16 v[64:67], v[128:131], v[192:195], v[64:67]
  buffer_load_dwordx4 v[228:231], v1, s[28:31], s32 offen offset:1024 sc1
  v_mfma_f32_16x16x32_bf16 v[68:71], v[128:131], v[196:199], v[68:71]
  ds_read_b128 v[128:131], v1 offset:61440
  s_waitcnt lgkmcnt(7)
  v_mfma_f32_16x16x32_bf16 v[72:75], v[132:135], v[192:195], v[72:75]
  ds_write_b128 v42, a[64:67] offset:38912
  v_mfma_f32_16x16x32_bf16 v[76:79], v[132:135], v[196:199], v[76:79]
  ds_read_b128 v[132:135], v1 offset:62464
  s_waitcnt lgkmcnt(8)
  v_mfma_f32_16x16x32_bf16 v[80:83], v[112:115], v[192:195], v[80:83]
  buffer_load_dwordx4 v[232:235], v1, s[28:31], s32 offen offset:2048 sc1
  v_mfma_f32_16x16x32_bf16 v[84:87], v[112:115], v[196:199], v[84:87]
  ds_read_b128 v[112:115], v1 offset:63488
  s_waitcnt lgkmcnt(7)
  v_mfma_f32_16x16x32_bf16 v[88:91], v[116:119], v[192:195], v[88:91]
  buffer_load_dwordx4 v[236:239], v1, s[28:31], s32 offen offset:3072 sc1
  s_add_u32 s32, s32, 4096
  v_mfma_f32_16x16x32_bf16 v[92:95], v[116:119], v[196:199], v[92:95]
  ds_read_b128 v[116:119], v1 offset:64512
  s_waitcnt vmcnt(8) lgkmcnt(7)
  v_mfma_f32_16x16x32_bf16 v[56:59], v[120:123], v[200:203], v[56:59]
  ds_write_b128 v42, a[68:71] offset:39936
  v_mfma_f32_16x16x32_bf16 v[60:63], v[120:123], v[204:207], v[60:63]
  ds_read_b128 v[120:123], v2 offset:0
  s_waitcnt lgkmcnt(7)
  v_mfma_f32_16x16x32_bf16 v[64:67], v[124:127], v[200:203], v[64:67]
  buffer_load_dwordx4 v[240:243], v1, s[28:31], s32 offen offset:0 sc1
  v_mfma_f32_16x16x32_bf16 v[68:71], v[124:127], v[204:207], v[68:71]
  ds_read_b128 v[124:127], v2 offset:1024
  s_waitcnt lgkmcnt(7)
  v_mfma_f32_16x16x32_bf16 v[72:75], v[128:131], v[200:203], v[72:75]
  v_mfma_f32_16x16x32_bf16 v[76:79], v[128:131], v[204:207], v[76:79]
  ds_read_b128 v[128:131], v2 offset:2048
  s_waitcnt lgkmcnt(6)
  v_mfma_f32_16x16x32_bf16 v[80:83], v[132:135], v[200:203], v[80:83]
  buffer_load_dwordx4 v[244:247], v1, s[28:31], s32 offen offset:1024 sc1
  v_mfma_f32_16x16x32_bf16 v[84:87], v[132:135], v[204:207], v[84:87]
  ds_read_b128 v[132:135], v2 offset:3072
  s_waitcnt lgkmcnt(6)
  v_mfma_f32_16x16x32_bf16 v[88:91], v[112:115], v[200:203], v[88:91]
  buffer_load_dwordx4 v[248:251], v1, s[28:31], s32 offen offset:2048 sc1
  v_mfma_f32_16x16x32_bf16 v[92:95], v[112:115], v[204:207], v[92:95]
  ds_read_b128 v[112:115], v2 offset:4096
  s_waitcnt vmcnt(9) lgkmcnt(6)
  v_mfma_f32_16x16x32_bf16 v[56:59], v[116:119], v[208:211], v[56:59]
  ds_write_b128 v42, a[72:75] offset:40960
  v_mfma_f32_16x16x32_bf16 v[60:63], v[116:119], v[212:215], v[60:63]
  ds_read_b128 v[116:119], v2 offset:5120
  s_waitcnt lgkmcnt(6)
  v_mfma_f32_16x16x32_bf16 v[64:67], v[120:123], v[208:211], v[64:67]
  buffer_load_dwordx4 v[252:255], v1, s[28:31], s32 offen offset:3072 sc1
  s_add_u32 s32, s32, 4096
  v_mfma_f32_16x16x32_bf16 v[68:71], v[120:123], v[212:215], v[68:71]
  ds_read_b128 v[120:123], v2 offset:6144
  s_waitcnt lgkmcnt(6)
  v_mfma_f32_16x16x32_bf16 v[72:75], v[124:127], v[208:211], v[72:75]
  ds_write_b128 v42, a[76:79] offset:41984
  v_mfma_f32_16x16x32_bf16 v[76:79], v[124:127], v[212:215], v[76:79]
  ds_read_b128 v[124:127], v2 offset:7168
  s_waitcnt lgkmcnt(7)
  v_mfma_f32_16x16x32_bf16 v[80:83], v[128:131], v[208:211], v[80:83]
  buffer_load_dwordx4 a[192:195], v1, s[28:31], s32 offen offset:0 sc1
  v_mfma_f32_16x16x32_bf16 v[84:87], v[128:131], v[212:215], v[84:87]
  ds_read_b128 v[128:131], v2 offset:8192
  s_waitcnt lgkmcnt(7)
  v_mfma_f32_16x16x32_bf16 v[88:91], v[132:135], v[208:211], v[88:91]
  buffer_load_dwordx4 a[196:199], v1, s[28:31], s32 offen offset:1024 sc1
  v_mfma_f32_16x16x32_bf16 v[92:95], v[132:135], v[212:215], v[92:95]
  ds_read_b128 v[132:135], v2 offset:9216
  s_waitcnt vmcnt(10) lgkmcnt(7)
  v_mfma_f32_16x16x32_bf16 v[56:59], v[112:115], v[216:219], v[56:59]
  ds_write_b128 v42, a[80:83] offset:55296
  v_mfma_f32_16x16x32_bf16 v[60:63], v[112:115], v[220:223], v[60:63]
  ds_read_b128 v[112:115], v2 offset:10240
  s_waitcnt lgkmcnt(7)
  v_mfma_f32_16x16x32_bf16 v[64:67], v[116:119], v[216:219], v[64:67]
  buffer_load_dwordx4 a[200:203], v1, s[28:31], s32 offen offset:2048 sc1
  v_mfma_f32_16x16x32_bf16 v[68:71], v[116:119], v[220:223], v[68:71]
  ds_read_b128 v[116:119], v2 offset:11264
  s_waitcnt lgkmcnt(7)
  v_mfma_f32_16x16x32_bf16 v[72:75], v[120:123], v[216:219], v[72:75]
  ds_write_b128 v42, a[84:87] offset:56320
  v_mfma_f32_16x16x32_bf16 v[76:79], v[120:123], v[220:223], v[76:79]
  ds_read_b128 v[120:123], v2 offset:12288
  s_waitcnt lgkmcnt(7)
  v_mfma_f32_16x16x32_bf16 v[80:83], v[124:127], v[216:219], v[80:83]
  buffer_load_dwordx4 a[204:207], v1, s[28:31], s32 offen offset:3072 sc1
  s_add_u32 s32, s32, 4096
  v_mfma_f32_16x16x32_bf16 v[84:87], v[124:127], v[220:223], v[84:87]
  ds_read_b128 v[124:127], v2 offset:13312
  s_waitcnt lgkmcnt(7)
  v_mfma_f32_16x16x32_bf16 v[88:91], v[128:131], v[216:219], v[88:91]
  ds_write_b128 v42, a[88:91] offset:57344
  v_mfma_f32_16x16x32_bf16 v[92:95], v[128:131], v[220:223], v[92:95]
  ds_read_b128 v[128:131], v2 offset:14336
  s_waitcnt vmcnt(10) lgkmcnt(8)
  v_mfma_f32_16x16x32_bf16 v[56:59], v[132:135], v[224:227], v[56:59]
  buffer_load_dwordx4 a[208:211], v1, s[28:31], s32 offen offset:0 sc1
  v_mfma_f32_16x16x32_bf16 v[60:63], v[132:135], v[228:231], v[60:63]
  ds_read_b128 v[132:135], v2 offset:15360
  s_waitcnt lgkmcnt(7)
  v_mfma_f32_16x16x32_bf16 v[64:67], v[112:115], v[224:227], v[64:67]
  buffer_load_dwordx4 a[212:215], v1, s[28:31], s32 offen offset:1024 sc1
  v_mfma_f32_16x16x32_bf16 v[68:71], v[112:115], v[228:231], v[68:71]
  ds_read_b128 v[112:115], v2 offset:16384
  s_waitcnt lgkmcnt(7)
  v_mfma_f32_16x16x32_bf16 v[72:75], v[116:119], v[224:227], v[72:75]
  ds_write_b128 v42, a[92:95] offset:58368
  v_mfma_f32_16x16x32_bf16 v[76:79], v[116:119], v[228:231], v[76:79]
  ds_read_b128 v[116:119], v2 offset:17408
  s_waitcnt lgkmcnt(7)
  v_mfma_f32_16x16x32_bf16 v[80:83], v[120:123], v[224:227], v[80:83]
  buffer_load_dwordx4 a[216:219], v1, s[28:31], s32 offen offset:2048 sc1
  v_mov_b32 v98, v97
  v_mfma_f32_16x16x32_bf16 v[84:87], v[120:123], v[228:231], v[84:87]
  ds_read_b128 v[120:123], v2 offset:18432
  s_waitcnt lgkmcnt(7)
  v_mfma_f32_16x16x32_bf16 v[88:91], v[124:127], v[224:227], v[88:91]
  v_mov_b32 v99, v105
  v_mfma_f32_16x16x32_bf16 v[92:95], v[124:127], v[228:231], v[92:95]
  ds_read_b128 v[124:127], v2 offset:19456
  s_waitcnt vmcnt(11) lgkmcnt(6)
  v_mfma_f32_16x16x32_bf16 v[56:59], v[128:131], v[232:235], v[56:59]
  buffer_load_dwordx4 a[220:223], v1, s[28:31], s32 offen offset:3072 sc1
  s_add_u32 s32, s32, 4096
  v_mfma_f32_16x16x32_bf16 v[60:63], v[128:131], v[236:239], v[60:63]
  ds_read_b128 v[128:131], v2 offset:20480
  s_waitcnt lgkmcnt(6)
  v_mfma_f32_16x16x32_bf16 v[64:67], v[132:135], v[232:235], v[64:67]
  buffer_load_dwordx4 a[224:227], v1, s[28:31], s32 offen offset:0 sc1
  v_mfma_f32_16x16x32_bf16 v[68:71], v[132:135], v[236:239], v[68:71]
  ds_read_b128 v[132:135], v2 offset:21504
  s_waitcnt lgkmcnt(6)
  v_mfma_f32_16x16x32_bf16 v[72:75], v[112:115], v[232:235], v[72:75]
  v_permlane32_swap_b32 v98, v97
  v_mfma_f32_16x16x32_bf16 v[76:79], v[112:115], v[236:239], v[76:79]
  s_waitcnt lgkmcnt(5)
  s_barrier
  ds_read_b128 v[112:115], v2 offset:22528
  s_waitcnt lgkmcnt(5)
  v_mfma_f32_16x16x32_bf16 v[80:83], v[116:119], v[232:235], v[80:83]
  buffer_load_dwordx4 a[228:231], v1, s[28:31], s32 offen offset:1024 sc1
  v_mfma_f32_16x16x32_bf16 v[84:87], v[116:119], v[236:239], v[84:87]
  ds_read_b128 v[116:119], v2 offset:23552
  s_waitcnt lgkmcnt(5)
  v_mfma_f32_16x16x32_bf16 v[88:91], v[120:123], v[232:235], v[88:91]
  v_permlane32_swap_b32 v99, v105
  v_mfma_f32_16x16x32_bf16 v[92:95], v[120:123], v[236:239], v[92:95]
  ds_read_b128 v[120:123], v2 offset:24576
  s_waitcnt vmcnt(12) lgkmcnt(5)
  v_mfma_f32_16x16x32_bf16 v[56:59], v[124:127], v[240:243], v[56:59]
  buffer_load_dwordx4 a[232:235], v1, s[28:31], s32 offen offset:2048 sc1
  v_add_f32 v97, v97, v98
  v_mfma_f32_16x16x32_bf16 v[60:63], v[124:127], v[244:247], v[60:63]
  ds_read_b128 v[124:127], v2 offset:25600
  s_waitcnt lgkmcnt(5)
  v_mfma_f32_16x16x32_bf16 v[64:67], v[128:131], v[240:243], v[64:67]
  buffer_load_dwordx4 a[236:239], v1, s[28:31], s32 offen offset:3072 sc1
  s_add_u32 s32, s32, 4096
  v_mfma_f32_16x16x32_bf16 v[68:71], v[128:131], v[244:247], v[68:71]
  ds_read_b128 v[128:131], v2 offset:26624
  s_waitcnt lgkmcnt(5)
  v_mfma_f32_16x16x32_bf16 v[72:75], v[132:135], v[240:243], v[72:75]
  v_add_f32 v105, v105, v99
  v_mov_b32 v98, v97
  v_mfma_f32_16x16x32_bf16 v[76:79], v[132:135], v[244:247], v[76:79]
  ds_read_b128 v[132:135], v2 offset:27648
  s_waitcnt lgkmcnt(5)
  v_mfma_f32_16x16x32_bf16 v[80:83], v[112:115], v[240:243], v[80:83]
  buffer_load_dwordx4 a[240:243], v1, s[28:31], s32 offen offset:0 sc1
  v_mov_b32 v99, v105
  v_mfma_f32_16x16x32_bf16 v[84:87], v[112:115], v[244:247], v[84:87]
  ds_read_b128 v[112:115], v2 offset:28672
  s_waitcnt lgkmcnt(5)
  v_mfma_f32_16x16x32_bf16 v[88:91], v[116:119], v[240:243], v[88:91]
  v_permlane16_swap_b32 v98, v97
  v_mfma_f32_16x16x32_bf16 v[92:95], v[116:119], v[244:247], v[92:95]
  ds_read_b128 v[116:119], v2 offset:29696
  s_waitcnt vmcnt(13) lgkmcnt(5)
  v_mfma_f32_16x16x32_bf16 v[56:59], v[120:123], v[248:251], v[56:59]
  buffer_load_dwordx4 a[244:247], v1, s[28:31], s32 offen offset:1024 sc1
  v_mfma_f32_16x16x32_bf16 v[60:63], v[120:123], v[252:255], v[60:63]
  ds_read_b128 v[120:123], v2 offset:30720
  s_waitcnt lgkmcnt(5)
  v_mfma_f32_16x16x32_bf16 v[64:67], v[124:127], v[248:251], v[64:67]
  v_permlane16_swap_b32 v99, v105
  v_mfma_f32_16x16x32_bf16 v[68:71], v[124:127], v[252:255], v[68:71]
  ds_read_b128 v[124:127], v2 offset:31744
  s_waitcnt lgkmcnt(5)
  v_mfma_f32_16x16x32_bf16 v[72:75], v[128:131], v[248:251], v[72:75]
  buffer_load_dwordx4 a[248:251], v1, s[28:31], s32 offen offset:2048 sc1
  v_add_f32 v97, v97, v98
  v_mfma_f32_16x16x32_bf16 v[76:79], v[128:131], v[252:255], v[76:79]
  ds_read_b128 v[128:131], v2 offset:32768
  s_waitcnt lgkmcnt(5)
  v_mfma_f32_16x16x32_bf16 v[80:83], v[132:135], v[248:251], v[80:83]
  buffer_load_dwordx4 a[252:255], v1, s[28:31], s32 offen offset:3072 sc1
  v_add_f32 v105, v105, v99
  v_mfma_f32_16x16x32_bf16 v[84:87], v[132:135], v[252:255], v[84:87]
  ds_read_b128 v[132:135], v2 offset:33792
  s_waitcnt lgkmcnt(5)
  v_mfma_f32_16x16x32_bf16 v[88:91], v[112:115], v[248:251], v[88:91]
  s_add_u32 m0, s35, 4096
  v_mul_f32 v97, 0x3ae38e39, v97
  v_mfma_f32_16x16x32_bf16 v[92:95], v[112:115], v[252:255], v[92:95]
  ds_read_b128 v[112:115], v2 offset:34816
  s_waitcnt vmcnt(14) lgkmcnt(5)
  v_mfma_f32_16x16x32_bf16 v[56:59], v[116:119], a[192:195], v[56:59]
  buffer_load_dwordx4 v1, s[8:11], s34 offen offset:2048 sc1 lds
  v_mul_f32 v105, 0x3ae38e39, v105
  v_mfma_f32_16x16x32_bf16 v[60:63], v[116:119], a[196:199], v[60:63]
  ds_read_b128 v[116:119], v2 offset:35840
  s_waitcnt lgkmcnt(5)
  v_mfma_f32_16x16x32_bf16 v[64:67], v[120:123], a[192:195], v[64:67]
  v_fma_f32 v97, -v96, v96, v97
  v_fma_f32 v105, -v104, v104, v105
  v_mfma_f32_16x16x32_bf16 v[68:71], v[120:123], a[196:199], v[68:71]
  s_barrier
  ds_read_b128 v[120:123], v2 offset:36864
  s_waitcnt lgkmcnt(5)
  v_mfma_f32_16x16x32_bf16 v[72:75], v[124:127], a[192:195], v[72:75]
  v_max_f32 v97, 0, v97
  v_max_f32 v105, 0, v105
  v_mfma_f32_16x16x32_bf16 v[76:79], v[124:127], a[196:199], v[76:79]
  ds_read_b128 v[124:127], v2 offset:37888
  s_waitcnt lgkmcnt(5)
  v_mfma_f32_16x16x32_bf16 v[80:83], v[128:131], a[192:195], v[80:83]
  buffer_load_dwordx4 v1, s[8:11], s34 offen offset:3072 sc1 lds
  v_add_f32 v97, 0x3727c5ac, v97
  v_mfma_f32_16x16x32_bf16 v[84:87], v[128:131], a[196:199], v[84:87]
  ds_read_b128 v[128:131], v2 offset:38912
  s_waitcnt lgkmcnt(5)
  v_mfma_f32_16x16x32_bf16 v[88:91], v[132:135], a[192:195], v[88:91]
  s_add_u32 s34, s34, 4096
  v_add_f32 v105, 0x3727c5ac, v105
  v_mfma_f32_16x16x32_bf16 v[92:95], v[132:135], a[196:199], v[92:95]
  ds_read_b128 v[132:135], v2 offset:39936
  s_waitcnt vmcnt(14) lgkmcnt(5)
  v_mfma_f32_16x16x32_bf16 v[56:59], v[112:115], a[200:203], v[56:59]
  s_add_u32 m0, s35, 8192
  v_mfma_f32_16x16x32_bf16 v[60:63], v[112:115], a[204:207], v[60:63]
  ds_read_b128 v[112:115], v2 offset:40960
  s_waitcnt lgkmcnt(5)
  v_mfma_f32_16x16x32_bf16 v[64:67], v[116:119], a[200:203], v[64:67]
  buffer_load_dwordx4 v1, s[8:11], s34 offen offset:0 sc1 lds
  v_mfma_f32_16x16x32_bf16 v[68:71], v[116:119], a[204:207], v[68:71]
  ds_read_b128 v[116:119], v2 offset:41984
  s_waitcnt lgkmcnt(5)
  v_mfma_f32_16x16x32_bf16 v[72:75], v[120:123], a[200:203], v[72:75]
  v_rsq_f32 v152, v97
  v_mfma_f32_16x16x32_bf16 v[76:79], v[120:123], a[204:207], v[76:79]
  ds_read_b128 v[120:123], v2 offset:43008
  s_waitcnt lgkmcnt(5)
  v_mfma_f32_16x16x32_bf16 v[80:83], v[124:127], a[200:203], v[80:83]
  v_rsq_f32 v153, v105
  v_mfma_f32_16x16x32_bf16 v[84:87], v[124:127], a[204:207], v[84:87]
  ds_read_b128 v[124:127], v2 offset:44032
  s_waitcnt lgkmcnt(5)
  v_mfma_f32_16x16x32_bf16 v[88:91], v[128:131], a[200:203], v[88:91]
  buffer_load_dwordx4 v1, s[8:11], s34 offen offset:1024 sc1 lds
  v_mul_f32 v154, 0x3fb8aa3b, v152
  v_mfma_f32_16x16x32_bf16 v[92:95], v[128:131], a[204:207], v[92:95]
  ds_read_b128 v[128:131], v2 offset:45056
  s_waitcnt vmcnt(14) lgkmcnt(5)
  v_mfma_f32_16x16x32_bf16 v[56:59], v[132:135], a[208:211], v[56:59]
  v_mul_f32 v155, 0x3fb8aa3b, v153
  v_mfma_f32_16x16x32_bf16 v[60:63], v[132:135], a[212:215], v[60:63]
  ds_read_b128 v[132:135], v2 offset:46080
  s_waitcnt lgkmcnt(5)
  v_mfma_f32_16x16x32_bf16 v[64:67], v[112:115], a[208:211], v[64:67]
  s_add_u32 m0, s37, 0
  v_mfma_f32_16x16x32_bf16 v[68:71], v[112:115], a[212:215], v[68:71]
  ds_read_b128 v[112:115], v2 offset:47104
  s_waitcnt lgkmcnt(5)
  v_mfma_f32_16x16x32_bf16 v[72:75], v[116:119], a[208:211], v[72:75]
  buffer_load_dwordx4 v1, s[8:11], s36 offen offset:0 sc1 lds
  v_mfma_f32_16x16x32_bf16 v[76:79], v[116:119], a[212:215], v[76:79]
  ds_read_b128 v[116:119], v2 offset:48128
  s_waitcnt lgkmcnt(5)
  v_mfma_f32_16x16x32_bf16 v[80:83], v[120:123], a[208:211], v[80:83]
  v_mfma_f32_16x16x32_bf16 v[84:87], v[120:123], a[212:215], v[84:87]
  ds_read_b128 v[120:123], v2 offset:49152
  s_waitcnt lgkmcnt(5)
  v_mfma_f32_16x16x32_bf16 v[88:91], v[124:127], a[208:211], v[88:91]
  buffer_load_dwordx4 v1, s[8:11], s36 offen offset:1024 sc1 lds
  v_mfma_f32_16x16x32_bf16 v[92:95], v[124:127], a[212:215], v[92:95]
  ds_read_b128 v[124:127], v2 offset:50176
  s_waitcnt vmcnt(14) lgkmcnt(5)
  v_mfma_f32_16x16x32_bf16 v[56:59], v[128:131], a[216:219], v[56:59]
  v_mfma_f32_16x16x32_bf16 v[60:63], v[128:131], a[220:223], v[60:63]
  ds_read_b128 v[128:131], v2 offset:51200
  s_waitcnt lgkmcnt(5)
  v_mfma_f32_16x16x32_bf16 v[64:67], v[132:135], a[216:219], v[64:67]
  buffer_load_dwordx4 v1, s[8:11], s36 offen offset:2048 sc1 lds
  v_mfma_f32_16x16x32_bf16 v[68:71], v[132:135], a[220:223], v[68:71]
  ds_read_b128 v[132:135], v2 offset:52224
  s_waitcnt lgkmcnt(5)
  v_mfma_f32_16x16x32_bf16 v[72:75], v[112:115], a[216:219], v[72:75]
  v_mfma_f32_16x16x32_bf16 v[76:79], v[112:115], a[220:223], v[76:79]
  ds_read_b128 v[112:115], v2 offset:53248
  s_waitcnt lgkmcnt(5)
  v_mfma_f32_16x16x32_bf16 v[80:83], v[116:119], a[216:219], v[80:83]
  buffer_load_dwordx4 v1, s[8:11], s36 offen offset:3072 sc1 lds
  s_add_u32 s36, s36, 4096
  v_mfma_f32_16x16x32_bf16 v[84:87], v[116:119], a[220:223], v[84:87]
  ds_read_b128 v[116:119], v2 offset:54272
  s_waitcnt lgkmcnt(5)
  v_mfma_f32_16x16x32_bf16 v[88:91], v[120:123], a[216:219], v[88:91]
  s_add_u32 m0, s37, 4096
  v_mfma_f32_16x16x32_bf16 v[92:95], v[120:123], a[220:223], v[92:95]
  ds_read_b128 v[120:123], v2 offset:55296
  s_waitcnt vmcnt(14) lgkmcnt(5)
  v_mfma_f32_16x16x32_bf16 v[56:59], v[124:127], a[224:227], v[56:59]
  buffer_load_dwordx4 v1, s[8:11], s36 offen offset:0 sc1 lds
  s_mul_i32 s36, s54, 8192
  v_mfma_f32_16x16x32_bf16 v[60:63], v[124:127], a[228:231], v[60:63]
  ds_read_b128 v[124:127], v2 offset:56320
  s_waitcnt lgkmcnt(5)
  v_mfma_f32_16x16x32_bf16 v[64:67], v[128:131], a[224:227], v[64:67]
  s_min_u32 s36, s36, 23552
  s_add_u32 s37, s36, 65536
  v_mfma_f32_16x16x32_bf16 v[68:71], v[128:131], a[228:231], v[68:71]
  ds_read_b128 v[128:131], v2 offset:57344
  s_waitcnt lgkmcnt(5)
  v_mfma_f32_16x16x32_bf16 v[72:75], v[132:135], a[224:227], v[72:75]
  s_add_u32 s36, s36, s39
  s_add_u32 m0, s37, 0
  v_mfma_f32_16x16x32_bf16 v[76:79], v[132:135], a[228:231], v[76:79]
  ds_read_b128 v[132:135], v2 offset:58368
  s_waitcnt lgkmcnt(5)
  v_mfma_f32_16x16x32_bf16 v[80:83], v[112:115], a[224:227], v[80:83]
  buffer_load_dwordx4 v1, s[8:11], s36 offen offset:0 sc1 lds
  buffer_load_dwordx4 v1, s[8:11], s36 offen offset:1024 sc1 lds
  v_mfma_f32_16x16x32_bf16 v[84:87], v[112:115], a[228:231], v[84:87]
  ds_read_b128 v[112:115], v2 offset:59392
  s_waitcnt lgkmcnt(5)
  v_mfma_f32_16x16x32_bf16 v[88:91], v[116:119], a[224:227], v[88:91]
  v_mfma_f32_16x16x32_bf16 v[92:95], v[116:119], a[228:231], v[92:95]
  ds_read_b128 v[116:119], v2 offset:60416
  s_waitcnt vmcnt(15) lgkmcnt(5)
  v_mfma_f32_16x16x32_bf16 v[56:59], v[120:123], a[232:235], v[56:59]
  buffer_load_dwordx4 v1, s[8:11], s36 offen offset:2048 sc1 lds
  v_mfma_f32_16x16x32_bf16 v[60:63], v[120:123], a[236:239], v[60:63]
  ds_read_b128 v[120:123], v2 offset:61440
  s_waitcnt lgkmcnt(5)
  v_mfma_f32_16x16x32_bf16 v[64:67], v[124:127], a[232:235], v[64:67]
  buffer_load_dwordx4 v1, s[8:11], s36 offen offset:3072 sc1 lds
  s_add_u32 s36, s36, 4096
  v_mfma_f32_16x16x32_bf16 v[68:71], v[124:127], a[236:239], v[68:71]
  ds_read_b128 v[124:127], v2 offset:62464
  s_waitcnt lgkmcnt(5)
  v_mfma_f32_16x16x32_bf16 v[72:75], v[128:131], a[232:235], v[72:75]
  s_add_u32 m0, s37, 4096
  v_mfma_f32_16x16x32_bf16 v[76:79], v[128:131], a[236:239], v[76:79]
  ds_read_b128 v[128:131], v2 offset:63488
  s_waitcnt lgkmcnt(5)
  v_mfma_f32_16x16x32_bf16 v[80:83], v[132:135], a[232:235], v[80:83]
  buffer_load_dwordx4 v1, s[8:11], s36 offen offset:0 sc1 lds
  v_mfma_f32_16x16x32_bf16 v[84:87], v[132:135], a[236:239], v[84:87]
  ds_read_b128 v[132:135], v2 offset:64512
  s_waitcnt lgkmcnt(5)
  v_mfma_f32_16x16x32_bf16 v[88:91], v[112:115], a[232:235], v[88:91]
  buffer_load_dwordx4 v1, s[8:11], s36 offen offset:1024 sc1 lds
  v_mfma_f32_16x16x32_bf16 v[92:95], v[112:115], a[236:239], v[92:95]
  ds_read_b128 v[112:115], v18 offset:0
  s_waitcnt vmcnt(17) lgkmcnt(5)
  v_mfma_f32_16x16x32_bf16 v[56:59], v[116:119], a[240:243], v[56:59]
  v_mfma_f32_16x16x32_bf16 v[60:63], v[116:119], a[244:247], v[60:63]
  ds_read_b128 v[116:119], v18 offset:1024
  s_waitcnt lgkmcnt(5)
  v_mfma_f32_16x16x32_bf16 v[64:67], v[120:123], a[240:243], v[64:67]
  buffer_load_dwordx4 v1, s[8:11], s36 offen offset:2048 sc1 lds
  v_mfma_f32_16x16x32_bf16 v[68:71], v[120:123], a[244:247], v[68:71]
  ds_read_b128 v[120:123], v18 offset:2048
  s_waitcnt lgkmcnt(5)
  v_mfma_f32_16x16x32_bf16 v[72:75], v[124:127], a[240:243], v[72:75]
  buffer_load_dwordx4 v1, s[8:11], s36 offen offset:3072 sc1 lds
  v_mfma_f32_16x16x32_bf16 v[76:79], v[124:127], a[244:247], v[76:79]
  ds_read_b128 v[124:127], v18 offset:3072
  s_waitcnt lgkmcnt(5)
  v_mfma_f32_16x16x32_bf16 v[80:83], v[128:131], a[240:243], v[80:83]
  v_mfma_f32_16x16x32_bf16 v[84:87], v[128:131], a[244:247], v[84:87]
  ds_read_b128 v[128:131], v18 offset:4096
  s_waitcnt lgkmcnt(5)
  v_mfma_f32_16x16x32_bf16 v[88:91], v[132:135], a[240:243], v[88:91]
  v_mfma_f32_16x16x32_bf16 v[92:95], v[132:135], a[244:247], v[92:95]
  s_waitcnt vmcnt(17) lgkmcnt(4)
  v_mfma_f32_16x16x32_bf16 v[56:59], v[112:115], a[248:251], v[56:59]
  v_mfma_f32_16x16x32_bf16 v[60:63], v[112:115], a[252:255], v[60:63]
  s_waitcnt lgkmcnt(3)
  v_mfma_f32_16x16x32_bf16 v[64:67], v[116:119], a[248:251], v[64:67]
  v_mfma_f32_16x16x32_bf16 v[68:71], v[116:119], a[252:255], v[68:71]
  s_waitcnt lgkmcnt(2)
  v_mfma_f32_16x16x32_bf16 v[72:75], v[120:123], a[248:251], v[72:75]
  v_mfma_f32_16x16x32_bf16 v[76:79], v[120:123], a[252:255], v[76:79]
  s_waitcnt lgkmcnt(1)
  v_mfma_f32_16x16x32_bf16 v[80:83], v[124:127], a[248:251], v[80:83]
  v_mfma_f32_16x16x32_bf16 v[84:87], v[124:127], a[252:255], v[84:87]
  s_waitcnt lgkmcnt(0)
  v_mfma_f32_16x16x32_bf16 v[88:91], v[128:131], a[248:251], v[88:91]
  v_mfma_f32_16x16x32_bf16 v[92:95], v[128:131], a[252:255], v[92:95]
  v_pk_mul_f32 v[112:113], v[56:57], v[154:155] op_sel_hi:[1,0]
  v_pk_mul_f32 v[114:115], v[58:59], v[154:155] op_sel_hi:[1,0]
  v_pk_mul_f32 v[116:117], v[60:61], v[154:155] op_sel:[0,1] op_sel_hi:[1,1]
  v_pk_mul_f32 v[118:119], v[62:63], v[154:155] op_sel:[0,1] op_sel_hi:[1,1]
  v_pk_mul_f32 v[120:121], v[64:65], v[154:155] op_sel_hi:[1,0]
  v_pk_mul_f32 v[122:123], v[66:67], v[154:155] op_sel_hi:[1,0]
  v_pk_mul_f32 v[124:125], v[68:69], v[154:155] op_sel:[0,1] op_sel_hi:[1,1]
  v_pk_mul_f32 v[126:127], v[70:71], v[154:155] op_sel:[0,1] op_sel_hi:[1,1]
  v_pk_mul_f32 v[128:129], v[90:91], v[154:155] op_sel_hi:[1,0]
  v_pk_mul_f32 v[130:131], v[94:95], v[154:155] op_sel:[0,1] op_sel_hi:[1,1]
  v_exp_f32 v112, v112 clamp
  v_exp_f32 v113, v113 clamp
  v_pk_fma_f32 v[56:57], v[56:57], v[152:153], 1.0 op_sel_hi:[1,0,0]
  v_exp_f32 v114, v114 clamp
  v_exp_f32 v115, v115 clamp
  v_pk_fma_f32 v[58:59], v[58:59], v[152:153], 1.0 op_sel_hi:[1,0,0]
  v_exp_f32 v116, v116 clamp
  v_exp_f32 v117, v117 clamp
  v_pk_fma_f32 v[60:61], v[60:61], v[152:153], 1.0 op_sel:[0,1,0] op_sel_hi:[1,1,0]
  v_exp_f32 v118, v118 clamp
  v_exp_f32 v119, v119 clamp
  v_pk_fma_f32 v[62:63], v[62:63], v[152:153], 1.0 op_sel:[0,1,0] op_sel_hi:[1,1,0]
  v_exp_f32 v120, v120 clamp
  v_exp_f32 v121, v121 clamp
  v_pk_fma_f32 v[64:65], v[64:65], v[152:153], 1.0 op_sel_hi:[1,0,0]
  v_exp_f32 v122, v122 clamp
  v_exp_f32 v123, v123 clamp
  v_pk_fma_f32 v[66:67], v[66:67], v[152:153], 1.0 op_sel_hi:[1,0,0]
  v_exp_f32 v124, v124 clamp
  v_exp_f32 v125, v125 clamp
  v_pk_fma_f32 v[68:69], v[68:69], v[152:153], 1.0 op_sel:[0,1,0] op_sel_hi:[1,1,0]
  v_exp_f32 v126, v126 clamp
  v_exp_f32 v127, v127 clamp
  v_pk_fma_f32 v[70:71], v[70:71], v[152:153], 1.0 op_sel:[0,1,0] op_sel_hi:[1,1,0]
  v_exp_f32 v128, v128 clamp
  v_exp_f32 v129, v129 clamp
  v_pk_fma_f32 v[90:91], v[90:91], v[152:153], 1.0 op_sel_hi:[1,0,0]
  v_exp_f32 v130, v130 clamp
  v_exp_f32 v131, v131 clamp
  v_pk_fma_f32 v[94:95], v[94:95], v[152:153], 1.0 op_sel:[0,1,0] op_sel_hi:[1,1,0]
  s_mov_b32 s86, 0x358637bd
  s_mov_b32 s87, 0x358637bd
  v_max_f32 v56, v56, v112
  v_max_f32 v57, v57, v113
  v_pk_add_f32 v[56:57], v[56:57], s[86:87]
  v_max_f32 v58, v58, v114
  v_max_f32 v59, v59, v115
  v_pk_add_f32 v[58:59], v[58:59], s[86:87]
  v_max_f32 v60, v60, v116
  v_max_f32 v61, v61, v117
  v_pk_add_f32 v[60:61], v[60:61], s[86:87]
  v_max_f32 v62, v62, v118
  v_max_f32 v63, v63, v119
  v_pk_add_f32 v[62:63], v[62:63], s[86:87]
  v_max_f32 v64, v64, v120
  v_max_f32 v65, v65, v121
  v_pk_add_f32 v[64:65], v[64:65], s[86:87]
  v_max_f32 v66, v66, v122
  v_max_f32 v67, v67, v123
  v_pk_add_f32 v[66:67], v[66:67], s[86:87]
  v_max_f32 v68, v68, v124
  v_max_f32 v69, v69, v125
  v_pk_add_f32 v[68:69], v[68:69], s[86:87]
  v_max_f32 v70, v70, v126
  v_max_f32 v71, v71, v127
  v_pk_add_f32 v[70:71], v[70:71], s[86:87]
  v_max_f32 v90, v90, v128
  v_max_f32 v91, v91, v129
  v_pk_add_f32 v[90:91], v[90:91], s[86:87]
  v_max_f32 v94, v94, v130
  v_max_f32 v95, v95, v131
  v_pk_add_f32 v[94:95], v[94:95], s[86:87]
  v_cvt_pk_bf16_f32 v132, v56, v57
  v_cvt_pk_bf16_f32 v133, v58, v59
  v_cvt_pk_bf16_f32 v134, v64, v65
  v_cvt_pk_bf16_f32 v135, v66, v67
  v_cvt_pk_bf16_f32 v136, v60, v61
  v_cvt_pk_bf16_f32 v137, v62, v63
  v_cvt_pk_bf16_f32 v138, v68, v69
  v_cvt_pk_bf16_f32 v139, v70, v71
  ds_write_b128 v19, v[132:135] offset:38912
  ds_write_b128 v19, v[136:139] offset:39168
  v_pk_mul_f32 v[72:73], v[72:73], v[152:153] op_sel_hi:[1,0]
  v_pk_mul_f32 v[74:75], v[74:75], v[152:153] op_sel_hi:[1,0]
  v_pk_mul_f32 v[76:77], v[76:77], v[152:153] op_sel:[0,1] op_sel_hi:[1,1]
  v_pk_mul_f32 v[78:79], v[78:79], v[152:153] op_sel:[0,1] op_sel_hi:[1,1]
  v_pk_mul_f32 v[80:81], v[80:81], v[152:153] op_sel_hi:[1,0]
  v_pk_mul_f32 v[82:83], v[82:83], v[152:153] op_sel_hi:[1,0]
  v_pk_mul_f32 v[84:85], v[84:85], v[152:153] op_sel:[0,1] op_sel_hi:[1,1]
  v_pk_mul_f32 v[86:87], v[86:87], v[152:153] op_sel:[0,1] op_sel_hi:[1,1]
  v_cvt_pk_bf16_f32 v140, v72, v73
  v_cvt_pk_bf16_f32 v141, v74, v75
  v_cvt_pk_bf16_f32 v142, v80, v81
  v_cvt_pk_bf16_f32 v143, v82, v83
  v_cvt_pk_bf16_f32 v144, v76, v77
  v_cvt_pk_bf16_f32 v145, v78, v79
  v_cvt_pk_bf16_f32 v146, v84, v85
  v_cvt_pk_bf16_f32 v147, v86, v87
  ds_write_b128 v19, v[140:143] offset:39936
  ds_write_b128 v19, v[144:147] offset:40192
  v_pk_mul_f32 v[88:89], v[88:89], v[152:153] op_sel_hi:[1,0]
  v_pk_mul_f32 v[92:93], v[92:93], v[152:153] op_sel:[0,1] op_sel_hi:[1,1]
  v_cvt_pk_bf16_f32 v148, v88, v89
  v_cvt_pk_bf16_f32 v48, v92, v93
  v_cvt_pk_bf16_f32 v150, v90, v91
  v_cvt_pk_bf16_f32 v164, v94, v95
  v_mov_b32 v149, 0x3f803f80
  v_mov_b32 v151, 0
  v_permlane16_swap_b32 v148, v48
  v_permlane16_swap_b32 v150, v164
  ds_write_b128 v43, v[148:151] offset:38912
  s_waitcnt vmcnt(13) lgkmcnt(0)
  s_barrier
  ds_read_b64_tr_b16 v[56:57], v41 offset:38912
  ds_read_b64_tr_b16 v[58:59], v41 offset:38976
  ds_read_b64_tr_b16 v[60:61], v40 offset:38912
  ds_read_b64_tr_b16 v[62:63], v40 offset:38976
  ds_read_b64_tr_b16 v[64:65], v0 offset:40968
  ds_read_b64_tr_b16 v[66:67], v0 offset:41032
  ds_read_b64_tr_b16 v[68:69], v41 offset:44032
  ds_read_b64_tr_b16 v[70:71], v41 offset:44096
  ds_read_b64_tr_b16 v[72:73], v40 offset:44032
  ds_read_b64_tr_b16 v[74:75], v40 offset:44096
  ds_read_b64_tr_b16 v[76:77], v0 offset:46088
  ds_read_b64_tr_b16 v[78:79], v0 offset:46152
  s_waitcnt lgkmcnt(8)
  v_mfma_f32_16x16x32_bf16 v[80:83], v[60:63], v[56:59], 0
  s_waitcnt lgkmcnt(6)
  v_mfma_f32_16x16x32_bf16 v[84:87], v[64:67], v[56:59], 0
  ds_read_b64_tr_b16 v[132:133], v41 offset:49152
  ds_read_b64_tr_b16 v[134:135], v41 offset:49216
  ds_read_b64_tr_b16 v[136:137], v40 offset:49152
  ds_read_b64_tr_b16 v[138:139], v40 offset:49216
  ds_read_b64_tr_b16 v[140:141], v0 offset:51208
  ds_read_b64_tr_b16 v[142:143], v0 offset:51272
  s_waitcnt lgkmcnt(8)
  v_mfma_f32_16x16x32_bf16 v[80:83], v[72:75], v[68:71], v[80:83]
  s_waitcnt lgkmcnt(6)
  v_mfma_f32_16x16x32_bf16 v[84:87], v[76:79], v[68:71], v[84:87]
  ds_read_b64_tr_b16 v[56:57], v41 offset:54272
  ds_read_b64_tr_b16 v[58:59], v41 offset:54336
  ds_read_b64_tr_b16 v[60:61], v40 offset:54272
  ds_read_b64_tr_b16 v[62:63], v40 offset:54336
  ds_read_b64_tr_b16 v[64:65], v0 offset:56328
  ds_read_b64_tr_b16 v[66:67], v0 offset:56392
  s_waitcnt lgkmcnt(8)
  v_mfma_f32_16x16x32_bf16 v[80:83], v[136:139], v[132:135], v[80:83]
  s_waitcnt lgkmcnt(6)
  v_mfma_f32_16x16x32_bf16 v[84:87], v[140:143], v[132:135], v[84:87]
  ds_read2st64_b32 v[112:113], v44 offset0:0 offset1:1
  ds_read2st64_b32 v[114:115], v44 offset0:2 offset1:3
  ds_read2st64_b32 v[116:117], v44 offset0:4 offset1:5
  ds_read2st64_b32 v[118:119], v44 offset0:6 offset1:7
  s_waitcnt lgkmcnt(6)
  v_mfma_f32_16x16x32_bf16 v[80:83], v[60:63], v[56:59], v[80:83]
  s_waitcnt lgkmcnt(4)
  v_mfma_f32_16x16x32_bf16 v[84:87], v[64:67], v[56:59], v[84:87]
  s_nop 5
  v_cvt_pk_bf16_f32 v88, v80, v81
  v_cvt_pk_bf16_f32 v89, v82, v83
  v_cvt_pk_bf16_f32 v90, v80, v81
  v_cvt_pk_bf16_f32 v91, v82, v83
  v_cvt_pk_bf16_f32 v92, v84, v85
  v_permlane16_swap_b32 v88, v90
  v_permlane16_swap_b32 v89, v91
  buffer_store_dword v92, v37, s[8:11], s25 offen offset:640 sc1
  buffer_store_dwordx4 v[88:91], v36, s[8:11], s25 offen sc1
  s_mov_b32 s80, s74
  ds_read_b128 v[120:123], v1 offset:2048
  ds_read_b128 v[124:127], v1 offset:4096
  ds_read_b128 v[128:131], v1 offset:3072
  s_waitcnt lgkmcnt(5)
  v_mfma_f32_16x16x32_bf16 v[96:99], v[112:115], v[156:159], 0
  global_load_dword v165, v[166:167], off sc1
  s_mul_i32 s36, s54, 10240
  v_mfma_f32_16x16x32_bf16 v[100:103], v[112:115], v[160:163], 0
  ds_read_b128 v[112:115], v1 offset:6144
  s_waitcnt lgkmcnt(4)
  v_mfma_f32_16x16x32_bf16 v[104:107], v[116:119], v[156:159], 0
  s_min_u32 s36, s36, 29696
  s_add_u32 s37, s36, 97280
  v_mfma_f32_16x16x32_bf16 v[108:111], v[116:119], v[160:163], 0
  ds_read_b128 v[116:119], v1 offset:8192
  s_waitcnt lgkmcnt(4)
  v_mfma_f32_16x16x32_bf16 v[96:99], v[120:123], v[176:179], v[96:99]
  s_add_u32 s36, s36, s39
  s_add_u32 s36, s36, 31744
  v_mfma_f32_16x16x32_bf16 v[100:103], v[120:123], v[180:183], v[100:103]
  ds_read_b128 v[120:123], v1 offset:10240
  s_waitcnt lgkmcnt(4)
  v_mfma_f32_16x16x32_bf16 v[96:99], v[124:127], v[184:187], v[96:99]
  s_add_u32 m0, s37, 0
  v_cmp_gt_u32 vcc, 32, v16
  v_mfma_f32_16x16x32_bf16 v[100:103], v[124:127], v[188:191], v[100:103]
  ds_read_b128 v[124:127], v1 offset:5120
  s_waitcnt lgkmcnt(4)
  v_mfma_f32_16x16x32_bf16 v[104:107], v[128:131], v[176:179], v[104:107]
  buffer_load_dwordx4 v1, s[8:11], s36 offen offset:0 sc1 lds
  v_mov_b32 v169, 0
  v_mfma_f32_16x16x32_bf16 v[108:111], v[128:131], v[180:183], v[108:111]
  ds_read_b128 v[128:131], v1 offset:12288
  s_waitcnt lgkmcnt(4)
  v_mfma_f32_16x16x32_bf16 v[96:99], v[112:115], v[192:195], v[96:99]
  buffer_load_dwordx4 v1, s[8:11], s36 offen offset:1024 sc1 lds
  v_mov_b32 v171, 0
  v_mfma_f32_16x16x32_bf16 v[100:103], v[112:115], v[196:199], v[100:103]
  ds_read_b128 v[112:115], v1 offset:14336
  s_waitcnt lgkmcnt(4)
  v_mfma_f32_16x16x32_bf16 v[96:99], v[116:119], v[200:203], v[96:99]
  buffer_load_dwordx4 v1, s[8:11], s36 offen offset:2048 sc1 lds
  v_mov_b32 v48, 0x3f80
  v_mfma_f32_16x16x32_bf16 v[100:103], v[116:119], v[204:207], v[100:103]
  ds_read_b128 v[116:119], v1 offset:16384
  s_waitcnt lgkmcnt(4)
  v_mfma_f32_16x16x32_bf16 v[96:99], v[120:123], v[208:211], v[96:99]
  buffer_load_dwordx4 v1, s[8:11], s36 offen offset:3072 sc1 lds
  s_add_u32 s36, s36, 4096
  v_mfma_f32_16x16x32_bf16 v[100:103], v[120:123], v[212:215], v[100:103]
  ds_read_b128 v[120:123], v1 offset:7168
  s_waitcnt lgkmcnt(4)
  v_mfma_f32_16x16x32_bf16 v[104:107], v[124:127], v[184:187], v[104:107]
  s_add_u32 m0, s37, 4096
  v_mov_b32 v49, 1.0
  v_mfma_f32_16x16x32_bf16 v[108:111], v[124:127], v[188:191], v[108:111]
  ds_read_b128 v[124:127], v1 offset:18432
  s_waitcnt lgkmcnt(4)
  v_mfma_f32_16x16x32_bf16 v[96:99], v[128:131], v[216:219], v[96:99]
  buffer_load_dwordx4 v1, s[8:11], s36 offen offset:0 sc1 lds
  buffer_load_dwordx4 v1, s[8:11], s36 offen offset:1024 sc1 lds
  v_mfma_f32_16x16x32_bf16 v[100:103], v[128:131], v[220:223], v[100:103]
  ds_read_b128 v[128:131], v1 offset:20480
  s_waitcnt lgkmcnt(4)
  v_mfma_f32_16x16x32_bf16 v[96:99], v[112:115], v[224:227], v[96:99]
  buffer_load_dwordx4 v1, s[8:11], s36 offen offset:2048 sc1 lds
  v_cndmask_b32 v168, 0, v164, vcc
  v_mfma_f32_16x16x32_bf16 v[100:103], v[112:115], v[228:231], v[100:103]
  ds_read_b128 v[112:115], v1 offset:9216
  s_waitcnt lgkmcnt(4)
  v_mfma_f32_16x16x32_bf16 v[96:99], v[116:119], v[232:235], v[96:99]
  buffer_load_dwordx4 v1, s[8:11], s36 offen offset:3072 sc1 lds
  s_add_u32 s36, s36, 4096
  v_mfma_f32_16x16x32_bf16 v[100:103], v[116:119], v[236:239], v[100:103]
  ds_read_b128 v[116:119], v1 offset:22528
  s_waitcnt lgkmcnt(4)
  v_mfma_f32_16x16x32_bf16 v[104:107], v[120:123], v[192:195], v[104:107]
  s_add_u32 m0, s37, 8192
  v_cndmask_b32 v170, v164, 0, vcc
  v_mfma_f32_16x16x32_bf16 v[108:111], v[120:123], v[196:199], v[108:111]
  ds_read_b128 v[120:123], v1 offset:24576
  s_waitcnt lgkmcnt(4)
  v_mfma_f32_16x16x32_bf16 v[96:99], v[124:127], v[240:243], v[96:99]
  buffer_load_dwordx4 v1, s[8:11], s36 offen offset:0 sc1 lds
  buffer_load_dwordx4 v1, s[8:11], s36 offen offset:1024 sc1 lds
  v_mfma_f32_16x16x32_bf16 v[100:103], v[124:127], v[244:247], v[100:103]
  ds_read_b128 v[124:127], v1 offset:26624
  s_waitcnt lgkmcnt(4)
  v_mfma_f32_16x16x32_bf16 v[96:99], v[128:131], v[248:251], v[96:99]
  s_add_u32 s25, s25, 393216
  v_mfma_f32_16x16x32_bf16 v[100:103], v[128:131], v[252:255], v[100:103]
  ds_read_b128 v[128:131], v1 offset:11264
  s_waitcnt lgkmcnt(4)
  v_mfma_f32_16x16x32_bf16 v[104:107], v[112:115], v[200:203], v[104:107]
  v_mfma_f32_16x16x32_bf16 v[108:111], v[112:115], v[204:207], v[108:111]
  ds_read_b128 v[112:115], v1 offset:28672
  s_waitcnt lgkmcnt(4)
  v_mfma_f32_16x16x32_bf16 v[96:99], v[116:119], a[192:195], v[96:99]
  v_mfma_f32_16x16x32_bf16 v[100:103], v[116:119], a[196:199], v[100:103]
  ds_read_b128 v[116:119], v1 offset:30720
  s_waitcnt lgkmcnt(4)
  v_mfma_f32_16x16x32_bf16 v[96:99], v[120:123], a[200:203], v[96:99]
  v_mfma_f32_16x16x32_bf16 v[100:103], v[120:123], a[204:207], v[100:103]
  ds_read_b128 v[120:123], v1 offset:32768
  s_waitcnt lgkmcnt(4)
  v_mfma_f32_16x16x32_bf16 v[96:99], v[124:127], a[208:211], v[96:99]
  v_mfma_f32_16x16x32_bf16 v[100:103], v[124:127], a[212:215], v[100:103]
  ds_read_b128 v[124:127], v1 offset:13312
  s_waitcnt lgkmcnt(4)
  v_mfma_f32_16x16x32_bf16 v[104:107], v[128:131], v[208:211], v[104:107]
  v_mfma_f32_16x16x32_bf16 v[108:111], v[128:131], v[212:215], v[108:111]
  ds_read_b128 v[128:131], v1 offset:34816
  s_waitcnt lgkmcnt(4)
  v_mfma_f32_16x16x32_bf16 v[96:99], v[112:115], a[216:219], v[96:99]
  v_mfma_f32_16x16x32_bf16 v[100:103], v[112:115], a[220:223], v[100:103]
  ds_read_b128 v[112:115], v1 offset:36864
  s_waitcnt lgkmcnt(4)
  v_mfma_f32_16x16x32_bf16 v[96:99], v[116:119], a[224:227], v[96:99]
  v_mfma_f32_16x16x32_bf16 v[100:103], v[116:119], a[228:231], v[100:103]
  ds_read_b128 v[116:119], v1 offset:15360
  s_waitcnt lgkmcnt(4)
  v_mfma_f32_16x16x32_bf16 v[96:99], v[120:123], a[232:235], v[96:99]
  v_mfma_f32_16x16x32_bf16 v[100:103], v[120:123], a[236:239], v[100:103]
  ds_read_b128 v[120:123], v1 offset:17408
  s_waitcnt lgkmcnt(4)
  v_mfma_f32_16x16x32_bf16 v[104:107], v[124:127], v[216:219], v[104:107]
  v_mfma_f32_16x16x32_bf16 v[108:111], v[124:127], v[220:223], v[108:111]
  ds_read_b128 v[124:127], v1 offset:19456
  s_waitcnt lgkmcnt(4)
  v_mfma_f32_16x16x32_bf16 v[96:99], v[128:131], a[240:243], v[96:99]
  buffer_load_dwordx4 v[56:59], v32, s[8:11], s80 offen offset:0 sc1
  v_mfma_f32_16x16x32_bf16 v[100:103], v[128:131], a[244:247], v[100:103]
  ds_read_b128 v[128:131], v1 offset:21504
  s_waitcnt lgkmcnt(4)
  v_mfma_f32_16x16x32_bf16 v[96:99], v[112:115], a[248:251], v[96:99]
  buffer_load_dwordx4 v[60:63], v32, s[8:11], s80 offen offset:3072 sc1
  s_add_u32 s80, s80, 6144
  v_mfma_f32_16x16x32_bf16 v[100:103], v[112:115], a[252:255], v[100:103]
  ds_read_b128 v[112:115], v1 offset:23552
  s_waitcnt lgkmcnt(4)
  v_mfma_f32_16x16x32_bf16 v[104:107], v[116:119], v[224:227], v[104:107]
  buffer_load_dwordx4 v[64:67], v32, s[8:11], s80 offen offset:0 sc1
  v_mfma_f32_16x16x32_bf16 v[108:111], v[116:119], v[228:231], v[108:111]
  ds_read_b128 v[116:119], v1 offset:25600
  s_waitcnt lgkmcnt(4)
  v_mfma_f32_16x16x32_bf16 v[104:107], v[120:123], v[232:235], v[104:107]
  buffer_load_dwordx4 v[68:71], v32, s[8:11], s80 offen offset:3072 sc1
  s_add_u32 s80, s80, 6144
  v_mfma_f32_16x16x32_bf16 v[108:111], v[120:123], v[236:239], v[108:111]
  ds_read_b128 v[120:123], v1 offset:27648
  s_waitcnt lgkmcnt(4)
  v_mfma_f32_16x16x32_bf16 v[104:107], v[124:127], v[240:243], v[104:107]
  buffer_load_dwordx4 v[72:75], v32, s[8:11], s80 offen offset:0 sc1
  v_mul_f32 v136, v96, v154
  v_mfma_f32_16x16x32_bf16 v[108:111], v[124:127], v[244:247], v[108:111]
  ds_read_b128 v[124:127], v1 offset:29696
  s_waitcnt lgkmcnt(4)
  v_mfma_f32_16x16x32_bf16 v[104:107], v[128:131], v[248:251], v[104:107]
  buffer_load_dwordx4 v[76:79], v32, s[8:11], s80 offen offset:3072 sc1
  s_add_u32 s80, s80, 6144
  v_mfma_f32_16x16x32_bf16 v[108:111], v[128:131], v[252:255], v[108:111]
  ds_read_b128 v[128:131], v1 offset:31744
  s_waitcnt lgkmcnt(4)
  v_mfma_f32_16x16x32_bf16 v[104:107], v[112:115], a[192:195], v[104:107]
  buffer_load_dwordx4 v[80:83], v32, s[8:11], s80 offen offset:0 sc1
  v_mul_f32 v137, v97, v154
  v_mfma_f32_16x16x32_bf16 v[108:111], v[112:115], a[196:199], v[108:111]
  ds_read_b128 v[112:115], v1 offset:33792
  s_waitcnt lgkmcnt(4)
  v_mfma_f32_16x16x32_bf16 v[104:107], v[116:119], a[200:203], v[104:107]
  buffer_load_dwordx4 v[84:87], v32, s[8:11], s80 offen offset:3072 sc1
  v_mul_f32 v138, v98, v154
  v_mfma_f32_16x16x32_bf16 v[108:111], v[116:119], a[204:207], v[108:111]
  ds_read_b128 v[116:119], v1 offset:35840
  s_waitcnt lgkmcnt(4)
  v_mfma_f32_16x16x32_bf16 v[104:107], v[120:123], a[208:211], v[104:107]
  v_mul_f32 v139, v99, v154
  v_mul_f32 v140, v100, v155
  v_mfma_f32_16x16x32_bf16 v[108:111], v[120:123], a[212:215], v[108:111]
  ds_read_b128 v[120:123], v1 offset:37888
  s_waitcnt lgkmcnt(4)
  v_mfma_f32_16x16x32_bf16 v[104:107], v[124:127], a[216:219], v[104:107]
  v_mul_f32 v141, v101, v155
  v_mul_f32 v142, v102, v155
  v_mfma_f32_16x16x32_bf16 v[108:111], v[124:127], a[220:223], v[108:111]
  s_waitcnt lgkmcnt(3)
  v_mfma_f32_16x16x32_bf16 v[104:107], v[128:131], a[224:227], v[104:107]
  v_mul_f32 v143, v103, v155
  v_mfma_f32_16x16x32_bf16 v[108:111], v[128:131], a[228:231], v[108:111]
  s_waitcnt lgkmcnt(2)
  v_mfma_f32_16x16x32_bf16 v[104:107], v[112:115], a[232:235], v[104:107]
  v_exp_f32 v136, v136 clamp
  v_mfma_f32_16x16x32_bf16 v[108:111], v[112:115], a[236:239], v[108:111]
  s_waitcnt lgkmcnt(1)
  v_mfma_f32_16x16x32_bf16 v[104:107], v[116:119], a[240:243], v[104:107]
  v_exp_f32 v137, v137 clamp
  v_mfma_f32_16x16x32_bf16 v[108:111], v[116:119], a[244:247], v[108:111]
  s_waitcnt lgkmcnt(0)
  v_mfma_f32_16x16x32_bf16 v[104:107], v[120:123], a[248:251], v[104:107]
  v_exp_f32 v138, v138 clamp
  v_mfma_f32_16x16x32_bf16 v[108:111], v[120:123], a[252:255], v[108:111]
  v_exp_f32 v139, v139 clamp
  v_exp_f32 v140, v140 clamp
  v_exp_f32 v141, v141 clamp
  v_exp_f32 v142, v142 clamp
  v_exp_f32 v143, v143 clamp
  v_fma_f32 v96, v96, v152, 1.0
  v_fma_f32 v97, v97, v152, 1.0
  v_fma_f32 v98, v98, v152, 1.0
  v_fma_f32 v99, v99, v152, 1.0
  v_fma_f32 v100, v100, v153, 1.0
  v_fma_f32 v101, v101, v153, 1.0
  v_fma_f32 v102, v102, v153, 1.0
  v_fma_f32 v103, v103, v153, 1.0
  v_max_f32 v96, v96, v136
  v_max_f32 v97, v97, v137
  v_max_f32 v98, v98, v138
  v_max_f32 v99, v99, v139
  v_max_f32 v100, v100, v140
  v_max_f32 v101, v101, v141
  v_max_f32 v102, v102, v142
  v_max_f32 v103, v103, v143
  v_pk_mul_f32 v[112:113], v[104:105], v[154:155] op_sel_hi:[1,0]
  v_pk_mul_f32 v[114:115], v[106:107], v[154:155] op_sel_hi:[1,0]
  v_pk_mul_f32 v[116:117], v[108:109], v[154:155] op_sel:[0,1] op_sel_hi:[1,1]
  v_pk_mul_f32 v[118:119], v[110:111], v[154:155] op_sel:[0,1] op_sel_hi:[1,1]
  v_exp_f32 v112, v112 clamp
  v_exp_f32 v113, v113 clamp
  v_pk_fma_f32 v[104:105], v[104:105], v[152:153], 1.0 op_sel_hi:[1,0,0]
  v_exp_f32 v114, v114 clamp
  v_exp_f32 v115, v115 clamp
  v_pk_fma_f32 v[106:107], v[106:107], v[152:153], 1.0 op_sel_hi:[1,0,0]
  v_exp_f32 v116, v116 clamp
  v_exp_f32 v117, v117 clamp
  v_pk_fma_f32 v[108:109], v[108:109], v[152:153], 1.0 op_sel:[0,1,0] op_sel_hi:[1,1,0]
  v_exp_f32 v118, v118 clamp
  v_exp_f32 v119, v119 clamp
  v_pk_fma_f32 v[110:111], v[110:111], v[152:153], 1.0 op_sel:[0,1,0] op_sel_hi:[1,1,0]
  s_mov_b32 s86, 0x358637bd
  s_mov_b32 s87, 0x358637bd
  v_max_f32 v104, v104, v112
  v_max_f32 v105, v105, v113
  v_pk_add_f32 v[104:105], v[104:105], s[86:87]
  v_max_f32 v106, v106, v114
  v_max_f32 v107, v107, v115
  v_pk_add_f32 v[106:107], v[106:107], s[86:87]
  v_max_f32 v108, v108, v116
  v_max_f32 v109, v109, v117
  v_pk_add_f32 v[108:109], v[108:109], s[86:87]
  v_max_f32 v110, v110, v118
  v_max_f32 v111, v111, v119
  v_pk_add_f32 v[110:111], v[110:111], s[86:87]
  v_pk_add_f32 v[96:97], v[96:97], s[86:87]
  v_pk_add_f32 v[98:99], v[98:99], s[86:87]
  v_pk_add_f32 v[100:101], v[100:101], s[86:87]
  v_pk_add_f32 v[102:103], v[102:103], s[86:87]
  v_cvt_pk_bf16_f32 v156, v96, v97
  v_cvt_pk_bf16_f32 v157, v98, v99
  v_cvt_pk_bf16_f32 v158, v104, v105
  v_cvt_pk_bf16_f32 v159, v106, v107
  v_cvt_pk_bf16_f32 v160, v100, v101
  v_cvt_pk_bf16_f32 v161, v102, v103
  v_cvt_pk_bf16_f32 v162, v108, v109
  v_cvt_pk_bf16_f32 v163, v110, v111
  v_permlane16_swap_b32 v156, v160
  v_permlane16_swap_b32 v157, v161
  v_permlane16_swap_b32 v158, v162
  v_permlane16_swap_b32 v159, v163
Lgat_66:
  s_waitcnt vmcnt(7)
  v_lshlrev_b32 v88, 16, v56
  v_and_b32 v89, 0xffff0000, v56
  v_lshlrev_b32 v90, 16, v57
  v_and_b32 v91, 0xffff0000, v57
  v_lshlrev_b32 v92, 16, v58
  v_and_b32 v93, 0xffff0000, v58
  v_lshlrev_b32 v94, 16, v59
  v_and_b32 v95, 0xffff0000, v59
  s_waitcnt vmcnt(6)
  v_dot2c_f32_bf16 v88, v60, v48
  v_dot2c_f32_bf16 v89, v60, v49
  v_dot2c_f32_bf16 v90, v61, v48
  v_dot2c_f32_bf16 v91, v61, v49
  v_dot2c_f32_bf16 v92, v62, v48
  v_dot2c_f32_bf16 v93, v62, v49
  v_dot2c_f32_bf16 v94, v63, v48
  v_dot2c_f32_bf16 v95, v63, v49
  s_waitcnt vmcnt(5)
  v_dot2c_f32_bf16 v88, v64, v48
  v_dot2c_f32_bf16 v89, v64, v49
  v_dot2c_f32_bf16 v90, v65, v48
  v_dot2c_f32_bf16 v91, v65, v49
  v_dot2c_f32_bf16 v92, v66, v48
  v_dot2c_f32_bf16 v93, v66, v49
  v_dot2c_f32_bf16 v94, v67, v48
  v_dot2c_f32_bf16 v95, v67, v49
  s_waitcnt vmcnt(4)
  v_dot2c_f32_bf16 v88, v68, v48
  v_dot2c_f32_bf16 v89, v68, v49
  v_dot2c_f32_bf16 v90, v69, v48
  v_dot2c_f32_bf16 v91, v69, v49
  v_dot2c_f32_bf16 v92, v70, v48
  v_dot2c_f32_bf16 v93, v70, v49
  v_dot2c_f32_bf16 v94, v71, v48
  v_dot2c_f32_bf16 v95, v71, v49
  s_waitcnt vmcnt(3)
  v_dot2c_f32_bf16 v88, v72, v48
  v_dot2c_f32_bf16 v89, v72, v49
  v_dot2c_f32_bf16 v90, v73, v48
  v_dot2c_f32_bf16 v91, v73, v49
  v_dot2c_f32_bf16 v92, v74, v48
  v_dot2c_f32_bf16 v93, v74, v49
  v_dot2c_f32_bf16 v94, v75, v48
  v_dot2c_f32_bf16 v95, v75, v49
  s_waitcnt vmcnt(2)
  v_dot2c_f32_bf16 v88, v76, v48
  v_dot2c_f32_bf16 v89, v76, v49
  v_dot2c_f32_bf16 v90, v77, v48
  v_dot2c_f32_bf16 v91, v77, v49
  v_dot2c_f32_bf16 v92, v78, v48
  v_dot2c_f32_bf16 v93, v78, v49
  v_dot2c_f32_bf16 v94, v79, v48
  v_dot2c_f32_bf16 v95, v79, v49
  s_waitcnt vmcnt(1)
  v_dot2c_f32_bf16 v88, v80, v48
  v_dot2c_f32_bf16 v89, v80, v49
  v_dot2c_f32_bf16 v90, v81, v48
  v_dot2c_f32_bf16 v91, v81, v49
  v_dot2c_f32_bf16 v92, v82, v48
  v_dot2c_f32_bf16 v93, v82, v49
  v_dot2c_f32_bf16 v94, v83, v48
  v_dot2c_f32_bf16 v95, v83, v49
  s_waitcnt vmcnt(0)
  v_dot2c_f32_bf16 v88, v84, v48
  v_dot2c_f32_bf16 v89, v84, v49
  v_dot2c_f32_bf16 v90, v85, v48
  v_dot2c_f32_bf16 v91, v85, v49
  v_dot2c_f32_bf16 v92, v86, v48
  v_dot2c_f32_bf16 v93, v86, v49
  v_dot2c_f32_bf16 v94, v87, v48
  v_dot2c_f32_bf16 v95, v87, v49
  s_nop 1
  v_permlane32_swap_b32 v88, v92
  v_permlane32_swap_b32 v89, v93
  v_permlane32_swap_b32 v90, v94
  v_permlane32_swap_b32 v91, v95
  v_pk_add_f32 v[88:89], v[88:89], v[92:93]
  v_pk_add_f32 v[90:91], v[90:91], v[94:95]
  v_cmp_u_f32 vcc, v88, v89
  v_cmp_u_f32 s[86:87], v90, v91
  v_cvt_pk_bf16_f32 v88, v88, v89
  v_cvt_pk_bf16_f32 v89, v90, v91
  s_or_b64 vcc, vcc, s[86:87]
  s_cbranch_scc0 Lgatdone_68
  s_cmp_eq_u32 s57, 0
  s_cbranch_scc1 Lgatdone_68
  s_sub_u32 s57, s57, 1
  s_mov_b32 s80, s74
  buffer_load_dwordx4 v[56:59], v32, s[8:11], s80 offen offset:0 sc1
  buffer_load_dwordx4 v[60:63], v32, s[8:11], s80 offen offset:3072 sc1
  s_add_u32 s80, s80, 6144
  buffer_load_dwordx4 v[64:67], v32, s[8:11], s80 offen offset:0 sc1
  buffer_load_dwordx4 v[68:71], v32, s[8:11], s80 offen offset:3072 sc1
  s_add_u32 s80, s80, 6144
  buffer_load_dwordx4 v[72:75], v32, s[8:11], s80 offen offset:0 sc1
  buffer_load_dwordx4 v[76:79], v32, s[8:11], s80 offen offset:3072 sc1
  s_add_u32 s80, s80, 6144
  buffer_load_dwordx4 v[80:83], v32, s[8:11], s80 offen offset:0 sc1
  buffer_load_dwordx4 v[84:87], v32, s[8:11], s80 offen offset:3072 sc1
  s_branch Lgat_66
Lgatdone_68:
  ds_write_b64 v33, v[88:89]
  v_mov_b32 v137, 0
  v_mov_b32 v139, 0
  s_add_u32 s74, s74, 393216
  s_waitcnt lgkmcnt(0)
  s_barrier
  ds_read_b128 v[128:131], v34 offset:0
  ds_read_b32 v136, v35 offset:0
  ds_read_b128 v[132:135], v34 offset:720
  ds_read_b32 v138, v35 offset:720
  s_waitcnt lgkmcnt(0)
  v_mfma_f32_32x32x16_bf16 v[208:223], v[128:131], v[156:159], 0
  v_mfma_f32_32x32x8_bf16 v[208:223], v[136:137], v[168:169], v[208:223]
  v_mfma_f32_32x32x16_bf16 v[224:239], v[132:135], v[160:163], 0
  v_mfma_f32_32x32x8_bf16 v[224:239], v[138:139], v[170:171], v[224:239]
  s_nop 9
  v_add_f32 v218, 0x358637bd, v218
  v_rcp_f32 v220, v218
  s_nop 0
  v_pk_mul_f32 v[208:209], v[208:209], v[220:221] op_sel_hi:[1,0]
  v_pk_mul_f32 v[210:211], v[210:211], v[220:221] op_sel_hi:[1,0]
  v_pk_mul_f32 v[212:213], v[212:213], v[220:221] op_sel_hi:[1,0]
  v_pk_mul_f32 v[214:215], v[214:215], v[220:221] op_sel_hi:[1,0]
  v_pk_mul_f32 v[216:217], v[216:217], v[220:221] op_sel_hi:[1,0]
  v_cvt_pk_bf16_f32 v240, v208, v209
  v_cvt_pk_bf16_f32 v241, v210, v211
  v_cvt_pk_bf16_f32 v242, v212, v213
  v_cvt_pk_bf16_f32 v243, v214, v215
  s_cmp_lg_u32 s56, 0
  s_cbranch_scc1 Lsafe_70
  buffer_store_dwordx4 v[240:243], v7, s[8:11], s67 offen offset:0
Lback_71:
  v_cvt_pk_bf16_f32 v248, v216, v217
  v_add_f32 v234, 0x358637bd, v234
  v_rcp_f32 v236, v234
  s_nop 0
  v_pk_mul_f32 v[224:225], v[224:225], v[236:237] op_sel_hi:[1,0]
  v_pk_mul_f32 v[226:227], v[226:227], v[236:237] op_sel_hi:[1,0]
  v_pk_mul_f32 v[228:229], v[228:229], v[236:237] op_sel_hi:[1,0]
  v_pk_mul_f32 v[230:231], v[230:231], v[236:237] op_sel_hi:[1,0]
  v_pk_mul_f32 v[232:233], v[232:233], v[236:237] op_sel_hi:[1,0]
  v_cvt_pk_bf16_f32 v244, v224, v225
  v_cvt_pk_bf16_f32 v245, v226, v227
  v_cvt_pk_bf16_f32 v246, v228, v229
  v_cvt_pk_bf16_f32 v247, v230, v231
  v_cvt_pk_bf16_f32 v249, v232, v233
  s_cmp_lg_u32 s56, 0
  s_cbranch_scc1 Lsafe_72
  buffer_store_dwordx4 v[244:247], v7, s[8:11], s67 offen offset:512
  buffer_store_dwordx2 v[248:249], v8, s[8:11], s68 offen
Lback_73:
  v_lshlrev_b32 v56, 16, v22
  v_and_b32 v57, 0xffff0000, v22
  v_lshlrev_b32 v58, 16, v23
  v_and_b32 v59, 0xffff0000, v23
  v_lshlrev_b32 v60, 16, v24
  v_and_b32 v61, 0xffff0000, v24
  v_lshlrev_b32 v62, 16, v25
  v_and_b32 v63, 0xffff0000, v25
  v_lshlrev_b32 v64, 16, v26
  v_and_b32 v65, 0xffff0000, v26
  v_lshlrev_b32 v66, 16, v27
  v_and_b32 v67, 0xffff0000, v27
  v_lshlrev_b32 v68, 16, v28
  v_and_b32 v69, 0xffff0000, v28
  v_lshlrev_b32 v70, 16, v29
  v_and_b32 v71, 0xffff0000, v29
  v_lshlrev_b32 v72, 16, v30
  v_and_b32 v73, 0xffff0000, v30
  v_lshlrev_b32 v74, 16, v31
  v_and_b32 v75, 0xffff0000, v31
  s_waitcnt vmcnt(11)
  s_barrier
  ds_write_b128 v38, a[96:99] offset:0
  ds_write_b128 v38, a[100:103] offset:1024
  s_mov_b64 exec, 3
  s_waitcnt vmcnt(0)
  s_cmp_lg_u32 s56, 0
  s_cbranch_scc1 Lsafe_74
  buffer_store_dword v17, v12, s[8:11], s69 offen
Lback_75:
  s_mov_b64 exec, -1
  ds_read_b128 v[76:79], v2 offset:0
  ds_read_b128 v[80:83], v2 offset:1024
  ds_read_b128 v[84:87], v2 offset:2048
  ds_read_b128 v[88:91], v2 offset:3072
  ds_read_b128 v[92:95], v2 offset:4096
  ds_read_b128 v[96:99], v2 offset:5120
  ds_read_b128 v[100:103], v2 offset:6144
  ds_read_b128 v[104:107], v2 offset:7168
  ds_read_b128 v[108:111], v2 offset:8192
  ds_read_b128 v[112:115], v2 offset:9216
  ds_write_b128 v38, a[104:107] offset:2048
  ds_write_b128 v38, a[108:111] offset:3072
  buffer_load_dword v165, v39, s[8:11], s71 offen sc1
  ds_write_b128 v38, a[112:115] offset:16384
  ds_write_b128 v38, a[116:119] offset:17408
  ds_write_b128 v38, a[120:123] offset:18432
  ds_write_b128 v38, a[124:127] offset:19456
  s_mul_i32 s34, s54, 10240
  s_min_u32 s34, s34, 28672
  s_add_u32 s35, s34, 97280
  s_add_u32 s34, s34, s38
  s_add_u32 s34, s34, 2276352
  s_mov_b32 s32, s70
Lpoll_76:
  s_waitcnt vmcnt(0)
  v_cmp_ne_u32 vcc, s55, v165
  s_nop 0
  s_cmp_lg_u64 vcc, 0
  s_cbranch_scc0 Lpdone_78
  s_cmp_eq_u32 s57, 0
  s_cbranch_scc1 Lpdone_78
  s_sub_u32 s57, s57, 1
  buffer_load_dword v165, v39, s[8:11], s71 offen sc1
  s_branch Lpoll_76
Lpdone_78:
  buffer_load_dwordx4 v[176:179], v1, s[8:11], s32 offen offset:0 sc1
  buffer_load_dwordx4 v[180:183], v1, s[8:11], s32 offen offset:1024 sc1
  ds_write_b128 v38, a[128:131] offset:32768
  buffer_load_dwordx4 v[184:187], v1, s[8:11], s32 offen offset:2048 sc1
  ds_write_b128 v38, a[132:135] offset:33792
  buffer_load_dwordx4 v[188:191], v1, s[8:11], s32 offen offset:3072 sc1
  ds_write_b128 v38, a[136:139] offset:34816
  s_add_u32 s32, s32, 4096
  buffer_load_dwordx4 v[192:195], v1, s[8:11], s32 offen offset:0 sc1
  ds_write_b128 v38, a[140:143] offset:35840
  buffer_load_dwordx4 v[196:199], v1, s[8:11], s32 offen offset:1024 sc1
  s_waitcnt vmcnt(5) lgkmcnt(5)
  v_mfma_f32_16x16x32_bf16 v[56:59], v[76:79], v[176:179], v[56:59]
  ds_read_b128 v[116:119], v2 offset:10240
  buffer_load_dwordx4 v[200:203], v1, s[8:11], s32 offen offset:2048 sc1
  v_mfma_f32_16x16x32_bf16 v[60:63], v[80:83], v[176:179], v[60:63]
  ds_read_b128 v[120:123], v2 offset:11264
  buffer_load_dwordx4 v[204:207], v1, s[8:11], s32 offen offset:3072 sc1
  v_mfma_f32_16x16x32_bf16 v[64:67], v[84:87], v[176:179], v[64:67]
  ds_read_b128 v[124:127], v2 offset:12288
  s_add_u32 s32, s32, 4096
  v_mfma_f32_16x16x32_bf16 v[68:71], v[88:91], v[176:179], v[68:71]
  ds_read_b128 v[128:131], v2 offset:13312
  v_mfma_f32_16x16x32_bf16 v[72:75], v[92:95], v[176:179], v[72:75]
  ds_read_b128 v[132:135], v2 offset:14336
  s_waitcnt vmcnt(6) lgkmcnt(5)
  v_mfma_f32_16x16x32_bf16 v[56:59], v[96:99], v[180:183], v[56:59]
  ds_read_b128 v[76:79], v2 offset:15360
  buffer_load_dwordx4 v[208:211], v1, s[8:11], s32 offen offset:0 sc1
  v_mfma_f32_16x16x32_bf16 v[60:63], v[100:103], v[180:183], v[60:63]
  ds_read_b128 v[80:83], v2 offset:16384
  buffer_load_dwordx4 v[212:215], v1, s[8:11], s32 offen offset:1024 sc1
  v_mfma_f32_16x16x32_bf16 v[64:67], v[104:107], v[180:183], v[64:67]
  ds_read_b128 v[84:87], v2 offset:17408
  v_mfma_f32_16x16x32_bf16 v[68:71], v[108:111], v[180:183], v[68:71]
  ds_read_b128 v[88:91], v2 offset:18432
  v_mfma_f32_16x16x32_bf16 v[72:75], v[112:115], v[180:183], v[72:75]
  ds_read_b128 v[92:95], v2 offset:19456
  s_waitcnt vmcnt(7) lgkmcnt(5)
  v_mfma_f32_16x16x32_bf16 v[56:59], v[116:119], v[184:187], v[56:59]
  ds_read_b128 v[96:99], v2 offset:20480
  buffer_load_dwordx4 v[216:219], v1, s[8:11], s32 offen offset:2048 sc1
  v_mfma_f32_16x16x32_bf16 v[60:63], v[120:123], v[184:187], v[60:63]
  ds_read_b128 v[100:103], v2 offset:21504
  v_mfma_f32_16x16x32_bf16 v[64:67], v[124:127], v[184:187], v[64:67]
  ds_read_b128 v[104:107], v2 offset:22528
  v_mfma_f32_16x16x32_bf16 v[68:71], v[128:131], v[184:187], v[68:71]
  ds_read_b128 v[108:111], v2 offset:23552
  v_mfma_f32_16x16x32_bf16 v[72:75], v[132:135], v[184:187], v[72:75]
  ds_read_b128 v[112:115], v2 offset:24576
  s_waitcnt vmcnt(7) lgkmcnt(5)
  v_mfma_f32_16x16x32_bf16 v[56:59], v[76:79], v[188:191], v[56:59]
  ds_read_b128 v[116:119], v2 offset:25600
  buffer_load_dwordx4 v[220:223], v1, s[8:11], s32 offen offset:3072 sc1
  v_mfma_f32_16x16x32_bf16 v[60:63], v[80:83], v[188:191], v[60:63]
  ds_read_b128 v[120:123], v2 offset:26624
  s_add_u32 s32, s32, 4096
  v_mfma_f32_16x16x32_bf16 v[64:67], v[84:87], v[188:191], v[64:67]
  ds_read_b128 v[124:127], v2 offset:27648
  buffer_load_dwordx4 v[224:227], v1, s[8:11], s32 offen offset:0 sc1
  v_mfma_f32_16x16x32_bf16 v[68:71], v[88:91], v[188:191], v[68:71]
  ds_read_b128 v[128:131], v2 offset:28672
  v_mfma_f32_16x16x32_bf16 v[72:75], v[92:95], v[188:191], v[72:75]
  ds_read_b128 v[132:135], v2 offset:29696
  s_waitcnt vmcnt(8) lgkmcnt(5)
  v_mfma_f32_16x16x32_bf16 v[56:59], v[96:99], v[192:195], v[56:59]
  ds_read_b128 v[76:79], v2 offset:30720
  buffer_load_dwordx4 v[228:231], v1, s[8:11], s32 offen offset:1024 sc1
  v_mfma_f32_16x16x32_bf16 v[60:63], v[100:103], v[192:195], v[60:63]
  ds_read_b128 v[80:83], v2 offset:31744
  v_mfma_f32_16x16x32_bf16 v[64:67], v[104:107], v[192:195], v[64:67]
  ds_read_b128 v[84:87], v2 offset:32768
  v_mfma_f32_16x16x32_bf16 v[68:71], v[108:111], v[192:195], v[68:71]
  ds_read_b128 v[88:91], v2 offset:33792
  v_mfma_f32_16x16x32_bf16 v[72:75], v[112:115], v[192:195], v[72:75]
  ds_read_b128 v[92:95], v2 offset:34816
  s_waitcnt vmcnt(8) lgkmcnt(5)
  v_mfma_f32_16x16x32_bf16 v[56:59], v[116:119], v[196:199], v[56:59]
  ds_read_b128 v[96:99], v2 offset:35840
  buffer_load_dwordx4 v[232:235], v1, s[8:11], s32 offen offset:2048 sc1
  v_mfma_f32_16x16x32_bf16 v[60:63], v[120:123], v[196:199], v[60:63]
  ds_read_b128 v[100:103], v2 offset:36864
  buffer_load_dwordx4 v[236:239], v1, s[8:11], s32 offen offset:3072 sc1
  v_mfma_f32_16x16x32_bf16 v[64:67], v[124:127], v[196:199], v[64:67]
  ds_read_b128 v[104:107], v2 offset:37888
  s_add_u32 s32, s32, 4096
  v_mfma_f32_16x16x32_bf16 v[68:71], v[128:131], v[196:199], v[68:71]
  ds_read_b128 v[108:111], v2 offset:38912
  v_mfma_f32_16x16x32_bf16 v[72:75], v[132:135], v[196:199], v[72:75]
  ds_read_b128 v[112:115], v2 offset:39936
  s_waitcnt vmcnt(9) lgkmcnt(5)
  v_mfma_f32_16x16x32_bf16 v[56:59], v[76:79], v[200:203], v[56:59]
  ds_read_b128 v[116:119], v2 offset:40960
  buffer_load_dwordx4 v[240:243], v1, s[8:11], s32 offen offset:0 sc1
  v_mfma_f32_16x16x32_bf16 v[60:63], v[80:83], v[200:203], v[60:63]
  ds_read_b128 v[120:123], v2 offset:41984
  v_mfma_f32_16x16x32_bf16 v[64:67], v[84:87], v[200:203], v[64:67]
  ds_read_b128 v[124:127], v2 offset:43008
  v_mfma_f32_16x16x32_bf16 v[68:71], v[88:91], v[200:203], v[68:71]
  ds_read_b128 v[128:131], v2 offset:44032
  v_mfma_f32_16x16x32_bf16 v[72:75], v[92:95], v[200:203], v[72:75]
  ds_read_b128 v[132:135], v2 offset:45056
  s_waitcnt vmcnt(9) lgkmcnt(5)
  v_mfma_f32_16x16x32_bf16 v[56:59], v[96:99], v[204:207], v[56:59]
  ds_read_b128 v[76:79], v2 offset:46080
  buffer_load_dwordx4 v[244:247], v1, s[8:11], s32 offen offset:1024 sc1
  v_mfma_f32_16x16x32_bf16 v[60:63], v[100:103], v[204:207], v[60:63]
  ds_read_b128 v[80:83], v2 offset:47104
  v_mfma_f32_16x16x32_bf16 v[64:67], v[104:107], v[204:207], v[64:67]
  ds_read_b128 v[84:87], v2 offset:48128
  v_mfma_f32_16x16x32_bf16 v[68:71], v[108:111], v[204:207], v[68:71]
  ds_read_b128 v[88:91], v2 offset:49152
  v_mfma_f32_16x16x32_bf16 v[72:75], v[112:115], v[204:207], v[72:75]
  ds_read_b128 v[92:95], v2 offset:50176
  s_waitcnt vmcnt(9) lgkmcnt(5)
  v_mfma_f32_16x16x32_bf16 v[56:59], v[116:119], v[208:211], v[56:59]
  ds_read_b128 v[96:99], v2 offset:51200
  v_mfma_f32_16x16x32_bf16 v[60:63], v[120:123], v[208:211], v[60:63]
  ds_read_b128 v[100:103], v2 offset:52224
  v_mfma_f32_16x16x32_bf16 v[64:67], v[124:127], v[208:211], v[64:67]
  ds_read_b128 v[104:107], v2 offset:53248
  v_mfma_f32_16x16x32_bf16 v[68:71], v[128:131], v[208:211], v[68:71]
  ds_read_b128 v[108:111], v2 offset:54272
  v_mfma_f32_16x16x32_bf16 v[72:75], v[132:135], v[208:211], v[72:75]
  ds_read_b128 v[112:115], v2 offset:55296
  s_waitcnt vmcnt(8) lgkmcnt(5)
  v_mfma_f32_16x16x32_bf16 v[56:59], v[76:79], v[212:215], v[56:59]
  ds_read_b128 v[116:119], v2 offset:56320
  v_mfma_f32_16x16x32_bf16 v[60:63], v[80:83], v[212:215], v[60:63]
  ds_read_b128 v[120:123], v2 offset:57344
  v_mfma_f32_16x16x32_bf16 v[64:67], v[84:87], v[212:215], v[64:67]
  ds_read_b128 v[124:127], v2 offset:58368
  v_mfma_f32_16x16x32_bf16 v[68:71], v[88:91], v[212:215], v[68:71]
  ds_read_b128 v[128:131], v2 offset:59392
  v_mfma_f32_16x16x32_bf16 v[72:75], v[92:95], v[212:215], v[72:75]
  ds_read_b128 v[132:135], v2 offset:60416
  s_waitcnt vmcnt(7) lgkmcnt(5)
  v_mfma_f32_16x16x32_bf16 v[56:59], v[96:99], v[216:219], v[56:59]
  ds_read_b128 v[76:79], v2 offset:61440
  v_mfma_f32_16x16x32_bf16 v[60:63], v[100:103], v[216:219], v[60:63]
  ds_read_b128 v[80:83], v2 offset:62464
  v_mfma_f32_16x16x32_bf16 v[64:67], v[104:107], v[216:219], v[64:67]
  ds_read_b128 v[84:87], v2 offset:63488
  v_mfma_f32_16x16x32_bf16 v[68:71], v[108:111], v[216:219], v[68:71]
  ds_read_b128 v[88:91], v2 offset:64512
  v_mfma_f32_16x16x32_bf16 v[72:75], v[112:115], v[216:219], v[72:75]
  ds_read_b128 v[92:95], v18 offset:0
  s_waitcnt vmcnt(6) lgkmcnt(5)
  v_mfma_f32_16x16x32_bf16 v[56:59], v[116:119], v[220:223], v[56:59]
  ds_read_b128 v[96:99], v18 offset:1024
  v_mfma_f32_16x16x32_bf16 v[60:63], v[120:123], v[220:223], v[60:63]
  ds_read_b128 v[100:103], v18 offset:2048
  v_mfma_f32_16x16x32_bf16 v[64:67], v[124:127], v[220:223], v[64:67]
  ds_read_b128 v[104:107], v18 offset:3072
  v_mfma_f32_16x16x32_bf16 v[68:71], v[128:131], v[220:223], v[68:71]
  ds_read_b128 v[108:111], v18 offset:4096
  v_mfma_f32_16x16x32_bf16 v[72:75], v[132:135], v[220:223], v[72:75]
  ds_read_b128 v[112:115], v18 offset:5120
  s_waitcnt vmcnt(5) lgkmcnt(5)
  v_mfma_f32_16x16x32_bf16 v[56:59], v[76:79], v[224:227], v[56:59]
  ds_read_b128 v[116:119], v18 offset:6144
  v_mfma_f32_16x16x32_bf16 v[60:63], v[80:83], v[224:227], v[60:63]
  ds_read_b128 v[120:123], v18 offset:7168
  v_mfma_f32_16x16x32_bf16 v[64:67], v[84:87], v[224:227], v[64:67]
  ds_read_b128 v[124:127], v18 offset:8192
  v_mfma_f32_16x16x32_bf16 v[68:71], v[88:91], v[224:227], v[68:71]
  ds_read_b128 v[128:131], v18 offset:9216
  v_mfma_f32_16x16x32_bf16 v[72:75], v[92:95], v[224:227], v[72:75]
  ds_read_b128 v[132:135], v18 offset:10240
  s_waitcnt vmcnt(4) lgkmcnt(5)
  v_mfma_f32_16x16x32_bf16 v[56:59], v[96:99], v[228:231], v[56:59]
  ds_read_b128 v[76:79], v18 offset:11264
  v_mfma_f32_16x16x32_bf16 v[60:63], v[100:103], v[228:231], v[60:63]
  ds_read_b128 v[80:83], v18 offset:12288
  v_mfma_f32_16x16x32_bf16 v[64:67], v[104:107], v[228:231], v[64:67]
  ds_read_b128 v[84:87], v18 offset:13312
  v_mfma_f32_16x16x32_bf16 v[68:71], v[108:111], v[228:231], v[68:71]
  ds_read_b128 v[88:91], v18 offset:14336
  v_mfma_f32_16x16x32_bf16 v[72:75], v[112:115], v[228:231], v[72:75]
  ds_read_b128 v[92:95], v18 offset:15360
  s_waitcnt vmcnt(3) lgkmcnt(5)
  v_mfma_f32_16x16x32_bf16 v[56:59], v[116:119], v[232:235], v[56:59]
  ds_read_b128 v[96:99], v18 offset:16384
  v_mfma_f32_16x16x32_bf16 v[60:63], v[120:123], v[232:235], v[60:63]
  ds_read_b128 v[100:103], v18 offset:17408
  v_mfma_f32_16x16x32_bf16 v[64:67], v[124:127], v[232:235], v[64:67]
  ds_read_b128 v[104:107], v18 offset:18432
  v_mfma_f32_16x16x32_bf16 v[68:71], v[128:131], v[232:235], v[68:71]
  ds_read_b128 v[108:111], v18 offset:19456
  v_mfma_f32_16x16x32_bf16 v[72:75], v[132:135], v[232:235], v[72:75]
  ds_read_b128 v[112:115], v18 offset:20480
  s_waitcnt vmcnt(2) lgkmcnt(5)
  v_mfma_f32_16x16x32_bf16 v[56:59], v[76:79], v[236:239], v[56:59]
  ds_read_b128 v[116:119], v18 offset:21504
  v_mfma_f32_16x16x32_bf16 v[60:63], v[80:83], v[236:239], v[60:63]
  ds_read_b128 v[120:123], v18 offset:22528
  v_mfma_f32_16x16x32_bf16 v[64:67], v[84:87], v[236:239], v[64:67]
  ds_read_b128 v[124:127], v18 offset:23552
  v_mfma_f32_16x16x32_bf16 v[68:71], v[88:91], v[236:239], v[68:71]
  ds_read_b128 v[128:131], v18 offset:24576
  v_mfma_f32_16x16x32_bf16 v[72:75], v[92:95], v[236:239], v[72:75]
  ds_read_b128 v[132:135], v18 offset:25600
  s_waitcnt vmcnt(1) lgkmcnt(5)
  v_mfma_f32_16x16x32_bf16 v[56:59], v[96:99], v[240:243], v[56:59]
  v_mfma_f32_16x16x32_bf16 v[60:63], v[100:103], v[240:243], v[60:63]
  v_mfma_f32_16x16x32_bf16 v[64:67], v[104:107], v[240:243], v[64:67]
  v_mfma_f32_16x16x32_bf16 v[68:71], v[108:111], v[240:243], v[68:71]
  v_mfma_f32_16x16x32_bf16 v[72:75], v[112:115], v[240:243], v[72:75]
  s_waitcnt vmcnt(0) lgkmcnt(0)
  v_mfma_f32_16x16x32_bf16 v[56:59], v[116:119], v[244:247], v[56:59]
  v_mfma_f32_16x16x32_bf16 v[60:63], v[120:123], v[244:247], v[60:63]
  v_mfma_f32_16x16x32_bf16 v[64:67], v[124:127], v[244:247], v[64:67]
  v_mfma_f32_16x16x32_bf16 v[68:71], v[128:131], v[244:247], v[68:71]
  v_mfma_f32_16x16x32_bf16 v[72:75], v[132:135], v[244:247], v[72:75]
  s_add_u32 s55, s55, 1
  v_mov_b32 v17, s55
  s_nop 1
  v_cvt_pk_bf16_f32 v22, v56, v57
  v_cvt_pk_bf16_f32 v23, v58, v59
  v_cvt_pk_bf16_f32 v24, v60, v61
  v_cvt_pk_bf16_f32 v25, v62, v63
  v_cvt_pk_bf16_f32 v26, v64, v65
  v_cvt_pk_bf16_f32 v27, v66, v67
  v_cvt_pk_bf16_f32 v28, v68, v69
  v_cvt_pk_bf16_f32 v29, v70, v71
  v_cvt_pk_bf16_f32 v30, v72, v73
  v_cvt_pk_bf16_f32 v31, v74, v75
  s_cmp_lg_u32 s56, 0
  s_cbranch_scc1 Lsafe_80
  buffer_store_dwordx4 v[22:25], v1, s[28:31], s64 offen
  buffer_store_dwordx4 v[26:29], v1, s[28:31], s64 offen offset:2048
  buffer_store_dwordx2 v[30:31], v5, s[28:31], s65 offen
Lback_81:
  v_mov_b32 v52, 0
  v_mov_b32 v53, 0
  v_mov_b32 v54, 0x3f803f80
  v_dot2c_f32_bf16 v52, v22, v54
  v_dot2c_f32_bf16 v53, v22, v22
  v_dot2c_f32_bf16 v52, v23, v54
  v_dot2c_f32_bf16 v53, v23, v23
  v_dot2c_f32_bf16 v52, v24, v54
  v_dot2c_f32_bf16 v53, v24, v24
  v_dot2c_f32_bf16 v52, v25, v54
  v_dot2c_f32_bf16 v53, v25, v25
  v_dot2c_f32_bf16 v52, v26, v54
  v_dot2c_f32_bf16 v53, v26, v26
  v_dot2c_f32_bf16 v52, v27, v54
  v_dot2c_f32_bf16 v53, v27, v27
  v_dot2c_f32_bf16 v52, v28, v54
  v_dot2c_f32_bf16 v53, v28, v28
  v_dot2c_f32_bf16 v52, v29, v54
  v_dot2c_f32_bf16 v53, v29, v29
  v_dot2c_f32_bf16 v52, v30, v54
  v_dot2c_f32_bf16 v53, v30, v30
  v_dot2c_f32_bf16 v52, v31, v54
  v_dot2c_f32_bf16 v53, v31, v31
  s_nop 2
  v_mov_b32 v54, v52
  v_mov_b32 v55, v53
  s_nop 0
  v_permlane32_swap_b32 v54, v52
  v_permlane32_swap_b32 v55, v53
  v_add_f32 v52, v52, v54
  v_add_f32 v53, v53, v55
  v_mov_b32 v54, v52
  v_mov_b32 v55, v53
  s_nop 0
  v_permlane16_swap_b32 v54, v52
  v_permlane16_swap_b32 v55, v53
  v_add_f32 v52, v52, v54
  v_add_f32 v53, v53, v55
  v_mov_b32 v54, s55
  s_waitcnt vmcnt(0)
  s_cmp_lg_u32 s56, 0
  s_cbranch_scc1 Lsafe_82
  buffer_store_dwordx4 v[52:55], v6, s[8:11], s66 offen
Lback_83:
  s_barrier
  ds_read2st64_b32 v[112:113], v44 offset0:0 offset1:1
  ds_read2st64_b32 v[114:115], v44 offset0:2 offset1:3
  ds_read2st64_b32 v[116:117], v44 offset0:4 offset1:5
  ds_read2st64_b32 v[118:119], v44 offset0:6 offset1:7
  ds_read2st64_b32 v[120:121], v44 offset0:8 offset1:9
  ds_read2st64_b32 v[122:123], v44 offset0:10 offset1:11
  ds_read2st64_b32 v[124:125], v44 offset0:12 offset1:13
  ds_read2st64_b32 v[126:127], v44 offset0:14 offset1:15
  ds_read2st64_b32 v[128:129], v44 offset0:16 offset1:17
  ds_read2st64_b32 v[130:131], v44 offset0:18 offset1:19
  ds_write_b128 v38, a[144:147] offset:49152
  buffer_load_dwordx4 v[96:99], v4, s[8:11], s63 offen offset:0 sc1
  buffer_load_dwordx4 v[100:103], v4, s[8:11], s63 offen offset:2048 sc1
  buffer_load_dwordx4 v[104:107], v4, s[8:11], s63 offen offset:256 sc1
  buffer_load_dwordx4 v[108:111], v4, s[8:11], s63 offen offset:2304 sc1
  ds_write_b128 v38, a[148:151] offset:50176
  ds_write_b128 v38, a[152:155] offset:51200
  ds_write_b128 v38, a[156:159] offset:52224
  ds_write_b128 v42, a[160:163] offset:0
  ds_write_b128 v42, a[164:167] offset:1024
  ds_write_b128 v42, a[168:171] offset:2048
  ds_write_b128 v42, a[172:175] offset:3072
  s_mov_b32 s32, s62
Lpoll_84:
  s_waitcnt vmcnt(0)
  v_cmp_ne_u32 s[86:87], s55, v98
  v_cmp_ne_u32 s[88:89], s55, v102
  v_cmp_ne_u32 s[90:91], s55, v106
  v_cmp_ne_u32 s[92:93], s55, v110
  s_or_b64 s[86:87], s[86:87], s[88:89]
  s_or_b64 s[90:91], s[90:91], s[92:93]
  s_or_b64 s[86:87], s[86:87], s[90:91]
  s_cbranch_scc0 Lpdone_86
  s_cmp_eq_u32 s57, 0
  s_cbranch_scc1 Lpdone_86
  s_sub_u32 s57, s57, 1
  buffer_load_dwordx4 v[96:99], v4, s[8:11], s63 offen offset:0 sc1
  buffer_load_dwordx4 v[100:103], v4, s[8:11], s63 offen offset:2048 sc1
  buffer_load_dwordx4 v[104:107], v4, s[8:11], s63 offen offset:256 sc1
  buffer_load_dwordx4 v[108:111], v4, s[8:11], s63 offen offset:2304 sc1
  s_branch Lpoll_84
Lpdone_86:
  buffer_load_dwordx4 v[176:179], v1, s[28:31], s32 offen offset:0 sc1
  v_add_f32 v96, v96, v100
  v_add_f32 v97, v97, v101
  v_add_f32 v104, v104, v108
  v_add_f32 v105, v105, v109
  v_mov_b32 v98, v96
  v_mov_b32 v99, v104
  s_nop 0
  v_permlane32_swap_b32 v98, v96
  v_permlane32_swap_b32 v99, v104
  v_add_f32 v96, v96, v98
  buffer_load_dwordx4 v[180:183], v1, s[28:31], s32 offen offset:1024 sc1
  v_add_f32 v104, v104, v99
  v_mov_b32 v98, v96
  v_mov_b32 v99, v104
  s_nop 0
  v_permlane16_swap_b32 v98, v96
  v_permlane16_swap_b32 v99, v104
  v_add_f32 v96, v96, v98
  v_add_f32 v104, v104, v99
  v_mul_f32 v96, 0xbae38e39, v96
  v_mul_f32 v104, 0xbae38e39, v104
  buffer_load_dwordx4 v[184:187], v1, s[28:31], s32 offen offset:2048 sc1
  v_cvt_pk_bf16_f32 v156, v96, v96
  v_cvt_pk_bf16_f32 v160, v104, v104
  v_cndmask_b32 v157, 0, v156, s[46:47]
  v_cndmask_b32 v158, 0, v156, s[46:47]
  v_cndmask_b32 v159, 0, v156, s[46:47]
  v_cndmask_b32 v156, 0, v156, s[46:47]
  v_cndmask_b32 v161, 0, v160, s[46:47]
  v_cndmask_b32 v162, 0, v160, s[46:47]
  v_cndmask_b32 v163, 0, v160, s[46:47]
  v_cndmask_b32 v160, 0, v160, s[46:47]
  buffer_load_dwordx4 v[188:191], v1, s[28:31], s32 offen offset:3072 sc1
  ds_read_b128 v[132:135], v1 offset:5120
  s_waitcnt lgkmcnt(15)
  v_mfma_f32_16x16x32_bf16 v[56:59], v[112:115], v[156:159], 0
  s_add_u32 s32, s32, 4096
  v_mfma_f32_16x16x32_bf16 v[60:63], v[112:115], v[160:163], 0
  ds_read_b128 v[112:115], v1 offset:6144
  s_waitcnt lgkmcnt(15)
  v_mfma_f32_16x16x32_bf16 v[64:67], v[116:119], v[156:159], 0
  buffer_load_dwordx4 v[192:195], v1, s[28:31], s32 offen offset:0 sc1
  v_mfma_f32_16x16x32_bf16 v[68:71], v[116:119], v[160:163], 0
  ds_read_b128 v[116:119], v1 offset:7168
  s_waitcnt lgkmcnt(15)
  v_mfma_f32_16x16x32_bf16 v[72:75], v[120:123], v[156:159], 0
  buffer_load_dwordx4 v[196:199], v1, s[28:31], s32 offen offset:1024 sc1
  v_mfma_f32_16x16x32_bf16 v[76:79], v[120:123], v[160:163], 0
  ds_read_b128 v[120:123], v1 offset:8192
  s_waitcnt lgkmcnt(14)
  v_mfma_f32_16x16x32_bf16 v[80:83], v[124:127], v[156:159], 0
  v_mfma_f32_16x16x32_bf16 v[84:87], v[124:127], v[160:163], 0
  ds_read_b128 v[124:127], v1 offset:9216
  s_waitcnt lgkmcnt(13)
  v_mfma_f32_16x16x32_bf16 v[88:91], v[128:131], v[156:159], 0
  buffer_load_dwordx4 v[200:203], v1, s[28:31], s32 offen offset:2048 sc1
  v_mfma_f32_16x16x32_bf16 v[92:95], v[128:131], v[160:163], 0
  ds_read_b128 v[128:131], v1 offset:10240
  s_waitcnt vmcnt(5) lgkmcnt(5)
  v_mfma_f32_16x16x32_bf16 v[56:59], v[132:135], v[176:179], v[56:59]
  v_mfma_f32_16x16x32_bf16 v[60:63], v[132:135], v[180:183], v[60:63]
  ds_read_b128 v[132:135], v1 offset:11264
  s_waitcnt lgkmcnt(5)
  v_mfma_f32_16x16x32_bf16 v[64:67], v[112:115], v[176:179], v[64:67]
  buffer_load_dwordx4 v[204:207], v1, s[28:31], s32 offen offset:3072 sc1
  s_add_u32 s32, s32, 4096
  v_mfma_f32_16x16x32_bf16 v[68:71], v[112:115], v[180:183], v[68:71]
  ds_read_b128 v[112:115], v1 offset:12288
  s_waitcnt lgkmcnt(5)
  v_mfma_f32_16x16x32_bf16 v[72:75], v[116:119], v[176:179], v[72:75]
  buffer_load_dwordx4 v[208:211], v1, s[28:31], s32 offen offset:0 sc1
  v_mfma_f32_16x16x32_bf16 v[76:79], v[116:119], v[180:183], v[76:79]
  ds_read_b128 v[116:119], v1 offset:13312
  s_waitcnt lgkmcnt(5)
  v_mfma_f32_16x16x32_bf16 v[80:83], v[120:123], v[176:179], v[80:83]
  ds_write_b128 v42, a[176:179] offset:16384
  v_mfma_f32_16x16x32_bf16 v[84:87], v[120:123], v[180:183], v[84:87]
  ds_read_b128 v[120:123], v1 offset:14336
  s_waitcnt lgkmcnt(6)
  v_mfma_f32_16x16x32_bf16 v[88:91], v[124:127], v[176:179], v[88:91]
  buffer_load_dwordx4 v[212:215], v1, s[28:31], s32 offen offset:1024 sc1
  v_mfma_f32_16x16x32_bf16 v[92:95], v[124:127], v[180:183], v[92:95]
  ds_read_b128 v[124:127], v1 offset:15360
  s_waitcnt vmcnt(6) lgkmcnt(6)
  v_mfma_f32_16x16x32_bf16 v[56:59], v[128:131], v[184:187], v[56:59]
  v_mfma_f32_16x16x32_bf16 v[60:63], v[128:131], v[188:191], v[60:63]
  ds_read_b128 v[128:131], v1 offset:16384
  s_waitcnt lgkmcnt(6)
  v_mfma_f32_16x16x32_bf16 v[64:67], v[132:135], v[184:187], v[64:67]
  buffer_load_dwordx4 v[216:219], v1, s[28:31], s32 offen offset:2048 sc1
  v_mfma_f32_16x16x32_bf16 v[68:71], v[132:135], v[188:191], v[68:71]
  ds_read_b128 v[132:135], v1 offset:17408
  s_waitcnt lgkmcnt(6)
  v_mfma_f32_16x16x32_bf16 v[72:75], v[112:115], v[184:187], v[72:75]
  buffer_load_dwordx4 v[220:223], v1, s[28:31], s32 offen offset:3072 sc1
  s_add_u32 s32, s32, 4096
  v_mfma_f32_16x16x32_bf16 v[76:79], v[112:115], v[188:191], v[76:79]
  ds_read_b128 v[112:115], v1 offset:18432
  s_waitcnt lgkmcnt(6)
  v_mfma_f32_16x16x32_bf16 v[80:83], v[116:119], v[184:187], v[80:83]
  ds_write_b128 v42, a[180:183] offset:17408
  v_mfma_f32_16x16x32_bf16 v[84:87], v[116:119], v[188:191], v[84:87]
  ds_read_b128 v[116:119], v1 offset:19456
  s_waitcnt lgkmcnt(6)
  v_mfma_f32_16x16x32_bf16 v[88:91], v[120:123], v[184:187], v[88:91]
  buffer_load_dwordx4 v[224:227], v1, s[28:31], s32 offen offset:0 sc1
  v_mfma_f32_16x16x32_bf16 v[92:95], v[120:123], v[188:191], v[92:95]
  ds_read_b128 v[120:123], v1 offset:20480
  s_waitcnt vmcnt(7) lgkmcnt(6)
  v_mfma_f32_16x16x32_bf16 v[56:59], v[124:127], v[192:195], v[56:59]
  v_mfma_f32_16x16x32_bf16 v[60:63], v[124:127], v[196:199], v[60:63]
  ds_read_b128 v[124:127], v1 offset:21504
  s_waitcnt lgkmcnt(6)
  v_mfma_f32_16x16x32_bf16 v[64:67], v[128:131], v[192:195], v[64:67]
  buffer_load_dwordx4 v[228:231], v1, s[28:31], s32 offen offset:1024 sc1
  v_mfma_f32_16x16x32_bf16 v[68:71], v[128:131], v[196:199], v[68:71]
  ds_read_b128 v[128:131], v1 offset:22528
  s_waitcnt lgkmcnt(6)
  v_mfma_f32_16x16x32_bf16 v[72:75], v[132:135], v[192:195], v[72:75]
  ds_write_b128 v42, a[184:187] offset:18432
  v_mfma_f32_16x16x32_bf16 v[76:79], v[132:135], v[196:199], v[76:79]
  ds_read_b128 v[132:135], v1 offset:23552
  s_waitcnt lgkmcnt(7)
  v_mfma_f32_16x16x32_bf16 v[80:83], v[112:115], v[192:195], v[80:83]
  buffer_load_dwordx4 v[232:235], v1, s[28:31], s32 offen offset:2048 sc1
  v_mfma_f32_16x16x32_bf16 v[84:87], v[112:115], v[196:199], v[84:87]
  ds_read_b128 v[112:115], v1 offset:24576
  s_waitcnt lgkmcnt(6)
  v_mfma_f32_16x16x32_bf16 v[88:91], v[116:119], v[192:195], v[88:91]
  buffer_load_dwordx4 v[236:239], v1, s[28:31], s32 offen offset:3072 sc1
  s_add_u32 s32, s32, 4096
  v_mfma_f32_16x16x32_bf16 v[92:95], v[116:119], v[196:199], v[92:95]
  ds_read_b128 v[116:119], v1 offset:25600
  s_waitcnt vmcnt(8) lgkmcnt(6)
  v_mfma_f32_16x16x32_bf16 v[56:59], v[120:123], v[200:203], v[56:59]
  v_mfma_f32_16x16x32_bf16 v[60:63], v[120:123], v[204:207], v[60:63]
  ds_read_b128 v[120:123], v1 offset:26624
  s_waitcnt lgkmcnt(6)
  v_mfma_f32_16x16x32_bf16 v[64:67], v[124:127], v[200:203], v[64:67]
  buffer_load_dwordx4 v[240:243], v1, s[28:31], s32 offen offset:0 sc1
  v_mfma_f32_16x16x32_bf16 v[68:71], v[124:127], v[204:207], v[68:71]
  ds_read_b128 v[124:127], v1 offset:27648
  s_waitcnt lgkmcnt(6)
  v_mfma_f32_16x16x32_bf16 v[72:75], v[128:131], v[200:203], v[72:75]
  ds_write_b128 v42, a[188:191] offset:19456
  v_mfma_f32_16x16x32_bf16 v[76:79], v[128:131], v[204:207], v[76:79]
  ds_read_b128 v[128:131], v1 offset:28672
  s_waitcnt lgkmcnt(6)
  v_mfma_f32_16x16x32_bf16 v[80:83], v[132:135], v[200:203], v[80:83]
  buffer_load_dwordx4 v[244:247], v1, s[28:31], s32 offen offset:1024 sc1
  v_mov_b32 v98, v97
  v_mfma_f32_16x16x32_bf16 v[84:87], v[132:135], v[204:207], v[84:87]
  ds_read_b128 v[132:135], v1 offset:29696
  s_waitcnt lgkmcnt(6)
  v_mfma_f32_16x16x32_bf16 v[88:91], v[112:115], v[200:203], v[88:91]
  buffer_load_dwordx4 v[248:251], v1, s[28:31], s32 offen offset:2048 sc1
  v_mov_b32 v99, v105
  v_mfma_f32_16x16x32_bf16 v[92:95], v[112:115], v[204:207], v[92:95]
  ds_read_b128 v[112:115], v1 offset:30720
  s_waitcnt vmcnt(9) lgkmcnt(6)
  v_mfma_f32_16x16x32_bf16 v[56:59], v[116:119], v[208:211], v[56:59]
  v_permlane32_swap_b32 v98, v97
  v_mfma_f32_16x16x32_bf16 v[60:63], v[116:119], v[212:215], v[60:63]
  ds_read_b128 v[116:119], v1 offset:31744
  s_waitcnt lgkmcnt(6)
  v_mfma_f32_16x16x32_bf16 v[64:67], v[120:123], v[208:211], v[64:67]
  buffer_load_dwordx4 v[252:255], v1, s[28:31], s32 offen offset:3072 sc1
  s_add_u32 s32, s32, 4096
  v_mfma_f32_16x16x32_bf16 v[68:71], v[120:123], v[212:215], v[68:71]
  ds_read_b128 v[120:123], v1 offset:32768
  s_waitcnt lgkmcnt(6)
  v_mfma_f32_16x16x32_bf16 v[72:75], v[124:127], v[208:211], v[72:75]
  v_permlane32_swap_b32 v99, v105
  v_mfma_f32_16x16x32_bf16 v[76:79], v[124:127], v[212:215], v[76:79]
  ds_read_b128 v[124:127], v1 offset:33792
  s_waitcnt lgkmcnt(5)
  v_mfma_f32_16x16x32_bf16 v[80:83], v[128:131], v[208:211], v[80:83]
  buffer_load_dwordx4 a[192:195], v1, s[28:31], s32 offen offset:0 sc1
  v_add_f32 v97, v97, v98
  v_mfma_f32_16x16x32_bf16 v[84:87], v[128:131], v[212:215], v[84:87]
  ds_read_b128 v[128:131], v1 offset:34816
  s_waitcnt lgkmcnt(5)
  v_mfma_f32_16x16x32_bf16 v[88:91], v[132:135], v[208:211], v[88:91]
  buffer_load_dwordx4 a[196:199], v1, s[28:31], s32 offen offset:1024 sc1
  v_add_f32 v105, v105, v99
  v_mfma_f32_16x16x32_bf16 v[92:95], v[132:135], v[212:215], v[92:95]
  ds_read_b128 v[132:135], v1 offset:35840
  s_waitcnt vmcnt(10) lgkmcnt(5)
  v_mfma_f32_16x16x32_bf16 v[56:59], v[112:115], v[216:219], v[56:59]
  v_mov_b32 v98, v97
  v_mov_b32 v99, v105
  v_mfma_f32_16x16x32_bf16 v[60:63], v[112:115], v[220:223], v[60:63]
  ds_read_b128 v[112:115], v1 offset:36864
  s_waitcnt lgkmcnt(5)
  v_mfma_f32_16x16x32_bf16 v[64:67], v[116:119], v[216:219], v[64:67]
  buffer_load_dwordx4 a[200:203], v1, s[28:31], s32 offen offset:2048 sc1
  v_mfma_f32_16x16x32_bf16 v[68:71], v[116:119], v[220:223], v[68:71]
  ds_read_b128 v[116:119], v1 offset:37888
  s_waitcnt lgkmcnt(5)
  v_mfma_f32_16x16x32_bf16 v[72:75], v[120:123], v[216:219], v[72:75]
  v_permlane16_swap_b32 v98, v97
  v_mfma_f32_16x16x32_bf16 v[76:79], v[120:123], v[220:223], v[76:79]
  ds_read_b128 v[120:123], v1 offset:38912
  s_waitcnt lgkmcnt(5)
  v_mfma_f32_16x16x32_bf16 v[80:83], v[124:127], v[216:219], v[80:83]
  buffer_load_dwordx4 a[204:207], v1, s[28:31], s32 offen offset:3072 sc1
  s_add_u32 s32, s32, 4096
  v_mfma_f32_16x16x32_bf16 v[84:87], v[124:127], v[220:223], v[84:87]
  ds_read_b128 v[124:127], v1 offset:39936
  s_waitcnt lgkmcnt(5)
  v_mfma_f32_16x16x32_bf16 v[88:91], v[128:131], v[216:219], v[88:91]
  v_permlane16_swap_b32 v99, v105
  v_mfma_f32_16x16x32_bf16 v[92:95], v[128:131], v[220:223], v[92:95]
  ds_read_b128 v[128:131], v1 offset:40960
  s_waitcnt vmcnt(10) lgkmcnt(5)
  v_mfma_f32_16x16x32_bf16 v[56:59], v[132:135], v[224:227], v[56:59]
  buffer_load_dwordx4 a[208:211], v1, s[28:31], s32 offen offset:0 sc1
  v_add_f32 v97, v97, v98
  v_mfma_f32_16x16x32_bf16 v[60:63], v[132:135], v[228:231], v[60:63]
  ds_read_b128 v[132:135], v1 offset:41984
  s_waitcnt lgkmcnt(5)
  v_mfma_f32_16x16x32_bf16 v[64:67], v[112:115], v[224:227], v[64:67]
  buffer_load_dwordx4 a[212:215], v1, s[28:31], s32 offen offset:1024 sc1
  v_add_f32 v105, v105, v99
  v_mfma_f32_16x16x32_bf16 v[68:71], v[112:115], v[228:231], v[68:71]
  ds_read_b128 v[112:115], v1 offset:43008
  s_waitcnt lgkmcnt(5)
  v_mfma_f32_16x16x32_bf16 v[72:75], v[116:119], v[224:227], v[72:75]
  v_mul_f32 v97, 0x3ae38e39, v97
  v_mul_f32 v105, 0x3ae38e39, v105
  v_mfma_f32_16x16x32_bf16 v[76:79], v[116:119], v[228:231], v[76:79]
  ds_read_b128 v[116:119], v1 offset:44032
  s_waitcnt lgkmcnt(5)
  v_mfma_f32_16x16x32_bf16 v[80:83], v[120:123], v[224:227], v[80:83]
  buffer_load_dwordx4 a[216:219], v1, s[28:31], s32 offen offset:2048 sc1
  v_fma_f32 v97, -v96, v96, v97
  v_mfma_f32_16x16x32_bf16 v[84:87], v[120:123], v[228:231], v[84:87]
  ds_read_b128 v[120:123], v1 offset:45056
  s_waitcnt lgkmcnt(5)
  v_mfma_f32_16x16x32_bf16 v[88:91], v[124:127], v[224:227], v[88:91]
  v_fma_f32 v105, -v104, v104, v105
  v_max_f32 v97, 0, v97
  v_mfma_f32_16x16x32_bf16 v[92:95], v[124:127], v[228:231], v[92:95]
  ds_read_b128 v[124:127], v1 offset:46080
  s_waitcnt vmcnt(11) lgkmcnt(5)
  v_mfma_f32_16x16x32_bf16 v[56:59], v[128:131], v[232:235], v[56:59]
  buffer_load_dwordx4 a[220:223], v1, s[28:31], s32 offen offset:3072 sc1
  s_add_u32 s32, s32, 4096
  v_mfma_f32_16x16x32_bf16 v[60:63], v[128:131], v[236:239], v[60:63]
  ds_read_b128 v[128:131], v1 offset:47104
  s_waitcnt lgkmcnt(5)
  v_mfma_f32_16x16x32_bf16 v[64:67], v[132:135], v[232:235], v[64:67]
  buffer_load_dwordx4 a[224:227], v1, s[28:31], s32 offen offset:0 sc1
  v_max_f32 v105, 0, v105
  v_mfma_f32_16x16x32_bf16 v[68:71], v[132:135], v[236:239], v[68:71]
  ds_read_b128 v[132:135], v1 offset:48128
  s_waitcnt lgkmcnt(5)
  v_mfma_f32_16x16x32_bf16 v[72:75], v[112:115], v[232:235], v[72:75]
  v_add_f32 v97, 0x3727c5ac, v97
  v_add_f32 v105, 0x3727c5ac, v105
  v_mfma_f32_16x16x32_bf16 v[76:79], v[112:115], v[236:239], v[76:79]
  s_waitcnt lgkmcnt(15)
  s_barrier
  ds_read_b128 v[112:115], v1 offset:49152
  s_waitcnt lgkmcnt(5)
  v_mfma_f32_16x16x32_bf16 v[80:83], v[116:119], v[232:235], v[80:83]
  buffer_load_dwordx4 a[228:231], v1, s[28:31], s32 offen offset:1024 sc1
  v_mfma_f32_16x16x32_bf16 v[84:87], v[116:119], v[236:239], v[84:87]
  ds_read_b128 v[116:119], v1 offset:50176
  s_waitcnt lgkmcnt(5)
  v_mfma_f32_16x16x32_bf16 v[88:91], v[120:123], v[232:235], v[88:91]
  v_rsq_f32 v152, v97
  v_mfma_f32_16x16x32_bf16 v[92:95], v[120:123], v[236:239], v[92:95]
  ds_read_b128 v[120:123], v1 offset:51200
  s_waitcnt vmcnt(12) lgkmcnt(5)
  v_mfma_f32_16x16x32_bf16 v[56:59], v[124:127], v[240:243], v[56:59]
  buffer_load_dwordx4 a[232:235], v1, s[28:31], s32 offen offset:2048 sc1
  v_mfma_f32_16x16x32_bf16 v[60:63], v[124:127], v[244:247], v[60:63]
  ds_read_b128 v[124:127], v1 offset:52224
  s_waitcnt lgkmcnt(5)
  v_mfma_f32_16x16x32_bf16 v[64:67], v[128:131], v[240:243], v[64:67]
  buffer_load_dwordx4 a[236:239], v1, s[28:31], s32 offen offset:3072 sc1
  s_add_u32 s32, s32, 4096
  v_mfma_f32_16x16x32_bf16 v[68:71], v[128:131], v[244:247], v[68:71]
  ds_read_b128 v[128:131], v1 offset:53248
  s_waitcnt lgkmcnt(5)
  v_mfma_f32_16x16x32_bf16 v[72:75], v[132:135], v[240:243], v[72:75]
  v_rsq_f32 v153, v105
  v_mfma_f32_16x16x32_bf16 v[76:79], v[132:135], v[244:247], v[76:79]
  ds_read_b128 v[132:135], v1 offset:54272
  s_waitcnt lgkmcnt(5)
  v_mfma_f32_16x16x32_bf16 v[80:83], v[112:115], v[240:243], v[80:83]
  buffer_load_dwordx4 a[240:243], v1, s[28:31], s32 offen offset:0 sc1
  v_mul_f32 v154, 0x3eae1a93, v152
  v_mfma_f32_16x16x32_bf16 v[84:87], v[112:115], v[244:247], v[84:87]
  ds_read_b128 v[112:115], v1 offset:55296
  s_waitcnt lgkmcnt(5)
  v_mfma_f32_16x16x32_bf16 v[88:91], v[116:119], v[240:243], v[88:91]
  v_mul_f32 v155, 0x3eae1a93, v153
  v_mfma_f32_16x16x32_bf16 v[92:95], v[116:119], v[244:247], v[92:95]
  ds_read_b128 v[116:119], v1 offset:56320
  s_waitcnt vmcnt(13) lgkmcnt(5)
  v_mfma_f32_16x16x32_bf16 v[56:59], v[120:123], v[248:251], v[56:59]
  buffer_load_dwordx4 a[244:247], v1, s[28:31], s32 offen offset:1024 sc1
  v_mfma_f32_16x16x32_bf16 v[60:63], v[120:123], v[252:255], v[60:63]
  ds_read_b128 v[120:123], v1 offset:57344
  s_waitcnt lgkmcnt(5)
  v_mfma_f32_16x16x32_bf16 v[64:67], v[124:127], v[248:251], v[64:67]
  s_cmp_ge_u32 s52, 1
  s_cselect_b32 s43, s55, 0
  v_mfma_f32_16x16x32_bf16 v[68:71], v[124:127], v[252:255], v[68:71]
  ds_read_b128 v[124:127], v1 offset:58368
  s_waitcnt lgkmcnt(5)
  v_mfma_f32_16x16x32_bf16 v[72:75], v[128:131], v[248:251], v[72:75]
  buffer_load_dwordx4 a[248:251], v1, s[28:31], s32 offen offset:2048 sc1
  v_mfma_f32_16x16x32_bf16 v[76:79], v[128:131], v[252:255], v[76:79]
  ds_read_b128 v[128:131], v1 offset:59392
  s_waitcnt lgkmcnt(5)
  v_mfma_f32_16x16x32_bf16 v[80:83], v[132:135], v[248:251], v[80:83]
  buffer_load_dwordx4 a[252:255], v1, s[28:31], s32 offen offset:3072 sc1
  v_mfma_f32_16x16x32_bf16 v[84:87], v[132:135], v[252:255], v[84:87]
  ds_read_b128 v[132:135], v1 offset:60416
  s_waitcnt lgkmcnt(5)
  v_mfma_f32_16x16x32_bf16 v[88:91], v[112:115], v[248:251], v[88:91]
  s_add_u32 m0, s35, 0
  v_mfma_f32_16x16x32_bf16 v[92:95], v[112:115], v[252:255], v[92:95]
  ds_read_b128 v[112:115], v1 offset:61440
  s_waitcnt vmcnt(14) lgkmcnt(5)
  v_mfma_f32_16x16x32_bf16 v[56:59], v[116:119], a[192:195], v[56:59]
  buffer_load_dwordx4 v1, s[8:11], s34 offen offset:0 sc1 lds
  v_mfma_f32_16x16x32_bf16 v[60:63], v[116:119], a[196:199], v[60:63]
  ds_read_b128 v[116:119], v1 offset:62464
  s_waitcnt lgkmcnt(5)
  v_mfma_f32_16x16x32_bf16 v[64:67], v[120:123], a[192:195], v[64:67]
  s_cmp_ge_u32 s52, 2
  s_cselect_b32 s44, s55, 0
  v_mfma_f32_16x16x32_bf16 v[68:71], v[120:123], a[196:199], v[68:71]
  ds_read_b128 v[120:123], v1 offset:63488
  s_waitcnt lgkmcnt(5)
  v_mfma_f32_16x16x32_bf16 v[72:75], v[124:127], a[192:195], v[72:75]
  s_mul_i32 s21, s54, 23552
  s_min_u32 s21, s21, 68608
  v_mfma_f32_16x16x32_bf16 v[76:79], v[124:127], a[196:199], v[76:79]
  ds_read_b128 v[124:127], v1 offset:64512
  s_waitcnt lgkmcnt(5)
  v_mfma_f32_16x16x32_bf16 v[80:83], v[128:131], a[192:195], v[80:83]
  buffer_load_dwordx4 v1, s[8:11], s34 offen offset:1024 sc1 lds
  s_add_u32 s21, s21, 65536
  v_mfma_f32_16x16x32_bf16 v[84:87], v[128:131], a[196:199], v[84:87]
  ds_read_b128 v[128:131], v2 offset:0
  s_waitcnt lgkmcnt(5)
  v_mfma_f32_16x16x32_bf16 v[88:91], v[132:135], a[192:195], v[88:91]
  s_add_u32 s22, s39, 671744
  v_add_u32 v174, s22, v1
  v_mfma_f32_16x16x32_bf16 v[92:95], v[132:135], a[196:199], v[92:95]
  ds_read_b128 v[132:135], v2 offset:1024
  s_waitcnt vmcnt(14) lgkmcnt(5)
  v_mfma_f32_16x16x32_bf16 v[56:59], v[112:115], a[200:203], v[56:59]
  v_add_u32 v172, 65536, v19
  v_add_u32 v173, 65536, v9
  v_mfma_f32_16x16x32_bf16 v[60:63], v[112:115], a[204:207], v[60:63]
  ds_read_b128 v[112:115], v2 offset:2048
  s_waitcnt lgkmcnt(5)
  v_mfma_f32_16x16x32_bf16 v[64:67], v[116:119], a[200:203], v[64:67]
  buffer_load_dwordx4 v1, s[8:11], s34 offen offset:2048 sc1 lds
  v_lshl_add_u32 v52, s54, 8, v12
  v_mfma_f32_16x16x32_bf16 v[68:71], v[116:119], a[204:207], v[68:71]
  ds_read_b128 v[116:119], v2 offset:3072
  s_waitcnt lgkmcnt(5)
  v_mfma_f32_16x16x32_bf16 v[72:75], v[120:123], a[200:203], v[72:75]
  v_add_u32 v52, 157696, v52
  s_and_b32 s81, s54, 2
  v_mfma_f32_16x16x32_bf16 v[76:79], v[120:123], a[204:207], v[76:79]
  ds_read_b128 v[120:123], v2 offset:4096
  s_waitcnt lgkmcnt(5)
  v_mfma_f32_16x16x32_bf16 v[80:83], v[124:127], a[200:203], v[80:83]
  s_add_u32 s81, s81, s54
  s_lshl_b32 s81, s81, 7
  v_mfma_f32_16x16x32_bf16 v[84:87], v[124:127], a[204:207], v[84:87]
  ds_read_b128 v[124:127], v2 offset:5120
  s_waitcnt lgkmcnt(5)
  v_mfma_f32_16x16x32_bf16 v[88:91], v[128:131], a[200:203], v[88:91]
  buffer_load_dwordx4 v1, s[8:11], s34 offen offset:3072 sc1 lds
  s_add_u32 s81, s81, 157696
  v_mfma_f32_16x16x32_bf16 v[92:95], v[128:131], a[204:207], v[92:95]
  ds_read_b128 v[128:131], v2 offset:6144
  s_waitcnt vmcnt(14) lgkmcnt(5)
  v_mfma_f32_16x16x32_bf16 v[56:59], v[132:135], a[208:211], v[56:59]
  s_add_u32 s34, s34, 4096
  v_add_u32 v53, s81, v39
  v_mfma_f32_16x16x32_bf16 v[60:63], v[132:135], a[212:215], v[60:63]
  ds_read_b128 v[132:135], v2 offset:7168
  s_waitcnt lgkmcnt(5)
  v_mfma_f32_16x16x32_bf16 v[64:67], v[112:115], a[208:211], v[64:67]
  s_add_u32 m0, s35, 4096
  v_mov_b32 v55, 0xff800000
  v_mfma_f32_16x16x32_bf16 v[68:71], v[112:115], a[212:215], v[68:71]
  ds_read_b128 v[112:115], v2 offset:8192
  s_waitcnt lgkmcnt(5)
  v_mfma_f32_16x16x32_bf16 v[72:75], v[116:119], a[208:211], v[72:75]
  buffer_load_dwordx4 v1, s[8:11], s34 offen offset:0 sc1 lds
  v_mov_b32 v169, 0
  v_mfma_f32_16x16x32_bf16 v[76:79], v[116:119], a[212:215], v[76:79]
  ds_read_b128 v[116:119], v2 offset:9216
  s_waitcnt lgkmcnt(5)
  v_mfma_f32_16x16x32_bf16 v[80:83], v[120:123], a[208:211], v[80:83]
  v_mov_b32 v171, 0
  v_mov_b32 v149, 0x3f803f80
  v_mfma_f32_16x16x32_bf16 v[84:87], v[120:123], a[212:215], v[84:87]
  ds_read_b128 v[120:123], v2 offset:10240
  s_waitcnt lgkmcnt(5)
  v_mfma_f32_16x16x32_bf16 v[88:91], v[124:127], a[208:211], v[88:91]
  s_add_u32 s80, s55, 0x3f803f80
  v_mul_f32 v50, v21, v152
  v_mfma_f32_16x16x32_bf16 v[92:95], v[124:127], a[212:215], v[92:95]
  ds_read_b128 v[124:127], v2 offset:11264
  s_waitcnt vmcnt(13) lgkmcnt(5)
  v_mfma_f32_16x16x32_bf16 v[56:59], v[128:131], a[216:219], v[56:59]
  buffer_load_dwordx4 v1, s[8:11], s34 offen offset:1024 sc1 lds
  v_mul_f32 v51, v21, v153
  v_mfma_f32_16x16x32_bf16 v[60:63], v[128:131], a[220:223], v[60:63]
  ds_read_b128 v[128:131], v2 offset:12288
  s_waitcnt lgkmcnt(5)
  v_mfma_f32_16x16x32_bf16 v[64:67], v[132:135], a[216:219], v[64:67]
  v_mfma_f32_16x16x32_bf16 v[68:71], v[132:135], a[220:223], v[68:71]
  ds_read_b128 v[132:135], v2 offset:13312
  s_waitcnt lgkmcnt(5)
  v_mfma_f32_16x16x32_bf16 v[72:75], v[112:115], a[216:219], v[72:75]
  v_mfma_f32_16x16x32_bf16 v[76:79], v[112:115], a[220:223], v[76:79]
  ds_read_b128 v[112:115], v2 offset:14336
  s_waitcnt lgkmcnt(5)
  v_mfma_f32_16x16x32_bf16 v[80:83], v[116:119], a[216:219], v[80:83]
  buffer_load_dwordx4 v1, s[8:11], s34 offen offset:2048 sc1 lds
  v_mfma_f32_16x16x32_bf16 v[84:87], v[116:119], a[220:223], v[84:87]
  ds_read_b128 v[116:119], v2 offset:15360
  s_waitcnt lgkmcnt(5)
  v_mfma_f32_16x16x32_bf16 v[88:91], v[120:123], a[216:219], v[88:91]
  v_mfma_f32_16x16x32_bf16 v[92:95], v[120:123], a[220:223], v[92:95]
  ds_read_b128 v[120:123], v2 offset:16384
  s_waitcnt vmcnt(13) lgkmcnt(5)
  v_mfma_f32_16x16x32_bf16 v[56:59], v[124:127], a[224:227], v[56:59]
  v_mfma_f32_16x16x32_bf16 v[60:63], v[124:127], a[228:231], v[60:63]
  ds_read_b128 v[124:127], v2 offset:17408
  s_waitcnt lgkmcnt(5)
  v_mfma_f32_16x16x32_bf16 v[64:67], v[128:131], a[224:227], v[64:67]
  buffer_load_dwordx4 v1, s[8:11], s34 offen offset:3072 sc1 lds
  v_mfma_f32_16x16x32_bf16 v[68:71], v[128:131], a[228:231], v[68:71]
  ds_read_b128 v[128:131], v2 offset:18432
  s_waitcnt lgkmcnt(5)
  v_mfma_f32_16x16x32_bf16 v[72:75], v[132:135], a[224:227], v[72:75]
  s_add_u32 s34, s34, 4096
  v_mfma_f32_16x16x32_bf16 v[76:79], v[132:135], a[228:231], v[76:79]
  ds_read_b128 v[132:135], v2 offset:19456
  s_waitcnt lgkmcnt(5)
  v_mfma_f32_16x16x32_bf16 v[80:83], v[112:115], a[224:227], v[80:83]
  s_add_u32 m0, s35, 8192
  v_mfma_f32_16x16x32_bf16 v[84:87], v[112:115], a[228:231], v[84:87]
  ds_read_b128 v[112:115], v2 offset:20480
  s_waitcnt lgkmcnt(5)
  v_mfma_f32_16x16x32_bf16 v[88:91], v[116:119], a[224:227], v[88:91]
  buffer_load_dwordx4 v1, s[8:11], s34 offen offset:0 sc1 lds
  v_mfma_f32_16x16x32_bf16 v[92:95], v[116:119], a[228:231], v[92:95]
  ds_read_b128 v[116:119], v2 offset:21504
  s_waitcnt vmcnt(13) lgkmcnt(5)
  v_mfma_f32_16x16x32_bf16 v[56:59], v[120:123], a[232:235], v[56:59]
  v_mfma_f32_16x16x32_bf16 v[60:63], v[120:123], a[236:239], v[60:63]
  ds_read_b128 v[120:123], v2 offset:22528
  s_waitcnt lgkmcnt(5)
  v_mfma_f32_16x16x32_bf16 v[64:67], v[124:127], a[232:235], v[64:67]
  v_mfma_f32_16x16x32_bf16 v[68:71], v[124:127], a[236:239], v[68:71]
  ds_read_b128 v[124:127], v2 offset:23552
  s_waitcnt lgkmcnt(5)
  v_mfma_f32_16x16x32_bf16 v[72:75], v[128:131], a[232:235], v[72:75]
  buffer_load_dwordx4 v1, s[8:11], s34 offen offset:1024 sc1 lds
  v_mfma_f32_16x16x32_bf16 v[76:79], v[128:131], a[236:239], v[76:79]
  ds_read_b128 v[128:131], v2 offset:24576
  s_waitcnt lgkmcnt(5)
  v_mfma_f32_16x16x32_bf16 v[80:83], v[132:135], a[232:235], v[80:83]
  v_mfma_f32_16x16x32_bf16 v[84:87], v[132:135], a[236:239], v[84:87]
  ds_read_b128 v[132:135], v2 offset:25600
  s_waitcnt lgkmcnt(5)
  v_mfma_f32_16x16x32_bf16 v[88:91], v[112:115], a[232:235], v[88:91]
  v_mfma_f32_16x16x32_bf16 v[92:95], v[112:115], a[236:239], v[92:95]
  ds_read_b128 v[112:115], v2 offset:26624
  s_waitcnt vmcnt(12) lgkmcnt(5)
  v_mfma_f32_16x16x32_bf16 v[56:59], v[116:119], a[240:243], v[56:59]
  v_mfma_f32_16x16x32_bf16 v[60:63], v[116:119], a[244:247], v[60:63]
  ds_read_b128 v[116:119], v2 offset:27648
  s_waitcnt lgkmcnt(5)
  v_mfma_f32_16x16x32_bf16 v[64:67], v[120:123], a[240:243], v[64:67]
  v_mfma_f32_16x16x32_bf16 v[68:71], v[120:123], a[244:247], v[68:71]
  ds_read_b128 v[120:123], v2 offset:28672
  s_waitcnt lgkmcnt(5)
  v_mfma_f32_16x16x32_bf16 v[72:75], v[124:127], a[240:243], v[72:75]
  v_mfma_f32_16x16x32_bf16 v[76:79], v[124:127], a[244:247], v[76:79]
  ds_read_b128 v[124:127], v2 offset:29696
  s_waitcnt lgkmcnt(5)
  v_mfma_f32_16x16x32_bf16 v[80:83], v[128:131], a[240:243], v[80:83]
  v_mfma_f32_16x16x32_bf16 v[84:87], v[128:131], a[244:247], v[84:87]
  ds_read_b128 v[128:131], v2 offset:30720
  s_waitcnt lgkmcnt(5)
  v_mfma_f32_16x16x32_bf16 v[88:91], v[132:135], a[240:243], v[88:91]
  v_mfma_f32_16x16x32_bf16 v[92:95], v[132:135], a[244:247], v[92:95]
  s_waitcnt vmcnt(10) lgkmcnt(4)
  v_mfma_f32_16x16x32_bf16 v[56:59], v[112:115], a[248:251], v[56:59]
  v_mfma_f32_16x16x32_bf16 v[60:63], v[112:115], a[252:255], v[60:63]
  s_waitcnt lgkmcnt(3)
  v_mfma_f32_16x16x32_bf16 v[64:67], v[116:119], a[248:251], v[64:67]
  v_mfma_f32_16x16x32_bf16 v[68:71], v[116:119], a[252:255], v[68:71]
  s_waitcnt lgkmcnt(2)
  v_mfma_f32_16x16x32_bf16 v[72:75], v[120:123], a[248:251], v[72:75]
  v_mfma_f32_16x16x32_bf16 v[76:79], v[120:123], a[252:255], v[76:79]
  s_waitcnt lgkmcnt(1)
  v_mfma_f32_16x16x32_bf16 v[80:83], v[124:127], a[248:251], v[80:83]
  v_mfma_f32_16x16x32_bf16 v[84:87], v[124:127], a[252:255], v[84:87]
  s_waitcnt lgkmcnt(0)
  v_mfma_f32_16x16x32_bf16 v[88:91], v[128:131], a[248:251], v[88:91]
  v_mfma_f32_16x16x32_bf16 v[92:95], v[128:131], a[252:255], v[92:95]
  v_pk_mul_f32 v[56:57], v[56:57], v[152:153] op_sel_hi:[1,0]
  v_pk_mul_f32 v[58:59], v[58:59], v[152:153] op_sel_hi:[1,0]
  v_pk_mul_f32 v[60:61], v[60:61], v[152:153] op_sel:[0,1] op_sel_hi:[1,1]
  v_pk_mul_f32 v[62:63], v[62:63], v[152:153] op_sel:[0,1] op_sel_hi:[1,1]
  v_pk_mul_f32 v[64:65], v[64:65], v[152:153] op_sel_hi:[1,0]
  v_pk_mul_f32 v[66:67], v[66:67], v[152:153] op_sel_hi:[1,0]
  v_pk_mul_f32 v[68:69], v[68:69], v[152:153] op_sel:[0,1] op_sel_hi:[1,1]
  v_pk_mul_f32 v[70:71], v[70:71], v[152:153] op_sel:[0,1] op_sel_hi:[1,1]
  v_cvt_pk_bf16_f32 v132, v56, v57
  v_cvt_pk_bf16_f32 v133, v58, v59
  v_cvt_pk_bf16_f32 v134, v64, v65
  v_cvt_pk_bf16_f32 v135, v66, v67
  v_cvt_pk_bf16_f32 v136, v60, v61
  v_cvt_pk_bf16_f32 v137, v62, v63
  v_cvt_pk_bf16_f32 v138, v68, v69
  v_cvt_pk_bf16_f32 v139, v70, v71
  buffer_store_dwordx4 v[132:135], v3, s[8:11], s72 offen offset:0 sc1
  buffer_store_dwordx4 v[136:139], v3, s[8:11], s72 offen offset:256 sc1
  v_pk_mul_f32 v[72:73], v[72:73], v[152:153] op_sel_hi:[1,0]
  v_pk_mul_f32 v[74:75], v[74:75], v[152:153] op_sel_hi:[1,0]
  v_pk_mul_f32 v[76:77], v[76:77], v[152:153] op_sel:[0,1] op_sel_hi:[1,1]
  v_pk_mul_f32 v[78:79], v[78:79], v[152:153] op_sel:[0,1] op_sel_hi:[1,1]
  v_pk_mul_f32 v[80:81], v[80:81], v[152:153] op_sel_hi:[1,0]
  v_pk_mul_f32 v[82:83], v[82:83], v[152:153] op_sel_hi:[1,0]
  v_pk_mul_f32 v[84:85], v[84:85], v[152:153] op_sel:[0,1] op_sel_hi:[1,1]
  v_pk_mul_f32 v[86:87], v[86:87], v[152:153] op_sel:[0,1] op_sel_hi:[1,1]
  v_cvt_pk_bf16_f32 v140, v72, v73
  v_cvt_pk_bf16_f32 v141, v74, v75
  v_cvt_pk_bf16_f32 v142, v80, v81
  v_cvt_pk_bf16_f32 v143, v82, v83
  v_cvt_pk_bf16_f32 v144, v76, v77
  v_cvt_pk_bf16_f32 v145, v78, v79
  v_cvt_pk_bf16_f32 v146, v84, v85
  v_cvt_pk_bf16_f32 v147, v86, v87
  buffer_store_dwordx4 v[140:143], v3, s[8:11], s72 offen offset:1024 sc1
  buffer_store_dwordx4 v[144:147], v3, s[8:11], s72 offen offset:1280 sc1
  s_waitcnt vmcnt(4)
  s_barrier
  v_add_u32 v54, 97280, v44
  ds_read2st64_b32 v[112:113], v54 offset0:0 offset1:1
  ds_read2st64_b32 v[114:115], v54 offset0:2 offset1:3
  ds_read2st64_b32 v[116:117], v54 offset0:4 offset1:5
  ds_read2st64_b32 v[118:119], v54 offset0:6 offset1:7
  v_pk_mul_f32 v[88:89], v[88:89], v[152:153] op_sel_hi:[1,0]
  v_pk_mul_f32 v[90:91], v[90:91], v[50:51] op_sel_hi:[1,0]
  v_pk_mul_f32 v[92:93], v[92:93], v[152:153] op_sel:[0,1] op_sel_hi:[1,1]
  v_pk_mul_f32 v[94:95], v[94:95], v[50:51] op_sel:[0,1] op_sel_hi:[1,1]
  v_cvt_pk_bf16_f32 v148, v88, v89
  v_cvt_pk_bf16_f32 v48, v92, v93
  v_cvt_pk_bf16_f32 v150, v90, v91
  v_cvt_pk_bf16_f32 v164, v94, v95
  v_add3_u32 v151, v132, v133, s80
  v_add3_u32 v151, v134, v135, v151
  v_add3_u32 v151, v136, v137, v151
  v_add3_u32 v151, v138, v139, v151
  v_add3_u32 v151, v140, v141, v151
  v_add3_u32 v151, v142, v143, v151
  v_add3_u32 v151, v144, v145, v151
  v_add3_u32 v151, v146, v147, v151
  v_permlane16_swap_b32 v148, v48
  v_permlane16_swap_b32 v150, v164
  v_add3_u32 v151, v148, v150, v151
  buffer_store_dwordx4 v[148:151], v20, s[8:11], s72 offen offset:0 sc1
  ds_read_b128 v[120:123], v2 offset:33792
  ds_read_b128 v[124:127], v2 offset:34816
  ds_read_b128 v[128:131], v2 offset:35840
  s_waitcnt lgkmcnt(5)
  v_mfma_f32_16x16x32_bf16 v[96:99], v[112:115], v[156:159], 0
  ds_write_b128 v19, v[132:135] offset:0
  v_mfma_f32_16x16x32_bf16 v[100:103], v[112:115], v[160:163], 0
  ds_read_b128 v[112:115], v2 offset:37888
  s_waitcnt lgkmcnt(5)
  v_mfma_f32_16x16x32_bf16 v[104:107], v[116:119], v[156:159], 0
  v_mfma_f32_16x16x32_bf16 v[108:111], v[116:119], v[160:163], 0
  ds_read_b128 v[116:119], v2 offset:36864
  s_waitcnt lgkmcnt(5)
  v_mfma_f32_16x16x32_bf16 v[96:99], v[120:123], v[176:179], v[96:99]
  ds_write_b128 v19, v[140:143] offset:1024
  v_mfma_f32_16x16x32_bf16 v[100:103], v[120:123], v[180:183], v[100:103]
  ds_read_b128 v[120:123], v2 offset:39936
  s_waitcnt lgkmcnt(6)
  v_mfma_f32_16x16x32_bf16 v[104:107], v[124:127], v[176:179], v[104:107]
  v_mfma_f32_16x16x32_bf16 v[108:111], v[124:127], v[180:183], v[108:111]
  ds_read_b128 v[124:127], v2 offset:41984
  s_waitcnt lgkmcnt(6)
  v_mfma_f32_16x16x32_bf16 v[96:99], v[128:131], v[184:187], v[96:99]
  ds_write_b128 v19, v[136:139] offset:256
  v_mfma_f32_16x16x32_bf16 v[100:103], v[128:131], v[188:191], v[100:103]
  ds_read_b128 v[128:131], v2 offset:38912
  s_waitcnt lgkmcnt(6)
  v_mfma_f32_16x16x32_bf16 v[96:99], v[112:115], v[192:195], v[96:99]
  v_mfma_f32_16x16x32_bf16 v[100:103], v[112:115], v[196:199], v[100:103]
  ds_read_b128 v[112:115], v2 offset:44032
  s_waitcnt lgkmcnt(6)
  v_mfma_f32_16x16x32_bf16 v[104:107], v[116:119], v[184:187], v[104:107]
  ds_write_b128 v19, v[144:147] offset:1280
  v_mfma_f32_16x16x32_bf16 v[108:111], v[116:119], v[188:191], v[108:111]
  ds_read_b128 v[116:119], v2 offset:40960
  s_waitcnt lgkmcnt(6)
  v_mfma_f32_16x16x32_bf16 v[96:99], v[120:123], v[200:203], v[96:99]
  ds_read_b128 v[176:179], v18 offset:28672
  v_mfma_f32_16x16x32_bf16 v[100:103], v[120:123], v[204:207], v[100:103]
  ds_read_b128 v[120:123], v2 offset:46080
  s_waitcnt lgkmcnt(7)
  v_mfma_f32_16x16x32_bf16 v[96:99], v[124:127], v[208:211], v[96:99]
  ds_write_b128 v43, v[148:151]
  v_mfma_f32_16x16x32_bf16 v[100:103], v[124:127], v[212:215], v[100:103]
  ds_read_b128 v[124:127], v2 offset:48128
  s_waitcnt lgkmcnt(7)
  v_mfma_f32_16x16x32_bf16 v[104:107], v[128:131], v[192:195], v[104:107]
  ds_write_b32 v52, v164
  ds_read_b128 v[180:183], v18 offset:29696
  v_mfma_f32_16x16x32_bf16 v[108:111], v[128:131], v[196:199], v[108:111]
  ds_read_b128 v[128:131], v2 offset:43008
  s_waitcnt lgkmcnt(9)
  v_mfma_f32_16x16x32_bf16 v[96:99], v[112:115], v[216:219], v[96:99]
  ds_read_b128 v[184:187], v18 offset:30720
  v_mfma_f32_16x16x32_bf16 v[100:103], v[112:115], v[220:223], v[100:103]
  ds_read_b128 v[112:115], v2 offset:50176
  s_waitcnt lgkmcnt(9)
  v_mfma_f32_16x16x32_bf16 v[104:107], v[116:119], v[200:203], v[104:107]
  ds_read_b128 v[188:191], v18 offset:31744
  v_mfma_f32_16x16x32_bf16 v[108:111], v[116:119], v[204:207], v[108:111]
  ds_read_b128 v[116:119], v2 offset:52224
  s_waitcnt lgkmcnt(9)
  v_mfma_f32_16x16x32_bf16 v[96:99], v[120:123], v[224:227], v[96:99]
  v_mfma_f32_16x16x32_bf16 v[100:103], v[120:123], v[228:231], v[100:103]
  ds_read_b128 v[120:123], v2 offset:45056
  s_waitcnt lgkmcnt(8)
  v_mfma_f32_16x16x32_bf16 v[96:99], v[124:127], v[232:235], v[96:99]
  v_mfma_f32_16x16x32_bf16 v[100:103], v[124:127], v[236:239], v[100:103]
  ds_read_b128 v[124:127], v2 offset:54272
  s_waitcnt lgkmcnt(6)
  v_mfma_f32_16x16x32_bf16 v[104:107], v[128:131], v[208:211], v[104:107]
  v_mfma_f32_16x16x32_bf16 v[108:111], v[128:131], v[212:215], v[108:111]
  ds_read_b128 v[128:131], v2 offset:56320
  s_waitcnt lgkmcnt(5)
  v_mfma_f32_16x16x32_bf16 v[96:99], v[112:115], v[240:243], v[96:99]
  v_mfma_f32_16x16x32_bf16 v[100:103], v[112:115], v[244:247], v[100:103]
  ds_read_b128 v[112:115], v2 offset:47104
  s_waitcnt lgkmcnt(4)
  v_mfma_f32_16x16x32_bf16 v[96:99], v[116:119], v[248:251], v[96:99]
  v_mfma_f32_16x16x32_bf16 v[100:103], v[116:119], v[252:255], v[100:103]
  ds_read_b128 v[116:119], v2 offset:58368
  s_waitcnt lgkmcnt(4)
  v_mfma_f32_16x16x32_bf16 v[104:107], v[120:123], v[216:219], v[104:107]
  s_waitcnt lgkmcnt(11)
  s_barrier
  v_mfma_f32_16x16x32_bf16 v[108:111], v[120:123], v[220:223], v[108:111]
  ds_read_b128 v[120:123], v2 offset:49152
  s_waitcnt lgkmcnt(4)
  v_mfma_f32_16x16x32_bf16 v[96:99], v[124:127], a[192:195], v[96:99]
  ds_read_b32 v168, v53 offset:0
  ds_read_b32 v170, v53 offset:256
  v_mfma_f32_16x16x32_bf16 v[100:103], v[124:127], a[196:199], v[100:103]
  ds_read_b128 v[124:127], v2 offset:60416
  s_waitcnt lgkmcnt(6)
  v_mfma_f32_16x16x32_bf16 v[96:99], v[128:131], a[200:203], v[96:99]
  v_cmp_gt_u32 vcc, 32, v16
  s_waitcnt lgkmcnt(10)
  v_mfma_f32_16x16x32_bf16 v[100:103], v[128:131], a[204:207], v[100:103]
  ds_read_b128 v[128:131], v2 offset:62464
  s_waitcnt lgkmcnt(6)
  v_mfma_f32_16x16x32_bf16 v[104:107], v[112:115], v[224:227], v[104:107]
  v_xor_b32 v192, v55, v176
  v_xor_b32 v193, v55, v177
  v_mfma_f32_16x16x32_bf16 v[108:111], v[112:115], v[228:231], v[108:111]
  ds_read_b128 v[112:115], v2 offset:51200
  s_waitcnt lgkmcnt(6)
  v_mfma_f32_16x16x32_bf16 v[96:99], v[116:119], a[208:211], v[96:99]
  v_xor_b32 v194, v55, v178
  v_xor_b32 v195, v55, v179
  v_mfma_f32_16x16x32_bf16 v[100:103], v[116:119], a[212:215], v[100:103]
  ds_read_b128 v[116:119], v2 offset:64512
  s_waitcnt lgkmcnt(6)
  v_mfma_f32_16x16x32_bf16 v[104:107], v[120:123], v[232:235], v[104:107]
  v_xor_b32 v196, v55, v180
  v_xor_b32 v197, v55, v181
  v_mfma_f32_16x16x32_bf16 v[108:111], v[120:123], v[236:239], v[108:111]
  ds_read_b128 v[120:123], v18 offset:1024
  s_waitcnt lgkmcnt(4)
  v_mfma_f32_16x16x32_bf16 v[96:99], v[124:127], a[216:219], v[96:99]
  s_waitcnt lgkmcnt(5)
  v_cndmask_b32 v168, 0, v168, vcc
  v_mfma_f32_16x16x32_bf16 v[100:103], v[124:127], a[220:223], v[100:103]
  ds_read_b128 v[124:127], v2 offset:53248
  s_waitcnt lgkmcnt(4)
  v_mfma_f32_16x16x32_bf16 v[96:99], v[128:131], a[224:227], v[96:99]
  v_cndmask_b32 v170, 0, v170, vcc
  v_xor_b32 v198, v55, v182
  v_mfma_f32_16x16x32_bf16 v[100:103], v[128:131], a[228:231], v[100:103]
  ds_read_b128 v[128:131], v18 offset:3072
  s_waitcnt lgkmcnt(4)
  v_mfma_f32_16x16x32_bf16 v[104:107], v[112:115], v[240:243], v[104:107]
  s_add_u32 m0, s45, 20480
  v_xor_b32 v199, v55, v183
  v_mfma_f32_16x16x32_bf16 v[108:111], v[112:115], v[244:247], v[108:111]
  ds_read_b128 v[112:115], v2 offset:55296
  s_waitcnt lgkmcnt(4)
  v_mfma_f32_16x16x32_bf16 v[96:99], v[116:119], a[232:235], v[96:99]
  buffer_load_dwordx4 v1, s[8:11], s41 offen offset:0 sc1 lds
  v_xor_b32 v200, v55, v184
  v_mfma_f32_16x16x32_bf16 v[100:103], v[116:119], a[236:239], v[100:103]
  ds_read_b128 v[116:119], v2 offset:57344
  s_waitcnt lgkmcnt(4)
  v_mfma_f32_16x16x32_bf16 v[96:99], v[120:123], a[240:243], v[96:99]
  buffer_load_dwordx4 v1, s[8:11], s41 offen offset:1024 sc1 lds
  v_xor_b32 v201, v55, v185
  v_mfma_f32_16x16x32_bf16 v[100:103], v[120:123], a[244:247], v[100:103]
  ds_read_b128 v[120:123], v2 offset:59392
  s_waitcnt lgkmcnt(4)
  v_mfma_f32_16x16x32_bf16 v[104:107], v[124:127], v[248:251], v[104:107]
  buffer_load_dwordx4 v1, s[8:11], s41 offen offset:2048 sc1 lds
  v_xor_b32 v202, v55, v186
  v_mfma_f32_16x16x32_bf16 v[108:111], v[124:127], v[252:255], v[108:111]
  ds_read_b128 v[124:127], v2 offset:61440
  s_waitcnt lgkmcnt(4)
  v_mfma_f32_16x16x32_bf16 v[96:99], v[128:131], a[248:251], v[96:99]
  buffer_load_dwordx4 v1, s[8:11], s41 offen offset:3072 sc1 lds
  v_xor_b32 v203, v55, v187
  v_mfma_f32_16x16x32_bf16 v[100:103], v[128:131], a[252:255], v[100:103]
  ds_read_b128 v[128:131], v2 offset:63488
  s_waitcnt lgkmcnt(4)
  v_mfma_f32_16x16x32_bf16 v[104:107], v[112:115], a[192:195], v[104:107]
  s_add_u32 s84, s41, 4096
  v_xor_b32 v204, v55, v188
  v_mfma_f32_16x16x32_bf16 v[108:111], v[112:115], a[196:199], v[108:111]
  ds_read_b128 v[112:115], v18 offset:0
  s_waitcnt lgkmcnt(4)
  v_mfma_f32_16x16x32_bf16 v[104:107], v[116:119], a[200:203], v[104:107]
  s_add_u32 m0, s45, 24576
  v_xor_b32 v205, v55, v189
  v_mfma_f32_16x16x32_bf16 v[108:111], v[116:119], a[204:207], v[108:111]
  ds_read_b128 v[116:119], v18 offset:2048
  s_waitcnt lgkmcnt(4)
  v_mfma_f32_16x16x32_bf16 v[104:107], v[120:123], a[208:211], v[104:107]
  buffer_load_dwordx4 v1, s[8:11], s84 offen sc1 lds
  v_mul_f32 v96, v96, v154
  v_mfma_f32_16x16x32_bf16 v[108:111], v[120:123], a[212:215], v[108:111]
  ds_read_b128 v[120:123], v18 offset:4096
  s_waitcnt lgkmcnt(4)
  v_mfma_f32_16x16x32_bf16 v[104:107], v[124:127], a[216:219], v[104:107]
  v_mul_f32 v97, v97, v154
  v_mul_f32 v98, v98, v154
  v_mfma_f32_16x16x32_bf16 v[108:111], v[124:127], a[220:223], v[108:111]
  s_waitcnt lgkmcnt(3)
  v_mfma_f32_16x16x32_bf16 v[104:107], v[128:131], a[224:227], v[104:107]
  v_mul_f32 v99, v99, v154
  v_mul_f32 v100, v100, v155
  v_mfma_f32_16x16x32_bf16 v[108:111], v[128:131], a[228:231], v[108:111]
  s_waitcnt lgkmcnt(2)
  v_mfma_f32_16x16x32_bf16 v[104:107], v[112:115], a[232:235], v[104:107]
  v_mul_f32 v101, v101, v155
  v_mul_f32 v102, v102, v155
  v_mfma_f32_16x16x32_bf16 v[108:111], v[112:115], a[236:239], v[108:111]
  s_waitcnt lgkmcnt(1)
  v_mfma_f32_16x16x32_bf16 v[104:107], v[116:119], a[240:243], v[104:107]
  v_mul_f32 v103, v103, v155
  v_cvt_pk_bf16_f32 v156, v96, v97
  v_mfma_f32_16x16x32_bf16 v[108:111], v[116:119], a[244:247], v[108:111]
  s_waitcnt lgkmcnt(0)
  v_mfma_f32_16x16x32_bf16 v[104:107], v[120:123], a[248:251], v[104:107]
  v_cvt_pk_bf16_f32 v157, v98, v99
  v_cvt_pk_bf16_f32 v160, v100, v101
  v_mfma_f32_16x16x32_bf16 v[108:111], v[120:123], a[252:255], v[108:111]
  v_xor_b32 v206, v55, v190
  v_xor_b32 v207, v55, v191
  v_cvt_pk_bf16_f32 v161, v102, v103
  v_accvgpr_write_b32 a197, 0
  v_accvgpr_write_b32 a205, 0
  ds_read_b128 a[192:195], v9 offset:0
  ds_read_b32 a196, v10 offset:0
  ds_read_b128 a[200:203], v9 offset:5120
  ds_read_b32 a204, v10 offset:5120
  ds_read_b64_tr_b16 a[208:209], v11 offset:0
  ds_read_b64_tr_b16 a[210:211], v11 offset:128
  ds_read_b64_tr_b16 a[212:213], v11 offset:256
  ds_read_b64_tr_b16 a[214:215], v11 offset:384
  v_pk_mul_f32 v[104:105], v[104:105], v[154:155] op_sel_hi:[1,0]
  v_pk_mul_f32 v[106:107], v[106:107], v[154:155] op_sel_hi:[1,0]
  v_cvt_pk_bf16_f32 v158, v104, v105
  v_cvt_pk_bf16_f32 v159, v106, v107
  ds_write_b128 v172, v[156:159] offset:0
  v_pk_mul_f32 v[108:109], v[108:109], v[154:155] op_sel:[0,1] op_sel_hi:[1,1]
  v_pk_mul_f32 v[110:111], v[110:111], v[154:155] op_sel:[0,1] op_sel_hi:[1,1]
  v_cvt_pk_bf16_f32 v162, v108, v109
  v_cvt_pk_bf16_f32 v163, v110, v111
  ds_write_b128 v172, v[160:163] offset:256
  s_waitcnt lgkmcnt(0)
  s_barrier
  ds_read_b128 v[160:163], v173
  ds_read_b128 v[156:159], v173 offset:5120
  ds_read_b64_tr_b16 a[216:217], v11 offset:5120
  ds_read_b64_tr_b16 a[218:219], v11 offset:5248
  ds_read_b64_tr_b16 a[220:221], v11 offset:5376
  ds_read_b64_tr_b16 a[222:223], v11 offset:5504
  s_waitcnt lgkmcnt(4)
  v_mfma_f32_32x32x16_bf16 v[112:127], a[192:195], v[160:163], v[176:191]
  v_mfma_f32_32x32x8_bf16 v[112:127], a[196:197], v[170:171], v[112:127]
  v_mfma_f32_32x32x16_bf16 v[128:143], a[200:203], v[160:163], 0
  s_nop 10
  v_exp_f32 v112, v112
  v_exp_f32 v113, v113
  v_exp_f32 v114, v114
  v_exp_f32 v115, v115
  v_cvt_pk_bf16_f32 v144, v112, v113
  v_exp_f32 v116, v116
  v_cvt_pk_bf16_f32 v145, v114, v115
  v_exp_f32 v117, v117
  v_exp_f32 v118, v118
  v_mfma_f32_32x32x8_bf16 v[128:143], a[204:205], v[170:171], v[128:143]
  v_exp_f32 v119, v119
  v_cvt_pk_bf16_f32 v146, v116, v117
  v_exp_f32 v120, v120
  v_cvt_pk_bf16_f32 v147, v118, v119
  v_exp_f32 v121, v121
  v_exp_f32 v122, v122
  v_mfma_f32_32x32x16_bf16 v[224:239], a[208:211], v[144:147], 0
  v_exp_f32 v123, v123
  v_cvt_pk_bf16_f32 v148, v120, v121
  v_exp_f32 v124, v124
  v_cvt_pk_bf16_f32 v149, v122, v123
  v_exp_f32 v125, v125
  v_exp_f32 v126, v126
  v_exp_f32 v127, v127
  v_cvt_pk_bf16_f32 v150, v124, v125
  v_cvt_pk_bf16_f32 v151, v126, v127
  s_waitcnt lgkmcnt(0)
  v_mfma_f32_32x32x16_bf16 v[112:127], a[200:203], v[156:159], v[176:191]
  s_add_u32 m0, s45, 40960
  v_exp_f32 v128, v128
  v_exp_f32 v129, v129
  v_exp_f32 v130, v130
  v_exp_f32 v131, v131
  v_mfma_f32_32x32x16_bf16 v[224:239], a[212:215], v[148:151], v[224:239]
  v_cvt_pk_bf16_f32 v144, v128, v129
  v_exp_f32 v132, v132
  v_cvt_pk_bf16_f32 v145, v130, v131
  v_exp_f32 v133, v133
  v_exp_f32 v134, v134
  v_mfma_f32_32x32x8_bf16 v[112:127], a[204:205], v[168:169], v[112:127]
  buffer_load_dwordx4 v1, s[8:11], s42 offen offset:0 sc1 lds
  v_exp_f32 v135, v135
  v_cvt_pk_bf16_f32 v146, v132, v133
  v_exp_f32 v136, v136
  v_cvt_pk_bf16_f32 v147, v134, v135
  v_exp_f32 v137, v137
  v_exp_f32 v138, v138
  v_mfma_f32_32x32x16_bf16 v[224:239], a[216:219], v[144:147], v[224:239]
  buffer_load_dwordx4 v1, s[8:11], s42 offen offset:1024 sc1 lds
  buffer_load_dwordx4 v1, s[8:11], s42 offen offset:2048 sc1 lds
  v_exp_f32 v139, v139
  v_cvt_pk_bf16_f32 v148, v136, v137
  v_exp_f32 v140, v140
  v_cvt_pk_bf16_f32 v149, v138, v139
  v_exp_f32 v141, v141
  v_exp_f32 v142, v142
  v_exp_f32 v143, v143
  v_cvt_pk_bf16_f32 v150, v140, v141
  v_cvt_pk_bf16_f32 v151, v142, v143
  v_exp_f32 v112, v112
  v_exp_f32 v113, v113
  v_exp_f32 v114, v114
  v_exp_f32 v115, v115
  v_mfma_f32_32x32x16_bf16 v[224:239], a[220:223], v[148:151], v[224:239]
  v_cvt_pk_bf16_f32 v144, v112, v113
  v_exp_f32 v116, v116
  v_cvt_pk_bf16_f32 v145, v114, v115
  v_exp_f32 v117, v117
  v_exp_f32 v118, v118
  v_exp_f32 v119, v119
  v_cvt_pk_bf16_f32 v146, v116, v117
  s_waitcnt vmcnt(3)
  ds_read_b128 v[56:59], v19 offset:20480
  ds_read_b128 v[60:63], v19 offset:20736
  ds_read_b128 v[64:67], v19 offset:21504
  ds_read_b128 v[68:71], v19 offset:21760
  ds_read_b128 v[72:75], v43 offset:20480
  v_exp_f32 v120, v120
  v_cvt_pk_bf16_f32 v147, v118, v119
  v_exp_f32 v121, v121
  v_exp_f32 v122, v122
  v_mfma_f32_32x32x16_bf16 v[208:223], a[216:219], v[144:147], 0
  v_exp_f32 v123, v123
  v_cvt_pk_bf16_f32 v148, v120, v121
  v_exp_f32 v124, v124
  v_cvt_pk_bf16_f32 v149, v122, v123
  s_waitcnt lgkmcnt(0)
Lnbchk_88:
  v_add3_u32 v48, v56, v57, s43
  v_add3_u32 v49, v58, v59, v72
  v_add3_u32 v48, v60, v61, v48
  v_add3_u32 v49, v62, v63, v49
  v_add3_u32 v48, v64, v65, v48
  v_add3_u32 v49, v66, v67, v49
  v_add3_u32 v48, v68, v69, v48
  v_add3_u32 v49, v70, v71, v49
  v_add3_u32 v48, v48, v73, v74
  v_add_u32 v48, v48, v49
  v_cmp_ne_u32 vcc, v48, v75
  s_cbranch_vccz Lnbok_89
  s_cmp_eq_u32 s57, 0
  s_cbranch_scc1 Lnbok_89
  s_sub_u32 s57, s57, 1
  s_mov_b32 s83, m0
  s_add_u32 m0, s45, 20480
  s_nop 0
  buffer_load_dwordx4 v1, s[8:11], s41 offen offset:0 sc1 lds
  buffer_load_dwordx4 v1, s[8:11], s41 offen offset:1024 sc1 lds
  buffer_load_dwordx4 v1, s[8:11], s41 offen offset:2048 sc1 lds
  buffer_load_dwordx4 v1, s[8:11], s41 offen offset:3072 sc1 lds
  s_add_u32 s84, s41, 4096
  s_add_u32 m0, s45, 24576
  s_nop 0
  buffer_load_dwordx4 v1, s[8:11], s84 offen sc1 lds
  s_mov_b32 m0, s83
  s_waitcnt vmcnt(0)
  ds_read_b128 v[56:59], v19 offset:20480
  ds_read_b128 v[60:63], v19 offset:20736
  ds_read_b128 v[64:67], v19 offset:21504
  ds_read_b128 v[68:71], v19 offset:21760
  ds_read_b128 v[72:75], v43 offset:20480
  s_waitcnt lgkmcnt(0)
  s_branch Lnbchk_88
Lnbok_89:
  s_barrier
  ds_read_b128 a[192:195], v9 offset:10240
  ds_read_b32 a196, v10 offset:10240
  ds_read_b64_tr_b16 a[208:209], v11 offset:10240
  ds_read_b64_tr_b16 a[210:211], v11 offset:10368
  ds_read_b64_tr_b16 a[212:213], v11 offset:10496
  ds_read_b64_tr_b16 a[214:215], v11 offset:10624
  v_exp_f32 v125, v125
  v_exp_f32 v126, v126
  v_exp_f32 v127, v127
  v_cvt_pk_bf16_f32 v150, v124, v125
  v_cvt_pk_bf16_f32 v151, v126, v127
  buffer_load_dwordx4 v1, s[8:11], s42 offen offset:3072 sc1 lds
  s_add_u32 s84, s42, 4096
  s_add_u32 m0, s45, 45056
  s_waitcnt lgkmcnt(4)
  v_mfma_f32_32x32x16_bf16 v[128:143], a[192:195], v[160:163], 0
  buffer_load_dwordx4 v1, s[8:11], s84 offen sc1 lds
  v_mfma_f32_32x32x8_bf16 v[128:143], a[196:197], v[170:171], v[128:143]
  s_waitcnt lgkmcnt(0)
  v_mfma_f32_32x32x16_bf16 v[112:127], a[192:195], v[156:159], 0
  ds_read_b128 a[200:203], v9 offset:15360
  ds_read_b32 a204, v10 offset:15360
  s_nop 7
  v_exp_f32 v128, v128
  v_exp_f32 v129, v129
  v_exp_f32 v130, v130
  v_exp_f32 v131, v131
  v_mfma_f32_32x32x16_bf16 v[208:223], a[220:223], v[148:151], v[208:223]
  ds_read_b64_tr_b16 a[216:217], v11 offset:15360
  ds_read_b64_tr_b16 a[218:219], v11 offset:15488
  ds_read_b64_tr_b16 a[220:221], v11 offset:15616
  ds_read_b64_tr_b16 a[222:223], v11 offset:15744
  v_cvt_pk_bf16_f32 v144, v128, v129
  v_exp_f32 v132, v132
  v_cvt_pk_bf16_f32 v145, v130, v131
  v_exp_f32 v133, v133
  v_exp_f32 v134, v134
  v_mfma_f32_32x32x8_bf16 v[112:127], a[196:197], v[168:169], v[112:127]
  v_exp_f32 v135, v135
  v_cvt_pk_bf16_f32 v146, v132, v133
  v_exp_f32 v136, v136
  v_cvt_pk_bf16_f32 v147, v134, v135
  v_exp_f32 v137, v137
  v_exp_f32 v138, v138
  v_mfma_f32_32x32x16_bf16 v[224:239], a[208:211], v[144:147], v[224:239]
  v_exp_f32 v139, v139
  v_cvt_pk_bf16_f32 v148, v136, v137
  v_exp_f32 v140, v140
  v_cvt_pk_bf16_f32 v149, v138, v139
  v_exp_f32 v141, v141
  v_exp_f32 v142, v142
  v_exp_f32 v143, v143
  v_cvt_pk_bf16_f32 v150, v140, v141
  v_cvt_pk_bf16_f32 v151, v142, v143
  s_waitcnt lgkmcnt(0)
  v_mfma_f32_32x32x16_bf16 v[128:143], a[200:203], v[160:163], 0
  s_add_u32 m0, s21, 0
  v_exp_f32 v112, v112
  v_exp_f32 v113, v113
  v_exp_f32 v114, v114
  v_exp_f32 v115, v115
  v_mfma_f32_32x32x16_bf16 v[224:239], a[212:215], v[148:151], v[224:239]
  v_cvt_pk_bf16_f32 v144, v112, v113
  v_exp_f32 v116, v116
  v_cvt_pk_bf16_f32 v145, v114, v115
  v_exp_f32 v117, v117
  v_exp_f32 v118, v118
  v_mfma_f32_32x32x8_bf16 v[128:143], a[204:205], v[170:171], v[128:143]
  v_exp_f32 v119, v119
  v_cvt_pk_bf16_f32 v146, v116, v117
  v_exp_f32 v120, v120
  v_cvt_pk_bf16_f32 v147, v118, v119
  v_exp_f32 v121, v121
  v_exp_f32 v122, v122
  v_mfma_f32_32x32x16_bf16 v[208:223], a[208:211], v[144:147], v[208:223]
  buffer_load_dwordx4 v174, s[8:11], m0 offen offset:0 sc1 lds
  buffer_load_dwordx4 v174, s[8:11], m0 offen offset:1024 sc1 lds
  buffer_load_dwordx4 v174, s[8:11], m0 offen offset:2048 sc1 lds
  buffer_load_dwordx4 v174, s[8:11], m0 offen offset:3072 sc1 lds
  v_exp_f32 v123, v123
  v_cvt_pk_bf16_f32 v148, v120, v121
  v_exp_f32 v124, v124
  v_cvt_pk_bf16_f32 v149, v122, v123
  v_exp_f32 v125, v125
  v_exp_f32 v126, v126
  v_exp_f32 v127, v127
  v_cvt_pk_bf16_f32 v150, v124, v125
  v_cvt_pk_bf16_f32 v151, v126, v127
  v_mfma_f32_32x32x16_bf16 v[112:127], a[200:203], v[156:159], 0
  ds_read_b128 a[192:195], v9 offset:20480
  ds_read_b32 a196, v10 offset:20480
  v_exp_f32 v128, v128
  v_exp_f32 v129, v129
  v_exp_f32 v130, v130
  v_exp_f32 v131, v131
  v_mfma_f32_32x32x16_bf16 v[208:223], a[212:215], v[148:151], v[208:223]
  ds_read_b64_tr_b16 a[208:209], v11 offset:20480
  ds_read_b64_tr_b16 a[210:211], v11 offset:20608
  ds_read_b64_tr_b16 a[212:213], v11 offset:20736
  ds_read_b64_tr_b16 a[214:215], v11 offset:20864
  v_cvt_pk_bf16_f32 v144, v128, v129
  v_exp_f32 v132, v132
  v_cvt_pk_bf16_f32 v145, v130, v131
  v_exp_f32 v133, v133
  v_exp_f32 v134, v134
  v_mfma_f32_32x32x8_bf16 v[112:127], a[204:205], v[168:169], v[112:127]
  s_waitcnt vmcnt(4)
  ds_read_b128 v[76:79], v19 offset:40960
  ds_read_b128 v[80:83], v19 offset:41216
  ds_read_b128 v[84:87], v19 offset:41984
  ds_read_b128 v[88:91], v19 offset:42240
  ds_read_b128 v[92:95], v43 offset:40960
  v_exp_f32 v135, v135
  v_cvt_pk_bf16_f32 v146, v132, v133
  v_exp_f32 v136, v136
  v_cvt_pk_bf16_f32 v147, v134, v135
  v_exp_f32 v137, v137
  v_exp_f32 v138, v138
  v_mfma_f32_32x32x16_bf16 v[224:239], a[216:219], v[144:147], v[224:239]
  v_exp_f32 v139, v139
  v_cvt_pk_bf16_f32 v148, v136, v137
  v_exp_f32 v140, v140
  v_cvt_pk_bf16_f32 v149, v138, v139
  v_exp_f32 v141, v141
  v_exp_f32 v142, v142
  v_exp_f32 v143, v143
  v_cvt_pk_bf16_f32 v150, v140, v141
  v_cvt_pk_bf16_f32 v151, v142, v143
  s_waitcnt lgkmcnt(0)
  v_add3_u32 v48, v76, v77, s44
  v_add3_u32 v49, v78, v79, v92
  v_add3_u32 v48, v80, v81, v48
  v_add3_u32 v49, v82, v83, v49
  v_add3_u32 v48, v84, v85, v48
  v_add3_u32 v49, v86, v87, v49
  v_add3_u32 v48, v88, v89, v48
  v_add3_u32 v49, v90, v91, v49
  v_add3_u32 v48, v48, v93, v94
  v_add_u32 v48, v48, v49
  v_cmp_ne_u32 vcc, v48, v95
  s_nop 0
  s_mov_b64 s[92:93], vcc
  s_cbranch_vccnz Lnbe_91
Lnbed_92:
  v_mfma_f32_32x32x16_bf16 v[128:143], a[192:195], v[160:163], 0
  s_add_u32 m0, s21, 4096
  v_exp_f32 v112, v112
  v_exp_f32 v113, v113
  v_exp_f32 v114, v114
  v_exp_f32 v115, v115
  v_mfma_f32_32x32x16_bf16 v[224:239], a[220:223], v[148:151], v[224:239]
  v_cvt_pk_bf16_f32 v144, v112, v113
  v_exp_f32 v116, v116
  v_cvt_pk_bf16_f32 v145, v114, v115
  v_exp_f32 v117, v117
  v_exp_f32 v118, v118
  v_mfma_f32_32x32x8_bf16 v[128:143], a[196:197], v[170:171], v[128:143]
  v_exp_f32 v119, v119
  v_cvt_pk_bf16_f32 v146, v116, v117
  v_exp_f32 v120, v120
  v_cvt_pk_bf16_f32 v147, v118, v119
  v_exp_f32 v121, v121
  v_exp_f32 v122, v122
  v_mfma_f32_32x32x16_bf16 v[208:223], a[216:219], v[144:147], v[208:223]
  buffer_load_dwordx4 v174, s[8:11], m0 offen offset:0 sc1 lds
  buffer_load_dwordx4 v174, s[8:11], m0 offen offset:1024 sc1 lds
  buffer_load_dwordx4 v174, s[8:11], m0 offen offset:2048 sc1 lds
  buffer_load_dwordx4 v174, s[8:11], m0 offen offset:3072 sc1 lds
  v_exp_f32 v123, v123
  v_cvt_pk_bf16_f32 v148, v120, v121
  v_exp_f32 v124, v124
  v_cvt_pk_bf16_f32 v149, v122, v123
  v_exp_f32 v125, v125
  v_exp_f32 v126, v126
  v_exp_f32 v127, v127
  v_cvt_pk_bf16_f32 v150, v124, v125
  v_cvt_pk_bf16_f32 v151, v126, v127
  v_mfma_f32_32x32x16_bf16 v[112:127], a[192:195], v[156:159], 0
  ds_read_b128 a[200:203], v9 offset:25600
  ds_read_b32 a204, v10 offset:25600
  v_exp_f32 v128, v128
  v_exp_f32 v129, v129
  v_exp_f32 v130, v130
  v_exp_f32 v131, v131
  v_mfma_f32_32x32x16_bf16 v[208:223], a[220:223], v[148:151], v[208:223]
  ds_read_b64_tr_b16 a[216:217], v11 offset:25600
  ds_read_b64_tr_b16 a[218:219], v11 offset:25728
  ds_read_b64_tr_b16 a[220:221], v11 offset:25856
  ds_read_b64_tr_b16 a[222:223], v11 offset:25984
  v_cvt_pk_bf16_f32 v144, v128, v129
  v_exp_f32 v132, v132
  v_cvt_pk_bf16_f32 v145, v130, v131
  v_exp_f32 v133, v133
  v_exp_f32 v134, v134
  v_mfma_f32_32x32x8_bf16 v[112:127], a[196:197], v[168:169], v[112:127]
  v_exp_f32 v135, v135
  v_cvt_pk_bf16_f32 v146, v132, v133
  v_exp_f32 v136, v136
  v_cvt_pk_bf16_f32 v147, v134, v135
  v_exp_f32 v137, v137
  v_exp_f32 v138, v138
  v_mfma_f32_32x32x16_bf16 v[224:239], a[208:211], v[144:147], v[224:239]
  v_exp_f32 v139, v139
  v_cvt_pk_bf16_f32 v148, v136, v137
  v_exp_f32 v140, v140
  v_cvt_pk_bf16_f32 v149, v138, v139
  v_exp_f32 v141, v141
  v_exp_f32 v142, v142
  v_exp_f32 v143, v143
  v_cvt_pk_bf16_f32 v150, v140, v141
  v_cvt_pk_bf16_f32 v151, v142, v143
  s_waitcnt lgkmcnt(0)
  v_mfma_f32_32x32x16_bf16 v[128:143], a[200:203], v[160:163], 0
  s_add_u32 m0, s21, 8192
  v_exp_f32 v112, v112
  v_exp_f32 v113, v113
  v_exp_f32 v114, v114
  v_exp_f32 v115, v115
  v_mfma_f32_32x32x16_bf16 v[224:239], a[212:215], v[148:151], v[224:239]
  v_cvt_pk_bf16_f32 v144, v112, v113
  v_exp_f32 v116, v116
  v_cvt_pk_bf16_f32 v145, v114, v115
  v_exp_f32 v117, v117
  v_exp_f32 v118, v118
  v_mfma_f32_32x32x8_bf16 v[128:143], a[204:205], v[170:171], v[128:143]
  v_exp_f32 v119, v119
  v_cvt_pk_bf16_f32 v146, v116, v117
  v_exp_f32 v120, v120
  v_cvt_pk_bf16_f32 v147, v118, v119
  v_exp_f32 v121, v121
  v_exp_f32 v122, v122
  v_mfma_f32_32x32x16_bf16 v[208:223], a[208:211], v[144:147], v[208:223]
  buffer_load_dwordx4 v174, s[8:11], m0 offen offset:0 sc1 lds
  buffer_load_dwordx4 v174, s[8:11], m0 offen offset:1024 sc1 lds
  buffer_load_dwordx4 v174, s[8:11], m0 offen offset:2048 sc1 lds
  buffer_load_dwordx4 v174, s[8:11], m0 offen offset:3072 sc1 lds
  v_exp_f32 v123, v123
  v_cvt_pk_bf16_f32 v148, v120, v121
  v_exp_f32 v124, v124
  v_cvt_pk_bf16_f32 v149, v122, v123
  v_exp_f32 v125, v125
  v_exp_f32 v126, v126
  v_exp_f32 v127, v127
  v_cvt_pk_bf16_f32 v150, v124, v125
  v_cvt_pk_bf16_f32 v151, v126, v127
  s_cmp_lg_u64 s[92:93], 0
  s_cbranch_scc1 Lnbl_93
Lnbld_95:
  s_barrier
  v_mfma_f32_32x32x16_bf16 v[112:127], a[200:203], v[156:159], 0
  ds_read_b128 a[192:195], v9 offset:30720
  ds_read_b32 a196, v10 offset:30720
  v_exp_f32 v128, v128
  v_exp_f32 v129, v129
  v_exp_f32 v130, v130
  v_exp_f32 v131, v131
  v_mfma_f32_32x32x16_bf16 v[208:223], a[212:215], v[148:151], v[208:223]
  ds_read_b64_tr_b16 a[208:209], v11 offset:30720
  ds_read_b64_tr_b16 a[210:211], v11 offset:30848
  ds_read_b64_tr_b16 a[212:213], v11 offset:30976
  ds_read_b64_tr_b16 a[214:215], v11 offset:31104
  v_cvt_pk_bf16_f32 v144, v128, v129
  v_exp_f32 v132, v132
  v_cvt_pk_bf16_f32 v145, v130, v131
  v_exp_f32 v133, v133
  v_exp_f32 v134, v134
  v_mfma_f32_32x32x8_bf16 v[112:127], a[204:205], v[168:169], v[112:127]
  v_exp_f32 v135, v135
  v_cvt_pk_bf16_f32 v146, v132, v133
  v_exp_f32 v136, v136
  v_cvt_pk_bf16_f32 v147, v134, v135
  v_exp_f32 v137, v137
  v_exp_f32 v138, v138
  v_mfma_f32_32x32x16_bf16 v[224:239], a[216:219], v[144:147], v[224:239]
  v_exp_f32 v139, v139
  v_cvt_pk_bf16_f32 v148, v136, v137
  v_exp_f32 v140, v140
  v_cvt_pk_bf16_f32 v149, v138, v139
  v_exp_f32 v141, v141
  v_exp_f32 v142, v142
  v_exp_f32 v143, v143
  v_cvt_pk_bf16_f32 v150, v140, v141
  v_cvt_pk_bf16_f32 v151, v142, v143
  s_waitcnt lgkmcnt(0)
  v_mfma_f32_32x32x16_bf16 v[128:143], a[192:195], v[160:163], 0
  s_add_u32 m0, s21, 12288
  v_exp_f32 v112, v112
  v_exp_f32 v113, v113
  v_exp_f32 v114, v114
  v_exp_f32 v115, v115
  v_mfma_f32_32x32x16_bf16 v[224:239], a[220:223], v[148:151], v[224:239]
  v_cvt_pk_bf16_f32 v144, v112, v113
  v_exp_f32 v116, v116
  v_cvt_pk_bf16_f32 v145, v114, v115
  v_exp_f32 v117, v117
  v_exp_f32 v118, v118
  v_mfma_f32_32x32x8_bf16 v[128:143], a[196:197], v[170:171], v[128:143]
  v_exp_f32 v119, v119
  v_cvt_pk_bf16_f32 v146, v116, v117
  v_exp_f32 v120, v120
  v_cvt_pk_bf16_f32 v147, v118, v119
  v_exp_f32 v121, v121
  v_exp_f32 v122, v122
  v_mfma_f32_32x32x16_bf16 v[208:223], a[216:219], v[144:147], v[208:223]
  buffer_load_dwordx4 v174, s[8:11], m0 offen offset:0 sc1 lds
  buffer_load_dwordx4 v174, s[8:11], m0 offen offset:1024 sc1 lds
  buffer_load_dwordx4 v174, s[8:11], m0 offen offset:2048 sc1 lds
  buffer_load_dwordx4 v174, s[8:11], m0 offen offset:3072 sc1 lds
  v_exp_f32 v123, v123
  v_cvt_pk_bf16_f32 v148, v120, v121
  v_exp_f32 v124, v124
  v_cvt_pk_bf16_f32 v149, v122, v123
  v_exp_f32 v125, v125
  v_exp_f32 v126, v126
  v_exp_f32 v127, v127
  v_cvt_pk_bf16_f32 v150, v124, v125
  v_cvt_pk_bf16_f32 v151, v126, v127
  v_mfma_f32_32x32x16_bf16 v[112:127], a[192:195], v[156:159], 0
  ds_read_b128 a[200:203], v9 offset:35840
  ds_read_b32 a204, v10 offset:35840
  v_exp_f32 v128, v128
  v_exp_f32 v129, v129
  v_exp_f32 v130, v130
  v_exp_f32 v131, v131
  v_mfma_f32_32x32x16_bf16 v[208:223], a[220:223], v[148:151], v[208:223]
  ds_read_b64_tr_b16 a[216:217], v11 offset:35840
  ds_read_b64_tr_b16 a[218:219], v11 offset:35968
  ds_read_b64_tr_b16 a[220:221], v11 offset:36096
  ds_read_b64_tr_b16 a[222:223], v11 offset:36224
  v_cvt_pk_bf16_f32 v144, v128, v129
  v_exp_f32 v132, v132
  v_cvt_pk_bf16_f32 v145, v130, v131
  v_exp_f32 v133, v133
  v_exp_f32 v134, v134
  v_mfma_f32_32x32x8_bf16 v[112:127], a[196:197], v[168:169], v[112:127]
  v_exp_f32 v135, v135
  v_cvt_pk_bf16_f32 v146, v132, v133
  v_exp_f32 v136, v136
  v_cvt_pk_bf16_f32 v147, v134, v135
  v_exp_f32 v137, v137
  v_exp_f32 v138, v138
  v_mfma_f32_32x32x16_bf16 v[224:239], a[208:211], v[144:147], v[224:239]
  v_exp_f32 v139, v139
  v_cvt_pk_bf16_f32 v148, v136, v137
  v_exp_f32 v140, v140
  v_cvt_pk_bf16_f32 v149, v138, v139
  v_exp_f32 v141, v141
  v_exp_f32 v142, v142
  v_exp_f32 v143, v143
  v_cvt_pk_bf16_f32 v150, v140, v141
  v_cvt_pk_bf16_f32 v151, v142, v143
  s_waitcnt lgkmcnt(0)
  v_mfma_f32_32x32x16_bf16 v[128:143], a[200:203], v[160:163], 0
  s_add_u32 m0, s21, 16384
  v_exp_f32 v112, v112
  v_exp_f32 v113, v113
  v_exp_f32 v114, v114
  v_exp_f32 v115, v115
  v_mfma_f32_32x32x16_bf16 v[224:239], a[212:215], v[148:151], v[224:239]
  v_cvt_pk_bf16_f32 v144, v112, v113
  v_exp_f32 v116, v116
  v_cvt_pk_bf16_f32 v145, v114, v115
  v_exp_f32 v117, v117
  v_exp_f32 v118, v118
  v_mfma_f32_32x32x8_bf16 v[128:143], a[204:205], v[170:171], v[128:143]
  v_exp_f32 v119, v119
  v_cvt_pk_bf16_f32 v146, v116, v117
  v_exp_f32 v120, v120
  v_cvt_pk_bf16_f32 v147, v118, v119
  v_exp_f32 v121, v121
  v_exp_f32 v122, v122
  v_mfma_f32_32x32x16_bf16 v[208:223], a[208:211], v[144:147], v[208:223]
  buffer_load_dwordx4 v174, s[8:11], m0 offen offset:0 sc1 lds
  buffer_load_dwordx4 v174, s[8:11], m0 offen offset:1024 sc1 lds
  buffer_load_dwordx4 v174, s[8:11], m0 offen offset:2048 sc1 lds
  buffer_load_dwordx4 v174, s[8:11], m0 offen offset:3072 sc1 lds
  v_exp_f32 v123, v123
  v_cvt_pk_bf16_f32 v148, v120, v121
  v_exp_f32 v124, v124
  v_cvt_pk_bf16_f32 v149, v122, v123
  v_exp_f32 v125, v125
  v_exp_f32 v126, v126
  v_exp_f32 v127, v127
  v_cvt_pk_bf16_f32 v150, v124, v125
  v_cvt_pk_bf16_f32 v151, v126, v127
  v_mfma_f32_32x32x16_bf16 v[112:127], a[200:203], v[156:159], 0
  ds_read_b128 a[192:195], v9 offset:40960
  ds_read_b32 a196, v10 offset:40960
  v_exp_f32 v128, v128
  v_exp_f32 v129, v129
  v_exp_f32 v130, v130
  v_exp_f32 v131, v131
  v_mfma_f32_32x32x16_bf16 v[208:223], a[212:215], v[148:151], v[208:223]
  ds_read_b64_tr_b16 a[208:209], v11 offset:40960
  ds_read_b64_tr_b16 a[210:211], v11 offset:41088
  ds_read_b64_tr_b16 a[212:213], v11 offset:41216
  ds_read_b64_tr_b16 a[214:215], v11 offset:41344
  v_cvt_pk_bf16_f32 v144, v128, v129
  v_exp_f32 v132, v132
  v_cvt_pk_bf16_f32 v145, v130, v131
  v_exp_f32 v133, v133
  v_exp_f32 v134, v134
  v_mfma_f32_32x32x8_bf16 v[112:127], a[204:205], v[168:169], v[112:127]
  v_exp_f32 v135, v135
  v_cvt_pk_bf16_f32 v146, v132, v133
  v_exp_f32 v136, v136
  v_cvt_pk_bf16_f32 v147, v134, v135
  v_exp_f32 v137, v137
  v_exp_f32 v138, v138
  v_mfma_f32_32x32x16_bf16 v[224:239], a[216:219], v[144:147], v[224:239]
  v_exp_f32 v139, v139
  v_cvt_pk_bf16_f32 v148, v136, v137
  v_exp_f32 v140, v140
  v_cvt_pk_bf16_f32 v149, v138, v139
  v_exp_f32 v141, v141
  v_exp_f32 v142, v142
  v_exp_f32 v143, v143
  v_cvt_pk_bf16_f32 v150, v140, v141
  v_cvt_pk_bf16_f32 v151, v142, v143
  s_waitcnt lgkmcnt(0)
  v_mfma_f32_32x32x16_bf16 v[128:143], a[192:195], v[160:163], v[192:207]
  s_add_u32 m0, s21, 20480
  v_exp_f32 v112, v112
  v_exp_f32 v113, v113
  v_exp_f32 v114, v114
  v_exp_f32 v115, v115
  v_mfma_f32_32x32x16_bf16 v[224:239], a[220:223], v[148:151], v[224:239]
  v_cvt_pk_bf16_f32 v144, v112, v113
  v_exp_f32 v116, v116
  v_cvt_pk_bf16_f32 v145, v114, v115
  v_exp_f32 v117, v117
  v_exp_f32 v118, v118
  v_mfma_f32_32x32x8_bf16 v[128:143], a[196:197], v[170:171], v[128:143]
  v_exp_f32 v119, v119
  v_cvt_pk_bf16_f32 v146, v116, v117
  v_exp_f32 v120, v120
  v_cvt_pk_bf16_f32 v147, v118, v119
  v_exp_f32 v121, v121
  v_exp_f32 v122, v122
  v_mfma_f32_32x32x16_bf16 v[208:223], a[216:219], v[144:147], v[208:223]
  buffer_load_dwordx4 v174, s[8:11], m0 offen offset:0 sc1 lds
  buffer_load_dwordx4 v174, s[8:11], m0 offen offset:1024 sc1 lds
  buffer_load_dwordx4 v174, s[8:11], m0 offen offset:2048 sc1 lds
  v_exp_f32 v123, v123
  v_cvt_pk_bf16_f32 v148, v120, v121
  v_exp_f32 v124, v124
  v_cvt_pk_bf16_f32 v149, v122, v123
  v_exp_f32 v125, v125
  v_exp_f32 v126, v126
  v_exp_f32 v127, v127
  v_cvt_pk_bf16_f32 v150, v124, v125
  v_cvt_pk_bf16_f32 v151, v126, v127
  v_mfma_f32_32x32x16_bf16 v[112:127], a[192:195], v[156:159], 0
  ds_read_b128 a[200:203], v9 offset:46080
  ds_read_b32 a204, v10 offset:46080
  v_exp_f32 v128, v128
  v_exp_f32 v129, v129
  v_exp_f32 v130, v130
  v_exp_f32 v131, v131
  v_mfma_f32_32x32x16_bf16 v[208:223], a[220:223], v[148:151], v[208:223]
  ds_read_b64_tr_b16 a[216:217], v11 offset:46080
  ds_read_b64_tr_b16 a[218:219], v11 offset:46208
  ds_read_b64_tr_b16 a[220:221], v11 offset:46336
  ds_read_b64_tr_b16 a[222:223], v11 offset:46464
  v_cvt_pk_bf16_f32 v144, v128, v129
  v_exp_f32 v132, v132
  v_cvt_pk_bf16_f32 v145, v130, v131
  v_exp_f32 v133, v133
  v_exp_f32 v134, v134
  v_mfma_f32_32x32x8_bf16 v[112:127], a[196:197], v[168:169], v[112:127]
  v_exp_f32 v135, v135
  v_cvt_pk_bf16_f32 v146, v132, v133
  v_exp_f32 v136, v136
  v_cvt_pk_bf16_f32 v147, v134, v135
  v_exp_f32 v137, v137
  v_exp_f32 v138, v138
  v_mfma_f32_32x32x16_bf16 v[224:239], a[208:211], v[144:147], v[224:239]
  v_exp_f32 v139, v139
  v_cvt_pk_bf16_f32 v148, v136, v137
  v_exp_f32 v140, v140
  v_cvt_pk_bf16_f32 v149, v138, v139
  v_exp_f32 v141, v141
  v_exp_f32 v142, v142
  v_exp_f32 v143, v143
  v_cvt_pk_bf16_f32 v150, v140, v141
  v_cvt_pk_bf16_f32 v151, v142, v143
  s_waitcnt lgkmcnt(0)
  v_mfma_f32_32x32x16_bf16 v[128:143], a[200:203], v[156:159], v[192:207]
  v_exp_f32 v112, v112
  v_exp_f32 v113, v113
  v_exp_f32 v114, v114
  v_exp_f32 v115, v115
  v_mfma_f32_32x32x16_bf16 v[224:239], a[212:215], v[148:151], v[224:239]
  v_cvt_pk_bf16_f32 v144, v112, v113
  v_exp_f32 v116, v116
  v_cvt_pk_bf16_f32 v145, v114, v115
  v_exp_f32 v117, v117
  v_exp_f32 v118, v118
  v_mfma_f32_32x32x8_bf16 v[128:143], a[204:205], v[168:169], v[128:143]
  v_exp_f32 v119, v119
  v_cvt_pk_bf16_f32 v146, v116, v117
  v_exp_f32 v120, v120
  v_cvt_pk_bf16_f32 v147, v118, v119
  v_exp_f32 v121, v121
  v_exp_f32 v122, v122
  v_mfma_f32_32x32x16_bf16 v[208:223], a[208:211], v[144:147], v[208:223]
  v_exp_f32 v123, v123
  v_cvt_pk_bf16_f32 v148, v120, v121
  v_exp_f32 v124, v124
  v_cvt_pk_bf16_f32 v149, v122, v123
  v_exp_f32 v125, v125
  v_exp_f32 v126, v126
  v_exp_f32 v127, v127
  v_cvt_pk_bf16_f32 v150, v124, v125
  v_cvt_pk_bf16_f32 v151, v126, v127
  v_rcp_f32 v236, v234
  s_nop 0
  v_pk_mul_f32 v[224:225], v[224:225], v[236:237] op_sel_hi:[1,0]
  v_pk_mul_f32 v[226:227], v[226:227], v[236:237] op_sel_hi:[1,0]
  v_pk_mul_f32 v[228:229], v[228:229], v[236:237] op_sel_hi:[1,0]
  v_pk_mul_f32 v[230:231], v[230:231], v[236:237] op_sel_hi:[1,0]
  v_pk_mul_f32 v[232:233], v[232:233], v[236:237] op_sel_hi:[1,0]
  v_cvt_pk_bf16_f32 v244, v224, v225
  v_cvt_pk_bf16_f32 v245, v226, v227
  v_cvt_pk_bf16_f32 v246, v228, v229
  v_cvt_pk_bf16_f32 v247, v230, v231
  s_cmp_lg_u32 s56, 0
  s_cbranch_scc1 Lsafe_96
  buffer_store_dwordx4 v[244:247], v7, s[8:11], s17 offen
Lback_97:
  v_cvt_pk_bf16_f32 v249, v232, v233
  v_exp_f32 v128, v128
  v_exp_f32 v129, v129
  v_exp_f32 v130, v130
  v_exp_f32 v131, v131
  v_mfma_f32_32x32x16_bf16 v[208:223], a[212:215], v[148:151], v[208:223]
  v_cvt_pk_bf16_f32 v144, v128, v129
  v_exp_f32 v132, v132
  v_cvt_pk_bf16_f32 v145, v130, v131
  v_exp_f32 v133, v133
  v_exp_f32 v134, v134
  v_exp_f32 v135, v135
  v_cvt_pk_bf16_f32 v146, v132, v133
  v_exp_f32 v136, v136
  v_cvt_pk_bf16_f32 v147, v134, v135
  v_exp_f32 v137, v137
  v_exp_f32 v138, v138
  v_mfma_f32_32x32x16_bf16 v[208:223], a[216:219], v[144:147], v[208:223]
  v_exp_f32 v139, v139
  v_cvt_pk_bf16_f32 v148, v136, v137
  v_exp_f32 v140, v140
  v_cvt_pk_bf16_f32 v149, v138, v139
  v_exp_f32 v141, v141
  v_exp_f32 v142, v142
  v_exp_f32 v143, v143
  v_cvt_pk_bf16_f32 v150, v140, v141
  v_cvt_pk_bf16_f32 v151, v142, v143
  s_nop 1
  v_mfma_f32_32x32x16_bf16 v[208:223], a[220:223], v[148:151], v[208:223]
  s_mov_b32 s80, 1509949440
Lslowback_99:
  s_mov_b32 vcc_lo, 0
  s_mov_b32 vcc_hi, -1
  v_lshlrev_b32 v56, 16, v22
  v_and_b32 v57, 0xffff0000, v22
  v_lshlrev_b32 v58, 16, v23
  v_and_b32 v59, 0xffff0000, v23
  v_lshlrev_b32 v60, 16, v24
  v_and_b32 v61, 0xffff0000, v24
  v_lshlrev_b32 v62, 16, v25
  v_and_b32 v63, 0xffff0000, v25
  v_lshlrev_b32 v64, 16, v26
  v_and_b32 v65, 0xffff0000, v26
  v_lshlrev_b32 v66, 16, v27
  v_and_b32 v67, 0xffff0000, v27
  v_lshlrev_b32 v68, 16, v28
  v_and_b32 v69, 0xffff0000, v28
  v_lshlrev_b32 v70, 16, v29
  v_and_b32 v71, 0xffff0000, v29
  v_lshlrev_b32 v72, 16, v30
  v_and_b32 v73, 0xffff0000, v30
  v_lshlrev_b32 v74, 16, v31
  v_and_b32 v75, 0xffff0000, v31
  v_rcp_f32 v220, v218
  s_nop 0
  v_pk_mul_f32 v[208:209], v[208:209], v[220:221] op_sel_hi:[1,0]
  v_pk_mul_f32 v[210:211], v[210:211], v[220:221] op_sel_hi:[1,0]
  v_pk_mul_f32 v[212:213], v[212:213], v[220:221] op_sel_hi:[1,0]
  v_pk_mul_f32 v[214:215], v[214:215], v[220:221] op_sel_hi:[1,0]
  v_pk_mul_f32 v[216:217], v[216:217], v[220:221] op_sel_hi:[1,0]
  v_cvt_pk_bf16_f32 v240, v208, v209
  v_cvt_pk_bf16_f32 v241, v210, v211
  v_cvt_pk_bf16_f32 v242, v212, v213
  v_cvt_pk_bf16_f32 v243, v214, v215
  v_cvt_pk_bf16_f32 v248, v216, v217
  v_cndmask_b32 v248, v248, v249, vcc
  s_cmp_lg_u32 s56, 0
  s_cbranch_scc1 Lsafe_102
  buffer_store_dwordx4 v[240:243], v7, s[8:11], s16 offen
  buffer_store_dword v248, v175, s[8:11], s18 offen
Lback_103:
  v_subrev_u32 v48, 310378496, v218
  v_subrev_u32 v49, 310378496, v234
  v_max_u32 v48, v48, v49
  v_cmp_lt_u32 vcc, s80, v48
  s_cbranch_vccnz Lslow_98
  s_add_u32 s72, s72, 5242880
  s_add_u32 s41, s41, 5242880
  s_add_u32 s42, s42, 5242880
  s_waitcnt vmcnt(3)
  s_barrier
  v_lshlrev_b32 v48, 7, v16
  s_mov_b64 exec, 3
  s_waitcnt vmcnt(0)
  s_cmp_lg_u32 s56, 0
  s_cbranch_scc1 Lsafe_104
  buffer_store_dword v17, v48, s[8:11], s20 offen
Lback_105:
  s_mov_b64 exec, -1
  ds_read_b128 v[76:79], v2 offset:0
  ds_read_b128 v[80:83], v2 offset:1024
  ds_read_b128 v[84:87], v2 offset:2048
  ds_read_b128 v[88:91], v2 offset:3072
  ds_read_b128 v[92:95], v2 offset:4096
  ds_read_b128 v[96:99], v2 offset:5120
  ds_read_b128 v[100:103], v2 offset:6144
  ds_read_b128 v[104:107], v2 offset:7168
  ds_read_b128 v[108:111], v2 offset:8192
  ds_read_b128 v[112:115], v2 offset:9216
  v_and_b32 v48, 15, v16
  v_lshrrev_b32 v49, 4, v16
  v_mul_u32_u24 v48, 144, v48
  s_lshl_b32 s80, s54, 12
  s_add_u32 s80, s80, 38912
  v_add_u32 v48, s80, v48
  v_lshl_add_u32 v152, v49, 4, v48
  v_lshl_add_u32 v153, v49, 3, v48
  v_add_u32 v153, 128, v153
  v_cmp_gt_u32 vcc, 2, v49
  v_mov_b32 v48, 157696
  s_nop 0
  v_cndmask_b32 v153, v48, v153, vcc
  v_readfirstlane_b32 s81, v13
  v_add_u32 v48, 0, v16
  v_mul_u32_u24 v49, 57, v48
  v_lshrrev_b32 v49, 9, v49
  v_mul_u32_u24 v49, 1008, v49
  v_lshl_add_u32 v49, v48, 4, v49
  v_add_u32 v154, s81, v49
  v_add_u32 v48, 64, v16
  v_mul_u32_u24 v49, 57, v48
  v_lshrrev_b32 v49, 9, v49
  v_mul_u32_u24 v49, 1008, v49
  v_lshl_add_u32 v49, v48, 4, v49
  v_add_u32 v155, s81, v49
  v_add_u32 v48, 128, v16
  v_mul_u32_u24 v49, 57, v48
  v_lshrrev_b32 v49, 9, v49
  v_mul_u32_u24 v49, 1008, v49
  v_lshl_add_u32 v49, v48, 4, v49
  v_add_u32 v156, s81, v49
  v_cmp_gt_u32 vcc, 16, v16
  v_mov_b32 v48, 2147483648
  s_nop 0
  v_cndmask_b32 v156, v48, v156, vcc
  s_mov_b32 s32, s70
  buffer_load_dword v165, v39, s[8:11], s71 offen sc1
Lpoll_106:
  s_waitcnt vmcnt(0)
  v_cmp_ne_u32 vcc, s55, v165
  s_nop 0
  s_cmp_lg_u64 vcc, 0
  s_cbranch_scc0 Lpdone_108
  s_cmp_eq_u32 s57, 0
  s_cbranch_scc1 Lpdone_108
  s_sub_u32 s57, s57, 1
  buffer_load_dword v165, v39, s[8:11], s71 offen sc1
  s_branch Lpoll_106
Lpdone_108:
  buffer_load_dwordx4 v[176:179], v1, s[8:11], s32 offen offset:0 sc1
  buffer_load_dwordx4 v[180:183], v1, s[8:11], s32 offen offset:1024 sc1
  buffer_load_dwordx4 v[184:187], v1, s[8:11], s32 offen offset:2048 sc1
  buffer_load_dwordx4 v[188:191], v1, s[8:11], s32 offen offset:3072 sc1
  s_add_u32 s32, s32, 4096
  buffer_load_dwordx4 v[192:195], v1, s[8:11], s32 offen offset:0 sc1
  buffer_load_dwordx4 v[196:199], v1, s[8:11], s32 offen offset:1024 sc1
  s_waitcnt vmcnt(5) lgkmcnt(5)
  v_mfma_f32_16x16x32_bf16 v[56:59], v[76:79], v[176:179], v[56:59]
  ds_read_b128 v[116:119], v2 offset:10240
  buffer_load_dwordx4 v[200:203], v1, s[8:11], s32 offen offset:2048 sc1
  v_mfma_f32_16x16x32_bf16 v[60:63], v[80:83], v[176:179], v[60:63]
  ds_read_b128 v[120:123], v2 offset:11264
  buffer_load_dwordx4 v[204:207], v1, s[8:11], s32 offen offset:3072 sc1
  v_mfma_f32_16x16x32_bf16 v[64:67], v[84:87], v[176:179], v[64:67]
  ds_read_b128 v[124:127], v2 offset:12288
  s_add_u32 s32, s32, 4096
  v_mfma_f32_16x16x32_bf16 v[68:71], v[88:91], v[176:179], v[68:71]
  ds_read_b128 v[128:131], v2 offset:13312
  v_mfma_f32_16x16x32_bf16 v[72:75], v[92:95], v[176:179], v[72:75]
  ds_read_b128 v[132:135], v2 offset:14336
  s_waitcnt vmcnt(6) lgkmcnt(5)
  v_mfma_f32_16x16x32_bf16 v[56:59], v[96:99], v[180:183], v[56:59]
  ds_read_b128 v[76:79], v2 offset:15360
  buffer_load_dwordx4 v[208:211], v1, s[8:11], s32 offen offset:0 sc1
  v_mfma_f32_16x16x32_bf16 v[60:63], v[100:103], v[180:183], v[60:63]
  ds_read_b128 v[80:83], v2 offset:16384
  buffer_load_dwordx4 v[212:215], v1, s[8:11], s32 offen offset:1024 sc1
  v_mfma_f32_16x16x32_bf16 v[64:67], v[104:107], v[180:183], v[64:67]
  ds_read_b128 v[84:87], v2 offset:17408
  v_mfma_f32_16x16x32_bf16 v[68:71], v[108:111], v[180:183], v[68:71]
  ds_read_b128 v[88:91], v2 offset:18432
  v_mfma_f32_16x16x32_bf16 v[72:75], v[112:115], v[180:183], v[72:75]
  ds_read_b128 v[92:95], v2 offset:19456
  s_waitcnt vmcnt(7) lgkmcnt(5)
  v_mfma_f32_16x16x32_bf16 v[56:59], v[116:119], v[184:187], v[56:59]
  ds_read_b128 v[96:99], v2 offset:20480
  buffer_load_dwordx4 v[216:219], v1, s[8:11], s32 offen offset:2048 sc1
  v_mfma_f32_16x16x32_bf16 v[60:63], v[120:123], v[184:187], v[60:63]
  ds_read_b128 v[100:103], v2 offset:21504
  v_mfma_f32_16x16x32_bf16 v[64:67], v[124:127], v[184:187], v[64:67]
  ds_read_b128 v[104:107], v2 offset:22528
  v_mfma_f32_16x16x32_bf16 v[68:71], v[128:131], v[184:187], v[68:71]
  ds_read_b128 v[108:111], v2 offset:23552
  v_mfma_f32_16x16x32_bf16 v[72:75], v[132:135], v[184:187], v[72:75]
  ds_read_b128 v[112:115], v2 offset:24576
  s_waitcnt vmcnt(7) lgkmcnt(5)
  v_mfma_f32_16x16x32_bf16 v[56:59], v[76:79], v[188:191], v[56:59]
  ds_read_b128 v[116:119], v2 offset:25600
  buffer_load_dwordx4 v[220:223], v1, s[8:11], s32 offen offset:3072 sc1
  v_mfma_f32_16x16x32_bf16 v[60:63], v[80:83], v[188:191], v[60:63]
  ds_read_b128 v[120:123], v2 offset:26624
  s_add_u32 s32, s32, 4096
  v_mfma_f32_16x16x32_bf16 v[64:67], v[84:87], v[188:191], v[64:67]
  ds_read_b128 v[124:127], v2 offset:27648
  buffer_load_dwordx4 v[224:227], v1, s[8:11], s32 offen offset:0 sc1
  v_mfma_f32_16x16x32_bf16 v[68:71], v[88:91], v[188:191], v[68:71]
  ds_read_b128 v[128:131], v2 offset:28672
  v_mfma_f32_16x16x32_bf16 v[72:75], v[92:95], v[188:191], v[72:75]
  ds_read_b128 v[132:135], v2 offset:29696
  s_waitcnt vmcnt(8) lgkmcnt(5)
  v_mfma_f32_16x16x32_bf16 v[56:59], v[96:99], v[192:195], v[56:59]
  ds_read_b128 v[76:79], v2 offset:30720
  buffer_load_dwordx4 v[228:231], v1, s[8:11], s32 offen offset:1024 sc1
  v_mfma_f32_16x16x32_bf16 v[60:63], v[100:103], v[192:195], v[60:63]
  ds_read_b128 v[80:83], v2 offset:31744
  v_mfma_f32_16x16x32_bf16 v[64:67], v[104:107], v[192:195], v[64:67]
  ds_read_b128 v[84:87], v2 offset:32768
  v_mfma_f32_16x16x32_bf16 v[68:71], v[108:111], v[192:195], v[68:71]
  ds_read_b128 v[88:91], v2 offset:33792
  v_mfma_f32_16x16x32_bf16 v[72:75], v[112:115], v[192:195], v[72:75]
  ds_read_b128 v[92:95], v2 offset:34816
  s_waitcnt vmcnt(8) lgkmcnt(5)
  v_mfma_f32_16x16x32_bf16 v[56:59], v[116:119], v[196:199], v[56:59]
  ds_read_b128 v[96:99], v2 offset:35840
  buffer_load_dwordx4 v[232:235], v1, s[8:11], s32 offen offset:2048 sc1
  v_mfma_f32_16x16x32_bf16 v[60:63], v[120:123], v[196:199], v[60:63]
  ds_read_b128 v[100:103], v2 offset:36864
  buffer_load_dwordx4 v[236:239], v1, s[8:11], s32 offen offset:3072 sc1
  v_mfma_f32_16x16x32_bf16 v[64:67], v[124:127], v[196:199], v[64:67]
  ds_read_b128 v[104:107], v2 offset:37888
  s_add_u32 s32, s32, 4096
  v_mfma_f32_16x16x32_bf16 v[68:71], v[128:131], v[196:199], v[68:71]
  ds_read_b128 v[108:111], v2 offset:38912
  v_mfma_f32_16x16x32_bf16 v[72:75], v[132:135], v[196:199], v[72:75]
  ds_read_b128 v[112:115], v2 offset:39936
  s_waitcnt vmcnt(9) lgkmcnt(5)
  v_mfma_f32_16x16x32_bf16 v[56:59], v[76:79], v[200:203], v[56:59]
  ds_read_b128 v[116:119], v2 offset:40960
  buffer_load_dwordx4 v[240:243], v1, s[8:11], s32 offen offset:0 sc1
  v_mfma_f32_16x16x32_bf16 v[60:63], v[80:83], v[200:203], v[60:63]
  ds_read_b128 v[120:123], v2 offset:41984
  v_mfma_f32_16x16x32_bf16 v[64:67], v[84:87], v[200:203], v[64:67]
  ds_read_b128 v[124:127], v2 offset:43008
  v_mfma_f32_16x16x32_bf16 v[68:71], v[88:91], v[200:203], v[68:71]
  ds_read_b128 v[128:131], v2 offset:44032
  v_mfma_f32_16x16x32_bf16 v[72:75], v[92:95], v[200:203], v[72:75]
  ds_read_b128 v[132:135], v2 offset:45056
  s_waitcnt vmcnt(9) lgkmcnt(5)
  v_mfma_f32_16x16x32_bf16 v[56:59], v[96:99], v[204:207], v[56:59]
  ds_read_b128 v[76:79], v2 offset:46080
  buffer_load_dwordx4 v[244:247], v1, s[8:11], s32 offen offset:1024 sc1
  v_mfma_f32_16x16x32_bf16 v[60:63], v[100:103], v[204:207], v[60:63]
  ds_read_b128 v[80:83], v2 offset:47104
  v_mfma_f32_16x16x32_bf16 v[64:67], v[104:107], v[204:207], v[64:67]
  ds_read_b128 v[84:87], v2 offset:48128
  v_mfma_f32_16x16x32_bf16 v[68:71], v[108:111], v[204:207], v[68:71]
  ds_read_b128 v[88:91], v2 offset:49152
  v_mfma_f32_16x16x32_bf16 v[72:75], v[112:115], v[204:207], v[72:75]
  ds_read_b128 v[92:95], v2 offset:50176
  s_waitcnt vmcnt(9) lgkmcnt(5)
  v_mfma_f32_16x16x32_bf16 v[56:59], v[116:119], v[208:211], v[56:59]
  ds_read_b128 v[96:99], v2 offset:51200
  v_mfma_f32_16x16x32_bf16 v[60:63], v[120:123], v[208:211], v[60:63]
  ds_read_b128 v[100:103], v2 offset:52224
  v_mfma_f32_16x16x32_bf16 v[64:67], v[124:127], v[208:211], v[64:67]
  ds_read_b128 v[104:107], v2 offset:53248
  v_mfma_f32_16x16x32_bf16 v[68:71], v[128:131], v[208:211], v[68:71]
  ds_read_b128 v[108:111], v2 offset:54272
  v_mfma_f32_16x16x32_bf16 v[72:75], v[132:135], v[208:211], v[72:75]
  ds_read_b128 v[112:115], v2 offset:55296
  s_waitcnt vmcnt(8) lgkmcnt(5)
  v_mfma_f32_16x16x32_bf16 v[56:59], v[76:79], v[212:215], v[56:59]
  ds_read_b128 v[116:119], v2 offset:56320
  v_mfma_f32_16x16x32_bf16 v[60:63], v[80:83], v[212:215], v[60:63]
  ds_read_b128 v[120:123], v2 offset:57344
  v_mfma_f32_16x16x32_bf16 v[64:67], v[84:87], v[212:215], v[64:67]
  ds_read_b128 v[124:127], v2 offset:58368
  v_mfma_f32_16x16x32_bf16 v[68:71], v[88:91], v[212:215], v[68:71]
  ds_read_b128 v[128:131], v2 offset:59392
  v_mfma_f32_16x16x32_bf16 v[72:75], v[92:95], v[212:215], v[72:75]
  ds_read_b128 v[132:135], v2 offset:60416
  s_waitcnt vmcnt(7) lgkmcnt(5)
  v_mfma_f32_16x16x32_bf16 v[56:59], v[96:99], v[216:219], v[56:59]
  ds_read_b128 v[76:79], v2 offset:61440
  v_mfma_f32_16x16x32_bf16 v[60:63], v[100:103], v[216:219], v[60:63]
  ds_read_b128 v[80:83], v2 offset:62464
  v_mfma_f32_16x16x32_bf16 v[64:67], v[104:107], v[216:219], v[64:67]
  ds_read_b128 v[84:87], v2 offset:63488
  v_mfma_f32_16x16x32_bf16 v[68:71], v[108:111], v[216:219], v[68:71]
  ds_read_b128 v[88:91], v2 offset:64512
  v_mfma_f32_16x16x32_bf16 v[72:75], v[112:115], v[216:219], v[72:75]
  ds_read_b128 v[92:95], v18 offset:0
  s_waitcnt vmcnt(6) lgkmcnt(5)
  v_mfma_f32_16x16x32_bf16 v[56:59], v[116:119], v[220:223], v[56:59]
  ds_read_b128 v[96:99], v18 offset:1024
  v_mfma_f32_16x16x32_bf16 v[60:63], v[120:123], v[220:223], v[60:63]
  ds_read_b128 v[100:103], v18 offset:2048
  v_mfma_f32_16x16x32_bf16 v[64:67], v[124:127], v[220:223], v[64:67]
  ds_read_b128 v[104:107], v18 offset:3072
  v_mfma_f32_16x16x32_bf16 v[68:71], v[128:131], v[220:223], v[68:71]
  ds_read_b128 v[108:111], v18 offset:4096
  v_mfma_f32_16x16x32_bf16 v[72:75], v[132:135], v[220:223], v[72:75]
  ds_read_b128 v[112:115], v18 offset:5120
  s_waitcnt vmcnt(5) lgkmcnt(5)
  v_mfma_f32_16x16x32_bf16 v[56:59], v[76:79], v[224:227], v[56:59]
  ds_read_b128 v[116:119], v18 offset:6144
  v_mfma_f32_16x16x32_bf16 v[60:63], v[80:83], v[224:227], v[60:63]
  ds_read_b128 v[120:123], v18 offset:7168
  v_mfma_f32_16x16x32_bf16 v[64:67], v[84:87], v[224:227], v[64:67]
  ds_read_b128 v[124:127], v18 offset:8192
  v_mfma_f32_16x16x32_bf16 v[68:71], v[88:91], v[224:227], v[68:71]
  ds_read_b128 v[128:131], v18 offset:9216
  v_mfma_f32_16x16x32_bf16 v[72:75], v[92:95], v[224:227], v[72:75]
  ds_read_b128 v[132:135], v18 offset:10240
  s_waitcnt vmcnt(4) lgkmcnt(5)
  v_mfma_f32_16x16x32_bf16 v[56:59], v[96:99], v[228:231], v[56:59]
  ds_read_b128 v[76:79], v18 offset:11264
  v_mfma_f32_16x16x32_bf16 v[60:63], v[100:103], v[228:231], v[60:63]
  ds_read_b128 v[80:83], v18 offset:12288
  v_mfma_f32_16x16x32_bf16 v[64:67], v[104:107], v[228:231], v[64:67]
  ds_read_b128 v[84:87], v18 offset:13312
  v_mfma_f32_16x16x32_bf16 v[68:71], v[108:111], v[228:231], v[68:71]
  ds_read_b128 v[88:91], v18 offset:14336
  v_mfma_f32_16x16x32_bf16 v[72:75], v[112:115], v[228:231], v[72:75]
  ds_read_b128 v[92:95], v18 offset:15360
  s_waitcnt vmcnt(3) lgkmcnt(5)
  v_mfma_f32_16x16x32_bf16 v[56:59], v[116:119], v[232:235], v[56:59]
  ds_read_b128 v[96:99], v18 offset:16384
  v_mfma_f32_16x16x32_bf16 v[60:63], v[120:123], v[232:235], v[60:63]
  ds_read_b128 v[100:103], v18 offset:17408
  v_mfma_f32_16x16x32_bf16 v[64:67], v[124:127], v[232:235], v[64:67]
  ds_read_b128 v[104:107], v18 offset:18432
  v_mfma_f32_16x16x32_bf16 v[68:71], v[128:131], v[232:235], v[68:71]
  ds_read_b128 v[108:111], v18 offset:19456
  v_mfma_f32_16x16x32_bf16 v[72:75], v[132:135], v[232:235], v[72:75]
  ds_read_b128 v[112:115], v18 offset:20480
  s_waitcnt vmcnt(2) lgkmcnt(5)
  v_mfma_f32_16x16x32_bf16 v[56:59], v[76:79], v[236:239], v[56:59]
  ds_read_b128 v[116:119], v18 offset:21504
  v_mfma_f32_16x16x32_bf16 v[60:63], v[80:83], v[236:239], v[60:63]
  ds_read_b128 v[120:123], v18 offset:22528
  v_mfma_f32_16x16x32_bf16 v[64:67], v[84:87], v[236:239], v[64:67]
  ds_read_b128 v[124:127], v18 offset:23552
  v_mfma_f32_16x16x32_bf16 v[68:71], v[88:91], v[236:239], v[68:71]
  ds_read_b128 v[128:131], v18 offset:24576
  v_mfma_f32_16x16x32_bf16 v[72:75], v[92:95], v[236:239], v[72:75]
  ds_read_b128 v[132:135], v18 offset:25600
  s_waitcnt vmcnt(1) lgkmcnt(5)
  v_mfma_f32_16x16x32_bf16 v[56:59], v[96:99], v[240:243], v[56:59]
  v_mfma_f32_16x16x32_bf16 v[60:63], v[100:103], v[240:243], v[60:63]
  v_mfma_f32_16x16x32_bf16 v[64:67], v[104:107], v[240:243], v[64:67]
  v_mfma_f32_16x16x32_bf16 v[68:71], v[108:111], v[240:243], v[68:71]
  v_mfma_f32_16x16x32_bf16 v[72:75], v[112:115], v[240:243], v[72:75]
  s_waitcnt vmcnt(0) lgkmcnt(0)
  v_mfma_f32_16x16x32_bf16 v[56:59], v[116:119], v[244:247], v[56:59]
  v_mfma_f32_16x16x32_bf16 v[60:63], v[120:123], v[244:247], v[60:63]
  v_mfma_f32_16x16x32_bf16 v[64:67], v[124:127], v[244:247], v[64:67]
  v_mfma_f32_16x16x32_bf16 v[68:71], v[128:131], v[244:247], v[68:71]
  v_mfma_f32_16x16x32_bf16 v[72:75], v[132:135], v[244:247], v[72:75]
  s_nop 3
  v_cvt_pk_bf16_f32 v22, v56, v57
  v_cvt_pk_bf16_f32 v23, v58, v59
  v_cvt_pk_bf16_f32 v24, v60, v61
  v_cvt_pk_bf16_f32 v25, v62, v63
  v_cvt_pk_bf16_f32 v26, v64, v65
  v_cvt_pk_bf16_f32 v27, v66, v67
  v_cvt_pk_bf16_f32 v28, v68, v69
  v_cvt_pk_bf16_f32 v29, v70, v71
  v_cvt_pk_bf16_f32 v30, v72, v73
  v_cvt_pk_bf16_f32 v31, v74, v75
  ds_write_b128 v152, v[22:25]
  ds_write_b64 v153, v[30:31]
  ds_write_b128 v152, v[26:29] offset:64
  s_waitcnt lgkmcnt(0)
  ds_read_b128 v[56:59], v38 offset:38912
  ds_read_b128 v[60:63], v38 offset:39936
  ds_read_b128 v[64:67], v38 offset:40960
  s_waitcnt lgkmcnt(0)
  s_cmp_lg_u32 s56, 0
  s_cbranch_scc1 Lsafe_110
  buffer_store_dwordx4 v[56:59], v154, s[28:31], 0 offen
  buffer_store_dwordx4 v[60:63], v155, s[28:31], 0 offen
  buffer_store_dwordx4 v[64:67], v156, s[28:31], 0 offen
Lback_111:
  s_or_b32 s80, s2, s54
  s_cmp_lg_u32 s80, 0
  s_cbranch_scc1 L_noep
  s_mov_b64 exec, 1
  buffer_store_dword v17, v12, s[8:11], 0 offen
  s_mov_b64 exec, -1
L_noep:
  s_cmp_lg_u32 s57, 0
  s_cbranch_scc1 L_noto
  v_mov_b32 v48, 0xdead
  v_mov_b32 v49, 0
  buffer_store_dword v48, v49, s[96:99], 0 offen
L_noto:
L_end:
  s_endpgm
Lretry_13:
  s_cmp_eq_u32 s57, 0
  s_cbranch_scc1 Lp2ok_12
  s_sub_u32 s57, s57, 1
  buffer_load_dwordx4 v[168:171], v55, s[8:11], 0 offen sc1
  s_waitcnt vmcnt(0)
  s_branch Lp2chk_11
Lsafe_18:
  buffer_store_dwordx4 v[240:243], v7, s[8:11], s67 offen offset:0 sc1
  s_branch Lback_19
Lsafe_20:
  buffer_store_dwordx4 v[244:247], v7, s[8:11], s67 offen offset:512 sc1
  buffer_store_dwordx2 v[248:249], v8, s[8:11], s68 offen sc1
  s_branch Lback_21
Lsafe_22:
  buffer_store_dword v17, v12, s[8:11], s69 offen sc1
  s_branch Lback_23
Lsafe_28:
  buffer_store_dwordx4 v[22:25], v1, s[28:31], s64 offen sc1
  buffer_store_dwordx4 v[26:29], v1, s[28:31], s64 offen offset:2048 sc1
  buffer_store_dwordx2 v[30:31], v5, s[28:31], s65 offen sc1
  s_branch Lback_29
Lsafe_30:
  buffer_store_dwordx4 v[52:55], v6, s[8:11], s66 offen sc1
  s_branch Lback_31
Lnbe_39:
  s_mov_b32 s83, m0
  s_add_u32 m0, s45, 40960
  s_nop 0
  buffer_load_dwordx4 v1, s[8:11], s42 offen offset:0 sc1 lds
  buffer_load_dwordx4 v1, s[8:11], s42 offen offset:1024 sc1 lds
  buffer_load_dwordx4 v1, s[8:11], s42 offen offset:2048 sc1 lds
  buffer_load_dwordx4 v1, s[8:11], s42 offen offset:3072 sc1 lds
  s_add_u32 s84, s42, 4096
  s_add_u32 m0, s45, 45056
  s_nop 0
  buffer_load_dwordx4 v1, s[8:11], s84 offen sc1 lds
  s_mov_b32 m0, s83
  s_branch Lnbed_40
Lnbl_41:
  s_waitcnt vmcnt(8)
Lnbll_42:
  ds_read_b128 v[76:79], v19 offset:40960
  ds_read_b128 v[80:83], v19 offset:41216
  ds_read_b128 v[84:87], v19 offset:41984
  ds_read_b128 v[88:91], v19 offset:42240
  ds_read_b128 v[92:95], v43 offset:40960
  s_waitcnt lgkmcnt(0)
  v_add3_u32 v48, v76, v77, s44
  v_add3_u32 v49, v78, v79, v92
  v_add3_u32 v48, v80, v81, v48
  v_add3_u32 v49, v82, v83, v49
  v_add3_u32 v48, v84, v85, v48
  v_add3_u32 v49, v86, v87, v49
  v_add3_u32 v48, v88, v89, v48
  v_add3_u32 v49, v90, v91, v49
  v_add3_u32 v48, v48, v93, v94
  v_add_u32 v48, v48, v49
  v_cmp_ne_u32 vcc, v48, v95
  s_cbranch_vccz Lnbld_43
  s_cmp_eq_u32 s57, 0
  s_cbranch_scc1 Lnbld_43
  s_sub_u32 s57, s57, 1
  s_mov_b32 s83, m0
  s_add_u32 m0, s45, 40960
  s_nop 0
  buffer_load_dwordx4 v1, s[8:11], s42 offen offset:0 sc1 lds
  buffer_load_dwordx4 v1, s[8:11], s42 offen offset:1024 sc1 lds
  buffer_load_dwordx4 v1, s[8:11], s42 offen offset:2048 sc1 lds
  buffer_load_dwordx4 v1, s[8:11], s42 offen offset:3072 sc1 lds
  s_add_u32 s84, s42, 4096
  s_add_u32 m0, s45, 45056
  s_nop 0
  buffer_load_dwordx4 v1, s[8:11], s84 offen sc1 lds
  s_mov_b32 m0, s83
  s_waitcnt vmcnt(0)
  s_branch Lnbll_42
Lsafe_44:
  buffer_store_dwordx4 v[244:247], v7, s[8:11], s17 offen sc1
  s_branch Lback_45
Lsafe_48:
  buffer_store_dwordx4 v[244:247], v7, s[8:11], s17 offen sc1
  s_branch Lback_49
Lslow_46:
  v_mov_b32 v48, v9
  v_mov_b32 v49, v10
  v_mov_b32 v50, v11
  v_mov_b32 v52, 0xff800000
  s_mov_b32 s80, 0
  s_and_b32 s81, s76, -2
  s_add_u32 s81, s81, 0
  s_min_u32 s81, s81, 8
Lsl_100001:
  ds_read_b128 a[192:195], v48 offset:5120
  ds_read_b32 a196, v49 offset:5120
  s_cmp_eq_u32 s80, 0
  s_cselect_b64 s[86:87], -1, 0
  s_cmp_eq_u32 s80, 8
  s_cselect_b64 s[88:89], -1, 0
  v_cndmask_b32 v56, 0, v176, s[86:87]
  v_cndmask_b32 v56, v56, v192, s[88:89]
  v_cndmask_b32 v57, 0, v177, s[86:87]
  v_cndmask_b32 v57, v57, v193, s[88:89]
  v_cndmask_b32 v58, 0, v178, s[86:87]
  v_cndmask_b32 v58, v58, v194, s[88:89]
  v_cndmask_b32 v59, 0, v179, s[86:87]
  v_cndmask_b32 v59, v59, v195, s[88:89]
  v_cndmask_b32 v60, 0, v180, s[86:87]
  v_cndmask_b32 v60, v60, v196, s[88:89]
  v_cndmask_b32 v61, 0, v181, s[86:87]
  v_cndmask_b32 v61, v61, v197, s[88:89]
  v_cndmask_b32 v62, 0, v182, s[86:87]
  v_cndmask_b32 v62, v62, v198, s[88:89]
  v_cndmask_b32 v63, 0, v183, s[86:87]
  v_cndmask_b32 v63, v63, v199, s[88:89]
  v_cndmask_b32 v64, 0, v184, s[86:87]
  v_cndmask_b32 v64, v64, v200, s[88:89]
  v_cndmask_b32 v65, 0, v185, s[86:87]
  v_cndmask_b32 v65, v65, v201, s[88:89]
  v_cndmask_b32 v66, 0, v186, s[86:87]
  v_cndmask_b32 v66, v66, v202, s[88:89]
  v_cndmask_b32 v67, 0, v187, s[86:87]
  v_cndmask_b32 v67, v67, v203, s[88:89]
  v_cndmask_b32 v68, 0, v188, s[86:87]
  v_cndmask_b32 v68, v68, v204, s[88:89]
  v_cndmask_b32 v69, 0, v189, s[86:87]
  v_cndmask_b32 v69, v69, v205, s[88:89]
  v_cndmask_b32 v70, 0, v190, s[86:87]
  v_cndmask_b32 v70, v70, v206, s[88:89]
  v_cndmask_b32 v71, 0, v191, s[86:87]
  v_cndmask_b32 v71, v71, v207, s[88:89]
  s_waitcnt lgkmcnt(0)
  s_nop 0
  v_mfma_f32_32x32x16_bf16 v[112:127], a[192:195], v[156:159], v[56:71]
  v_mfma_f32_32x32x8_bf16 v[112:127], a[196:197], v[168:169], v[112:127]
  s_nop 11
  v_max_f32 v52, v52, v112
  v_max_f32 v52, v52, v113
  v_max_f32 v52, v52, v114
  v_max_f32 v52, v52, v115
  v_max_f32 v52, v52, v116
  v_max_f32 v52, v52, v117
  v_max_f32 v52, v52, v118
  v_max_f32 v52, v52, v119
  v_max_f32 v52, v52, v120
  v_max_f32 v52, v52, v121
  v_max_f32 v52, v52, v122
  v_max_f32 v52, v52, v123
  v_max_f32 v52, v52, v124
  v_max_f32 v52, v52, v125
  v_max_f32 v52, v52, v126
  v_max_f32 v52, v52, v127
  v_add_u32 v48, 5120, v48
  v_add_u32 v49, 5120, v49
  v_add_u32 v50, 5120, v50
  s_add_u32 s80, s80, 1
  s_cmp_le_u32 s80, s81
  s_cbranch_scc1 Lsl_100001
  v_mov_b32 v51, v52
  s_nop 1
  v_permlane32_swap_b32 v51, v52
  v_max_f32 v52, v52, v51
  v_mov_b32 v48, v9
  v_mov_b32 v49, v10
  v_mov_b32 v50, v11
  v_mov_b32 v208, 0
  v_mov_b32 v209, 0
  v_mov_b32 v210, 0
  v_mov_b32 v211, 0
  v_mov_b32 v212, 0
  v_mov_b32 v213, 0
  v_mov_b32 v214, 0
  v_mov_b32 v215, 0
  v_mov_b32 v216, 0
  v_mov_b32 v217, 0
  v_mov_b32 v218, 0
  v_mov_b32 v219, 0
  v_mov_b32 v220, 0
  v_mov_b32 v221, 0
  v_mov_b32 v222, 0
  v_mov_b32 v223, 0
  s_mov_b32 s80, 0
  s_and_b32 s81, s76, -2
  s_add_u32 s81, s81, 0
  s_min_u32 s81, s81, 8
Lsl_100002:
  ds_read_b128 a[192:195], v48 offset:5120
  ds_read_b32 a196, v49 offset:5120
  ds_read_b64_tr_b16 a[208:209], v50 offset:5120
  ds_read_b64_tr_b16 a[210:211], v50 offset:5248
  ds_read_b64_tr_b16 a[212:213], v50 offset:5376
  ds_read_b64_tr_b16 a[214:215], v50 offset:5504
  s_cmp_eq_u32 s80, 0
  s_cselect_b64 s[86:87], -1, 0
  s_cmp_eq_u32 s80, 8
  s_cselect_b64 s[88:89], -1, 0
  v_cndmask_b32 v56, 0, v176, s[86:87]
  v_cndmask_b32 v56, v56, v192, s[88:89]
  v_cndmask_b32 v57, 0, v177, s[86:87]
  v_cndmask_b32 v57, v57, v193, s[88:89]
  v_cndmask_b32 v58, 0, v178, s[86:87]
  v_cndmask_b32 v58, v58, v194, s[88:89]
  v_cndmask_b32 v59, 0, v179, s[86:87]
  v_cndmask_b32 v59, v59, v195, s[88:89]
  v_cndmask_b32 v60, 0, v180, s[86:87]
  v_cndmask_b32 v60, v60, v196, s[88:89]
  v_cndmask_b32 v61, 0, v181, s[86:87]
  v_cndmask_b32 v61, v61, v197, s[88:89]
  v_cndmask_b32 v62, 0, v182, s[86:87]
  v_cndmask_b32 v62, v62, v198, s[88:89]
  v_cndmask_b32 v63, 0, v183, s[86:87]
  v_cndmask_b32 v63, v63, v199, s[88:89]
  v_cndmask_b32 v64, 0, v184, s[86:87]
  v_cndmask_b32 v64, v64, v200, s[88:89]
  v_cndmask_b32 v65, 0, v185, s[86:87]
  v_cndmask_b32 v65, v65, v201, s[88:89]
  v_cndmask_b32 v66, 0, v186, s[86:87]
  v_cndmask_b32 v66, v66, v202, s[88:89]
  v_cndmask_b32 v67, 0, v187, s[86:87]
  v_cndmask_b32 v67, v67, v203, s[88:89]
  v_cndmask_b32 v68, 0, v188, s[86:87]
  v_cndmask_b32 v68, v68, v204, s[88:89]
  v_cndmask_b32 v69, 0, v189, s[86:87]
  v_cndmask_b32 v69, v69, v205, s[88:89]
  v_cndmask_b32 v70, 0, v190, s[86:87]
  v_cndmask_b32 v70, v70, v206, s[88:89]
  v_cndmask_b32 v71, 0, v191, s[86:87]
  v_cndmask_b32 v71, v71, v207, s[88:89]
  s_waitcnt lgkmcnt(0)
  s_nop 0
  v_mfma_f32_32x32x16_bf16 v[112:127], a[192:195], v[156:159], v[56:71]
  v_mfma_f32_32x32x8_bf16 v[112:127], a[196:197], v[168:169], v[112:127]
  s_nop 11
  v_sub_f32 v112, v112, v52
  v_sub_f32 v113, v113, v52
  v_sub_f32 v114, v114, v52
  v_sub_f32 v115, v115, v52
  v_sub_f32 v116, v116, v52
  v_sub_f32 v117, v117, v52
  v_sub_f32 v118, v118, v52
  v_sub_f32 v119, v119, v52
  v_sub_f32 v120, v120, v52
  v_sub_f32 v121, v121, v52
  v_sub_f32 v122, v122, v52
  v_sub_f32 v123, v123, v52
  v_sub_f32 v124, v124, v52
  v_sub_f32 v125, v125, v52
  v_sub_f32 v126, v126, v52
  v_sub_f32 v127, v127, v52
  v_exp_f32 v112, v112
  v_exp_f32 v113, v113
  v_exp_f32 v114, v114
  v_exp_f32 v115, v115
  v_exp_f32 v116, v116
  v_exp_f32 v117, v117
  v_exp_f32 v118, v118
  v_exp_f32 v119, v119
  v_exp_f32 v120, v120
  v_exp_f32 v121, v121
  v_exp_f32 v122, v122
  v_exp_f32 v123, v123
  v_exp_f32 v124, v124
  v_exp_f32 v125, v125
  v_exp_f32 v126, v126
  v_exp_f32 v127, v127
  v_cvt_pk_bf16_f32 v144, v112, v113
  v_cvt_pk_bf16_f32 v145, v114, v115
  v_cvt_pk_bf16_f32 v146, v116, v117
  v_cvt_pk_bf16_f32 v147, v118, v119
  v_cvt_pk_bf16_f32 v148, v120, v121
  v_cvt_pk_bf16_f32 v149, v122, v123
  v_cvt_pk_bf16_f32 v150, v124, v125
  v_cvt_pk_bf16_f32 v151, v126, v127
  v_mfma_f32_32x32x16_bf16 v[208:223], a[208:211], v[144:147], v[208:223]
  s_nop 0
  v_mfma_f32_32x32x16_bf16 v[208:223], a[212:215], v[148:151], v[208:223]
  v_add_u32 v48, 5120, v48
  v_add_u32 v49, 5120, v49
  v_add_u32 v50, 5120, v50
  s_add_u32 s80, s80, 1
  s_cmp_le_u32 s80, s81
  s_cbranch_scc1 Lsl_100002
  v_mov_b32 v48, v9
  v_mov_b32 v49, v10
  v_mov_b32 v50, v11
  v_mov_b32 v52, 0xff800000
  s_mov_b32 s80, 0
  s_and_b32 s81, s76, -2
  s_add_u32 s81, s81, 1
  s_min_u32 s81, s81, 8
Lsl_100003:
  ds_read_b128 a[192:195], v48 offset:0
  ds_read_b32 a196, v49 offset:0
  s_cmp_eq_u32 s80, 0
  s_cselect_b64 s[86:87], -1, 0
  s_cmp_eq_u32 s80, 8
  s_cselect_b64 s[88:89], -1, 0
  v_cndmask_b32 v56, 0, v176, s[86:87]
  v_cndmask_b32 v56, v56, v192, s[88:89]
  v_cndmask_b32 v57, 0, v177, s[86:87]
  v_cndmask_b32 v57, v57, v193, s[88:89]
  v_cndmask_b32 v58, 0, v178, s[86:87]
  v_cndmask_b32 v58, v58, v194, s[88:89]
  v_cndmask_b32 v59, 0, v179, s[86:87]
  v_cndmask_b32 v59, v59, v195, s[88:89]
  v_cndmask_b32 v60, 0, v180, s[86:87]
  v_cndmask_b32 v60, v60, v196, s[88:89]
  v_cndmask_b32 v61, 0, v181, s[86:87]
  v_cndmask_b32 v61, v61, v197, s[88:89]
  v_cndmask_b32 v62, 0, v182, s[86:87]
  v_cndmask_b32 v62, v62, v198, s[88:89]
  v_cndmask_b32 v63, 0, v183, s[86:87]
  v_cndmask_b32 v63, v63, v199, s[88:89]
  v_cndmask_b32 v64, 0, v184, s[86:87]
  v_cndmask_b32 v64, v64, v200, s[88:89]
  v_cndmask_b32 v65, 0, v185, s[86:87]
  v_cndmask_b32 v65, v65, v201, s[88:89]
  v_cndmask_b32 v66, 0, v186, s[86:87]
  v_cndmask_b32 v66, v66, v202, s[88:89]
  v_cndmask_b32 v67, 0, v187, s[86:87]
  v_cndmask_b32 v67, v67, v203, s[88:89]
  v_cndmask_b32 v68, 0, v188, s[86:87]
  v_cndmask_b32 v68, v68, v204, s[88:89]
  v_cndmask_b32 v69, 0, v189, s[86:87]
  v_cndmask_b32 v69, v69, v205, s[88:89]
  v_cndmask_b32 v70, 0, v190, s[86:87]
  v_cndmask_b32 v70, v70, v206, s[88:89]
  v_cndmask_b32 v71, 0, v191, s[86:87]
  v_cndmask_b32 v71, v71, v207, s[88:89]
  s_waitcnt lgkmcnt(0)
  s_nop 0
  v_mfma_f32_32x32x16_bf16 v[112:127], a[192:195], v[160:163], v[56:71]
  v_mfma_f32_32x32x8_bf16 v[112:127], a[196:197], v[170:171], v[112:127]
  s_nop 11
  v_max_f32 v52, v52, v112
  v_max_f32 v52, v52, v113
  v_max_f32 v52, v52, v114
  v_max_f32 v52, v52, v115
  v_max_f32 v52, v52, v116
  v_max_f32 v52, v52, v117
  v_max_f32 v52, v52, v118
  v_max_f32 v52, v52, v119
  v_max_f32 v52, v52, v120
  v_max_f32 v52, v52, v121
  v_max_f32 v52, v52, v122
  v_max_f32 v52, v52, v123
  v_max_f32 v52, v52, v124
  v_max_f32 v52, v52, v125
  v_max_f32 v52, v52, v126
  v_max_f32 v52, v52, v127
  v_add_u32 v48, 5120, v48
  v_add_u32 v49, 5120, v49
  v_add_u32 v50, 5120, v50
  s_add_u32 s80, s80, 1
  s_cmp_le_u32 s80, s81
  s_cbranch_scc1 Lsl_100003
  v_mov_b32 v51, v52
  s_nop 1
  v_permlane32_swap_b32 v51, v52
  v_max_f32 v52, v52, v51
  v_mov_b32 v48, v9
  v_mov_b32 v49, v10
  v_mov_b32 v50, v11
  v_mov_b32 v224, 0
  v_mov_b32 v225, 0
  v_mov_b32 v226, 0
  v_mov_b32 v227, 0
  v_mov_b32 v228, 0
  v_mov_b32 v229, 0
  v_mov_b32 v230, 0
  v_mov_b32 v231, 0
  v_mov_b32 v232, 0
  v_mov_b32 v233, 0
  v_mov_b32 v234, 0
  v_mov_b32 v235, 0
  v_mov_b32 v236, 0
  v_mov_b32 v237, 0
  v_mov_b32 v238, 0
  v_mov_b32 v239, 0
  s_mov_b32 s80, 0
  s_and_b32 s81, s76, -2
  s_add_u32 s81, s81, 1
  s_min_u32 s81, s81, 8
Lsl_100004:
  ds_read_b128 a[192:195], v48 offset:0
  ds_read_b32 a196, v49 offset:0
  ds_read_b64_tr_b16 a[208:209], v50 offset:0
  ds_read_b64_tr_b16 a[210:211], v50 offset:128
  ds_read_b64_tr_b16 a[212:213], v50 offset:256
  ds_read_b64_tr_b16 a[214:215], v50 offset:384
  s_cmp_eq_u32 s80, 0
  s_cselect_b64 s[86:87], -1, 0
  s_cmp_eq_u32 s80, 8
  s_cselect_b64 s[88:89], -1, 0
  v_cndmask_b32 v56, 0, v176, s[86:87]
  v_cndmask_b32 v56, v56, v192, s[88:89]
  v_cndmask_b32 v57, 0, v177, s[86:87]
  v_cndmask_b32 v57, v57, v193, s[88:89]
  v_cndmask_b32 v58, 0, v178, s[86:87]
  v_cndmask_b32 v58, v58, v194, s[88:89]
  v_cndmask_b32 v59, 0, v179, s[86:87]
  v_cndmask_b32 v59, v59, v195, s[88:89]
  v_cndmask_b32 v60, 0, v180, s[86:87]
  v_cndmask_b32 v60, v60, v196, s[88:89]
  v_cndmask_b32 v61, 0, v181, s[86:87]
  v_cndmask_b32 v61, v61, v197, s[88:89]
  v_cndmask_b32 v62, 0, v182, s[86:87]
  v_cndmask_b32 v62, v62, v198, s[88:89]
  v_cndmask_b32 v63, 0, v183, s[86:87]
  v_cndmask_b32 v63, v63, v199, s[88:89]
  v_cndmask_b32 v64, 0, v184, s[86:87]
  v_cndmask_b32 v64, v64, v200, s[88:89]
  v_cndmask_b32 v65, 0, v185, s[86:87]
  v_cndmask_b32 v65, v65, v201, s[88:89]
  v_cndmask_b32 v66, 0, v186, s[86:87]
  v_cndmask_b32 v66, v66, v202, s[88:89]
  v_cndmask_b32 v67, 0, v187, s[86:87]
  v_cndmask_b32 v67, v67, v203, s[88:89]
  v_cndmask_b32 v68, 0, v188, s[86:87]
  v_cndmask_b32 v68, v68, v204, s[88:89]
  v_cndmask_b32 v69, 0, v189, s[86:87]
  v_cndmask_b32 v69, v69, v205, s[88:89]
  v_cndmask_b32 v70, 0, v190, s[86:87]
  v_cndmask_b32 v70, v70, v206, s[88:89]
  v_cndmask_b32 v71, 0, v191, s[86:87]
  v_cndmask_b32 v71, v71, v207, s[88:89]
  s_waitcnt lgkmcnt(0)
  s_nop 0
  v_mfma_f32_32x32x16_bf16 v[112:127], a[192:195], v[160:163], v[56:71]
  v_mfma_f32_32x32x8_bf16 v[112:127], a[196:197], v[170:171], v[112:127]
  s_nop 11
  v_sub_f32 v112, v112, v52
  v_sub_f32 v113, v113, v52
  v_sub_f32 v114, v114, v52
  v_sub_f32 v115, v115, v52
  v_sub_f32 v116, v116, v52
  v_sub_f32 v117, v117, v52
  v_sub_f32 v118, v118, v52
  v_sub_f32 v119, v119, v52
  v_sub_f32 v120, v120, v52
  v_sub_f32 v121, v121, v52
  v_sub_f32 v122, v122, v52
  v_sub_f32 v123, v123, v52
  v_sub_f32 v124, v124, v52
  v_sub_f32 v125, v125, v52
  v_sub_f32 v126, v126, v52
  v_sub_f32 v127, v127, v52
  v_exp_f32 v112, v112
  v_exp_f32 v113, v113
  v_exp_f32 v114, v114
  v_exp_f32 v115, v115
  v_exp_f32 v116, v116
  v_exp_f32 v117, v117
  v_exp_f32 v118, v118
  v_exp_f32 v119, v119
  v_exp_f32 v120, v120
  v_exp_f32 v121, v121
  v_exp_f32 v122, v122
  v_exp_f32 v123, v123
  v_exp_f32 v124, v124
  v_exp_f32 v125, v125
  v_exp_f32 v126, v126
  v_exp_f32 v127, v127
  v_cvt_pk_bf16_f32 v144, v112, v113
  v_cvt_pk_bf16_f32 v145, v114, v115
  v_cvt_pk_bf16_f32 v146, v116, v117
  v_cvt_pk_bf16_f32 v147, v118, v119
  v_cvt_pk_bf16_f32 v148, v120, v121
  v_cvt_pk_bf16_f32 v149, v122, v123
  v_cvt_pk_bf16_f32 v150, v124, v125
  v_cvt_pk_bf16_f32 v151, v126, v127
  v_mfma_f32_32x32x16_bf16 v[224:239], a[208:211], v[144:147], v[224:239]
  s_nop 0
  v_mfma_f32_32x32x16_bf16 v[224:239], a[212:215], v[148:151], v[224:239]
  v_add_u32 v48, 5120, v48
  v_add_u32 v49, 5120, v49
  v_add_u32 v50, 5120, v50
  s_add_u32 s80, s80, 1
  s_cmp_le_u32 s80, s81
  s_cbranch_scc1 Lsl_100004
  s_nop 5
  v_rcp_f32 v236, v234
  s_nop 0
  v_pk_mul_f32 v[224:225], v[224:225], v[236:237] op_sel_hi:[1,0]
  v_pk_mul_f32 v[226:227], v[226:227], v[236:237] op_sel_hi:[1,0]
  v_pk_mul_f32 v[228:229], v[228:229], v[236:237] op_sel_hi:[1,0]
  v_pk_mul_f32 v[230:231], v[230:231], v[236:237] op_sel_hi:[1,0]
  v_pk_mul_f32 v[232:233], v[232:233], v[236:237] op_sel_hi:[1,0]
  v_cvt_pk_bf16_f32 v244, v224, v225
  v_cvt_pk_bf16_f32 v245, v226, v227
  v_cvt_pk_bf16_f32 v246, v228, v229
  v_cvt_pk_bf16_f32 v247, v230, v231
  s_cmp_lg_u32 s56, 0
  s_cbranch_scc1 Lsafe_48
  buffer_store_dwordx4 v[244:247], v7, s[8:11], s17 offen
Lback_49:
  v_cvt_pk_bf16_f32 v249, v232, v233
  s_mov_b32 s80, -1
  s_branch Lslowback_47
Lsafe_50:
  buffer_store_dwordx4 v[240:243], v7, s[8:11], s16 offen sc1
  buffer_store_dword v248, v175, s[8:11], s18 offen sc1
  s_branch Lback_51
Lsafe_52:
  buffer_store_dword v17, v48, s[8:11], s20 offen sc1
  s_branch Lback_53
Lsafe_58:
  buffer_store_dwordx4 v[22:25], v1, s[28:31], s64 offen sc1
  buffer_store_dwordx4 v[26:29], v1, s[28:31], s64 offen offset:2048 sc1
  buffer_store_dwordx2 v[30:31], v5, s[28:31], s65 offen sc1
  s_branch Lback_59
Lsafe_60:
  buffer_store_dwordx4 v[52:55], v6, s[8:11], s66 offen sc1
  s_branch Lback_61
Lsafe_70:
  buffer_store_dwordx4 v[240:243], v7, s[8:11], s67 offen offset:0 sc1
  s_branch Lback_71
Lsafe_72:
  buffer_store_dwordx4 v[244:247], v7, s[8:11], s67 offen offset:512 sc1
  buffer_store_dwordx2 v[248:249], v8, s[8:11], s68 offen sc1
  s_branch Lback_73
Lsafe_74:
  buffer_store_dword v17, v12, s[8:11], s69 offen sc1
  s_branch Lback_75
Lsafe_80:
  buffer_store_dwordx4 v[22:25], v1, s[28:31], s64 offen sc1
  buffer_store_dwordx4 v[26:29], v1, s[28:31], s64 offen offset:2048 sc1
  buffer_store_dwordx2 v[30:31], v5, s[28:31], s65 offen sc1
  s_branch Lback_81
Lsafe_82:
  buffer_store_dwordx4 v[52:55], v6, s[8:11], s66 offen sc1
  s_branch Lback_83
Lnbe_91:
  s_mov_b32 s83, m0
  s_add_u32 m0, s45, 40960
  s_nop 0
  buffer_load_dwordx4 v1, s[8:11], s42 offen offset:0 sc1 lds
  buffer_load_dwordx4 v1, s[8:11], s42 offen offset:1024 sc1 lds
  buffer_load_dwordx4 v1, s[8:11], s42 offen offset:2048 sc1 lds
  buffer_load_dwordx4 v1, s[8:11], s42 offen offset:3072 sc1 lds
  s_add_u32 s84, s42, 4096
  s_add_u32 m0, s45, 45056
  s_nop 0
  buffer_load_dwordx4 v1, s[8:11], s84 offen sc1 lds
  s_mov_b32 m0, s83
  s_branch Lnbed_92
Lnbl_93:
  s_waitcnt vmcnt(8)
Lnbll_94:
  ds_read_b128 v[76:79], v19 offset:40960
  ds_read_b128 v[80:83], v19 offset:41216
  ds_read_b128 v[84:87], v19 offset:41984
  ds_read_b128 v[88:91], v19 offset:42240
  ds_read_b128 v[92:95], v43 offset:40960
  s_waitcnt lgkmcnt(0)
  v_add3_u32 v48, v76, v77, s44
  v_add3_u32 v49, v78, v79, v92
  v_add3_u32 v48, v80, v81, v48
  v_add3_u32 v49, v82, v83, v49
  v_add3_u32 v48, v84, v85, v48
  v_add3_u32 v49, v86, v87, v49
  v_add3_u32 v48, v88, v89, v48
  v_add3_u32 v49, v90, v91, v49
  v_add3_u32 v48, v48, v93, v94
  v_add_u32 v48, v48, v49
  v_cmp_ne_u32 vcc, v48, v95
  s_cbranch_vccz Lnbld_95
  s_cmp_eq_u32 s57, 0
  s_cbranch_scc1 Lnbld_95
  s_sub_u32 s57, s57, 1
  s_mov_b32 s83, m0
  s_add_u32 m0, s45, 40960
  s_nop 0
  buffer_load_dwordx4 v1, s[8:11], s42 offen offset:0 sc1 lds
  buffer_load_dwordx4 v1, s[8:11], s42 offen offset:1024 sc1 lds
  buffer_load_dwordx4 v1, s[8:11], s42 offen offset:2048 sc1 lds
  buffer_load_dwordx4 v1, s[8:11], s42 offen offset:3072 sc1 lds
  s_add_u32 s84, s42, 4096
  s_add_u32 m0, s45, 45056
  s_nop 0
  buffer_load_dwordx4 v1, s[8:11], s84 offen sc1 lds
  s_mov_b32 m0, s83
  s_waitcnt vmcnt(0)
  s_branch Lnbll_94
Lsafe_96:
  buffer_store_dwordx4 v[244:247], v7, s[8:11], s17 offen sc1
  s_branch Lback_97
Lsafe_100:
  buffer_store_dwordx4 v[244:247], v7, s[8:11], s17 offen sc1
  s_branch Lback_101
Lslow_98:
  v_mov_b32 v48, v9
  v_mov_b32 v49, v10
  v_mov_b32 v50, v11
  v_mov_b32 v52, 0xff800000
  s_mov_b32 s80, 0
  s_and_b32 s81, s76, -2
  s_add_u32 s81, s81, 0
  s_min_u32 s81, s81, 8
Lsl_100005:
  ds_read_b128 a[192:195], v48 offset:5120
  ds_read_b32 a196, v49 offset:5120
  s_cmp_eq_u32 s80, 0
  s_cselect_b64 s[86:87], -1, 0
  s_cmp_eq_u32 s80, 8
  s_cselect_b64 s[88:89], -1, 0
  v_cndmask_b32 v56, 0, v176, s[86:87]
  v_cndmask_b32 v56, v56, v192, s[88:89]
  v_cndmask_b32 v57, 0, v177, s[86:87]
  v_cndmask_b32 v57, v57, v193, s[88:89]
  v_cndmask_b32 v58, 0, v178, s[86:87]
  v_cndmask_b32 v58, v58, v194, s[88:89]
  v_cndmask_b32 v59, 0, v179, s[86:87]
  v_cndmask_b32 v59, v59, v195, s[88:89]
  v_cndmask_b32 v60, 0, v180, s[86:87]
  v_cndmask_b32 v60, v60, v196, s[88:89]
  v_cndmask_b32 v61, 0, v181, s[86:87]
  v_cndmask_b32 v61, v61, v197, s[88:89]
  v_cndmask_b32 v62, 0, v182, s[86:87]
  v_cndmask_b32 v62, v62, v198, s[88:89]
  v_cndmask_b32 v63, 0, v183, s[86:87]
  v_cndmask_b32 v63, v63, v199, s[88:89]
  v_cndmask_b32 v64, 0, v184, s[86:87]
  v_cndmask_b32 v64, v64, v200, s[88:89]
  v_cndmask_b32 v65, 0, v185, s[86:87]
  v_cndmask_b32 v65, v65, v201, s[88:89]
  v_cndmask_b32 v66, 0, v186, s[86:87]
  v_cndmask_b32 v66, v66, v202, s[88:89]
  v_cndmask_b32 v67, 0, v187, s[86:87]
  v_cndmask_b32 v67, v67, v203, s[88:89]
  v_cndmask_b32 v68, 0, v188, s[86:87]
  v_cndmask_b32 v68, v68, v204, s[88:89]
  v_cndmask_b32 v69, 0, v189, s[86:87]
  v_cndmask_b32 v69, v69, v205, s[88:89]
  v_cndmask_b32 v70, 0, v190, s[86:87]
  v_cndmask_b32 v70, v70, v206, s[88:89]
  v_cndmask_b32 v71, 0, v191, s[86:87]
  v_cndmask_b32 v71, v71, v207, s[88:89]
  s_waitcnt lgkmcnt(0)
  s_nop 0
  v_mfma_f32_32x32x16_bf16 v[112:127], a[192:195], v[156:159], v[56:71]
  v_mfma_f32_32x32x8_bf16 v[112:127], a[196:197], v[168:169], v[112:127]
  s_nop 11
  v_max_f32 v52, v52, v112
  v_max_f32 v52, v52, v113
  v_max_f32 v52, v52, v114
  v_max_f32 v52, v52, v115
  v_max_f32 v52, v52, v116
  v_max_f32 v52, v52, v117
  v_max_f32 v52, v52, v118
  v_max_f32 v52, v52, v119
  v_max_f32 v52, v52, v120
  v_max_f32 v52, v52, v121
  v_max_f32 v52, v52, v122
  v_max_f32 v52, v52, v123
  v_max_f32 v52, v52, v124
  v_max_f32 v52, v52, v125
  v_max_f32 v52, v52, v126
  v_max_f32 v52, v52, v127
  v_add_u32 v48, 5120, v48
  v_add_u32 v49, 5120, v49
  v_add_u32 v50, 5120, v50
  s_add_u32 s80, s80, 1
  s_cmp_le_u32 s80, s81
  s_cbranch_scc1 Lsl_100005
  v_mov_b32 v51, v52
  s_nop 1
  v_permlane32_swap_b32 v51, v52
  v_max_f32 v52, v52, v51
  v_mov_b32 v48, v9
  v_mov_b32 v49, v10
  v_mov_b32 v50, v11
  v_mov_b32 v208, 0
  v_mov_b32 v209, 0
  v_mov_b32 v210, 0
  v_mov_b32 v211, 0
  v_mov_b32 v212, 0
  v_mov_b32 v213, 0
  v_mov_b32 v214, 0
  v_mov_b32 v215, 0
  v_mov_b32 v216, 0
  v_mov_b32 v217, 0
  v_mov_b32 v218, 0
  v_mov_b32 v219, 0
  v_mov_b32 v220, 0
  v_mov_b32 v221, 0
  v_mov_b32 v222, 0
  v_mov_b32 v223, 0
  s_mov_b32 s80, 0
  s_and_b32 s81, s76, -2
  s_add_u32 s81, s81, 0
  s_min_u32 s81, s81, 8
Lsl_100006:
  ds_read_b128 a[192:195], v48 offset:5120
  ds_read_b32 a196, v49 offset:5120
  ds_read_b64_tr_b16 a[208:209], v50 offset:5120
  ds_read_b64_tr_b16 a[210:211], v50 offset:5248
  ds_read_b64_tr_b16 a[212:213], v50 offset:5376
  ds_read_b64_tr_b16 a[214:215], v50 offset:5504
  s_cmp_eq_u32 s80, 0
  s_cselect_b64 s[86:87], -1, 0
  s_cmp_eq_u32 s80, 8
  s_cselect_b64 s[88:89], -1, 0
  v_cndmask_b32 v56, 0, v176, s[86:87]
  v_cndmask_b32 v56, v56, v192, s[88:89]
  v_cndmask_b32 v57, 0, v177, s[86:87]
  v_cndmask_b32 v57, v57, v193, s[88:89]
  v_cndmask_b32 v58, 0, v178, s[86:87]
  v_cndmask_b32 v58, v58, v194, s[88:89]
  v_cndmask_b32 v59, 0, v179, s[86:87]
  v_cndmask_b32 v59, v59, v195, s[88:89]
  v_cndmask_b32 v60, 0, v180, s[86:87]
  v_cndmask_b32 v60, v60, v196, s[88:89]
  v_cndmask_b32 v61, 0, v181, s[86:87]
  v_cndmask_b32 v61, v61, v197, s[88:89]
  v_cndmask_b32 v62, 0, v182, s[86:87]
  v_cndmask_b32 v62, v62, v198, s[88:89]
  v_cndmask_b32 v63, 0, v183, s[86:87]
  v_cndmask_b32 v63, v63, v199, s[88:89]
  v_cndmask_b32 v64, 0, v184, s[86:87]
  v_cndmask_b32 v64, v64, v200, s[88:89]
  v_cndmask_b32 v65, 0, v185, s[86:87]
  v_cndmask_b32 v65, v65, v201, s[88:89]
  v_cndmask_b32 v66, 0, v186, s[86:87]
  v_cndmask_b32 v66, v66, v202, s[88:89]
  v_cndmask_b32 v67, 0, v187, s[86:87]
  v_cndmask_b32 v67, v67, v203, s[88:89]
  v_cndmask_b32 v68, 0, v188, s[86:87]
  v_cndmask_b32 v68, v68, v204, s[88:89]
  v_cndmask_b32 v69, 0, v189, s[86:87]
  v_cndmask_b32 v69, v69, v205, s[88:89]
  v_cndmask_b32 v70, 0, v190, s[86:87]
  v_cndmask_b32 v70, v70, v206, s[88:89]
  v_cndmask_b32 v71, 0, v191, s[86:87]
  v_cndmask_b32 v71, v71, v207, s[88:89]
  s_waitcnt lgkmcnt(0)
  s_nop 0
  v_mfma_f32_32x32x16_bf16 v[112:127], a[192:195], v[156:159], v[56:71]
  v_mfma_f32_32x32x8_bf16 v[112:127], a[196:197], v[168:169], v[112:127]
  s_nop 11
  v_sub_f32 v112, v112, v52
  v_sub_f32 v113, v113, v52
  v_sub_f32 v114, v114, v52
  v_sub_f32 v115, v115, v52
  v_sub_f32 v116, v116, v52
  v_sub_f32 v117, v117, v52
  v_sub_f32 v118, v118, v52
  v_sub_f32 v119, v119, v52
  v_sub_f32 v120, v120, v52
  v_sub_f32 v121, v121, v52
  v_sub_f32 v122, v122, v52
  v_sub_f32 v123, v123, v52
  v_sub_f32 v124, v124, v52
  v_sub_f32 v125, v125, v52
  v_sub_f32 v126, v126, v52
  v_sub_f32 v127, v127, v52
  v_exp_f32 v112, v112
  v_exp_f32 v113, v113
  v_exp_f32 v114, v114
  v_exp_f32 v115, v115
  v_exp_f32 v116, v116
  v_exp_f32 v117, v117
  v_exp_f32 v118, v118
  v_exp_f32 v119, v119
  v_exp_f32 v120, v120
  v_exp_f32 v121, v121
  v_exp_f32 v122, v122
  v_exp_f32 v123, v123
  v_exp_f32 v124, v124
  v_exp_f32 v125, v125
  v_exp_f32 v126, v126
  v_exp_f32 v127, v127
  v_cvt_pk_bf16_f32 v144, v112, v113
  v_cvt_pk_bf16_f32 v145, v114, v115
  v_cvt_pk_bf16_f32 v146, v116, v117
  v_cvt_pk_bf16_f32 v147, v118, v119
  v_cvt_pk_bf16_f32 v148, v120, v121
  v_cvt_pk_bf16_f32 v149, v122, v123
  v_cvt_pk_bf16_f32 v150, v124, v125
  v_cvt_pk_bf16_f32 v151, v126, v127
  v_mfma_f32_32x32x16_bf16 v[208:223], a[208:211], v[144:147], v[208:223]
  s_nop 0
  v_mfma_f32_32x32x16_bf16 v[208:223], a[212:215], v[148:151], v[208:223]
  v_add_u32 v48, 5120, v48
  v_add_u32 v49, 5120, v49
  v_add_u32 v50, 5120, v50
  s_add_u32 s80, s80, 1
  s_cmp_le_u32 s80, s81
  s_cbranch_scc1 Lsl_100006
  v_mov_b32 v48, v9
  v_mov_b32 v49, v10
  v_mov_b32 v50, v11
  v_mov_b32 v52, 0xff800000
  s_mov_b32 s80, 0
  s_and_b32 s81, s76, -2
  s_add_u32 s81, s81, 1
  s_min_u32 s81, s81, 8
Lsl_100007:
  ds_read_b128 a[192:195], v48 offset:0
  ds_read_b32 a196, v49 offset:0
  s_cmp_eq_u32 s80, 0
  s_cselect_b64 s[86:87], -1, 0
  s_cmp_eq_u32 s80, 8
  s_cselect_b64 s[88:89], -1, 0
  v_cndmask_b32 v56, 0, v176, s[86:87]
  v_cndmask_b32 v56, v56, v192, s[88:89]
  v_cndmask_b32 v57, 0, v177, s[86:87]
  v_cndmask_b32 v57, v57, v193, s[88:89]
  v_cndmask_b32 v58, 0, v178, s[86:87]
  v_cndmask_b32 v58, v58, v194, s[88:89]
  v_cndmask_b32 v59, 0, v179, s[86:87]
  v_cndmask_b32 v59, v59, v195, s[88:89]
  v_cndmask_b32 v60, 0, v180, s[86:87]
  v_cndmask_b32 v60, v60, v196, s[88:89]
  v_cndmask_b32 v61, 0, v181, s[86:87]
  v_cndmask_b32 v61, v61, v197, s[88:89]
  v_cndmask_b32 v62, 0, v182, s[86:87]
  v_cndmask_b32 v62, v62, v198, s[88:89]
  v_cndmask_b32 v63, 0, v183, s[86:87]
  v_cndmask_b32 v63, v63, v199, s[88:89]
  v_cndmask_b32 v64, 0, v184, s[86:87]
  v_cndmask_b32 v64, v64, v200, s[88:89]
  v_cndmask_b32 v65, 0, v185, s[86:87]
  v_cndmask_b32 v65, v65, v201, s[88:89]
  v_cndmask_b32 v66, 0, v186, s[86:87]
  v_cndmask_b32 v66, v66, v202, s[88:89]
  v_cndmask_b32 v67, 0, v187, s[86:87]
  v_cndmask_b32 v67, v67, v203, s[88:89]
  v_cndmask_b32 v68, 0, v188, s[86:87]
  v_cndmask_b32 v68, v68, v204, s[88:89]
  v_cndmask_b32 v69, 0, v189, s[86:87]
  v_cndmask_b32 v69, v69, v205, s[88:89]
  v_cndmask_b32 v70, 0, v190, s[86:87]
  v_cndmask_b32 v70, v70, v206, s[88:89]
  v_cndmask_b32 v71, 0, v191, s[86:87]
  v_cndmask_b32 v71, v71, v207, s[88:89]
  s_waitcnt lgkmcnt(0)
  s_nop 0
  v_mfma_f32_32x32x16_bf16 v[112:127], a[192:195], v[160:163], v[56:71]
  v_mfma_f32_32x32x8_bf16 v[112:127], a[196:197], v[170:171], v[112:127]
  s_nop 11
  v_max_f32 v52, v52, v112
  v_max_f32 v52, v52, v113
  v_max_f32 v52, v52, v114
  v_max_f32 v52, v52, v115
  v_max_f32 v52, v52, v116
  v_max_f32 v52, v52, v117
  v_max_f32 v52, v52, v118
  v_max_f32 v52, v52, v119
  v_max_f32 v52, v52, v120
  v_max_f32 v52, v52, v121
  v_max_f32 v52, v52, v122
  v_max_f32 v52, v52, v123
  v_max_f32 v52, v52, v124
  v_max_f32 v52, v52, v125
  v_max_f32 v52, v52, v126
  v_max_f32 v52, v52, v127
  v_add_u32 v48, 5120, v48
  v_add_u32 v49, 5120, v49
  v_add_u32 v50, 5120, v50
  s_add_u32 s80, s80, 1
  s_cmp_le_u32 s80, s81
  s_cbranch_scc1 Lsl_100007
  v_mov_b32 v51, v52
  s_nop 1
  v_permlane32_swap_b32 v51, v52
  v_max_f32 v52, v52, v51
  v_mov_b32 v48, v9
  v_mov_b32 v49, v10
  v_mov_b32 v50, v11
  v_mov_b32 v224, 0
  v_mov_b32 v225, 0
  v_mov_b32 v226, 0
  v_mov_b32 v227, 0
  v_mov_b32 v228, 0
  v_mov_b32 v229, 0
  v_mov_b32 v230, 0
  v_mov_b32 v231, 0
  v_mov_b32 v232, 0
  v_mov_b32 v233, 0
  v_mov_b32 v234, 0
  v_mov_b32 v235, 0
  v_mov_b32 v236, 0
  v_mov_b32 v237, 0
  v_mov_b32 v238, 0
  v_mov_b32 v239, 0
  s_mov_b32 s80, 0
  s_and_b32 s81, s76, -2
  s_add_u32 s81, s81, 1
  s_min_u32 s81, s81, 8
Lsl_100008:
  ds_read_b128 a[192:195], v48 offset:0
  ds_read_b32 a196, v49 offset:0
  ds_read_b64_tr_b16 a[208:209], v50 offset:0
  ds_read_b64_tr_b16 a[210:211], v50 offset:128
  ds_read_b64_tr_b16 a[212:213], v50 offset:256
  ds_read_b64_tr_b16 a[214:215], v50 offset:384
  s_cmp_eq_u32 s80, 0
  s_cselect_b64 s[86:87], -1, 0
  s_cmp_eq_u32 s80, 8
  s_cselect_b64 s[88:89], -1, 0
  v_cndmask_b32 v56, 0, v176, s[86:87]
  v_cndmask_b32 v56, v56, v192, s[88:89]
  v_cndmask_b32 v57, 0, v177, s[86:87]
  v_cndmask_b32 v57, v57, v193, s[88:89]
  v_cndmask_b32 v58, 0, v178, s[86:87]
  v_cndmask_b32 v58, v58, v194, s[88:89]
  v_cndmask_b32 v59, 0, v179, s[86:87]
  v_cndmask_b32 v59, v59, v195, s[88:89]
  v_cndmask_b32 v60, 0, v180, s[86:87]
  v_cndmask_b32 v60, v60, v196, s[88:89]
  v_cndmask_b32 v61, 0, v181, s[86:87]
  v_cndmask_b32 v61, v61, v197, s[88:89]
  v_cndmask_b32 v62, 0, v182, s[86:87]
  v_cndmask_b32 v62, v62, v198, s[88:89]
  v_cndmask_b32 v63, 0, v183, s[86:87]
  v_cndmask_b32 v63, v63, v199, s[88:89]
  v_cndmask_b32 v64, 0, v184, s[86:87]
  v_cndmask_b32 v64, v64, v200, s[88:89]
  v_cndmask_b32 v65, 0, v185, s[86:87]
  v_cndmask_b32 v65, v65, v201, s[88:89]
  v_cndmask_b32 v66, 0, v186, s[86:87]
  v_cndmask_b32 v66, v66, v202, s[88:89]
  v_cndmask_b32 v67, 0, v187, s[86:87]
  v_cndmask_b32 v67, v67, v203, s[88:89]
  v_cndmask_b32 v68, 0, v188, s[86:87]
  v_cndmask_b32 v68, v68, v204, s[88:89]
  v_cndmask_b32 v69, 0, v189, s[86:87]
  v_cndmask_b32 v69, v69, v205, s[88:89]
  v_cndmask_b32 v70, 0, v190, s[86:87]
  v_cndmask_b32 v70, v70, v206, s[88:89]
  v_cndmask_b32 v71, 0, v191, s[86:87]
  v_cndmask_b32 v71, v71, v207, s[88:89]
  s_waitcnt lgkmcnt(0)
  s_nop 0
  v_mfma_f32_32x32x16_bf16 v[112:127], a[192:195], v[160:163], v[56:71]
  v_mfma_f32_32x32x8_bf16 v[112:127], a[196:197], v[170:171], v[112:127]
  s_nop 11
  v_sub_f32 v112, v112, v52
  v_sub_f32 v113, v113, v52
  v_sub_f32 v114, v114, v52
  v_sub_f32 v115, v115, v52
  v_sub_f32 v116, v116, v52
  v_sub_f32 v117, v117, v52
  v_sub_f32 v118, v118, v52
  v_sub_f32 v119, v119, v52
  v_sub_f32 v120, v120, v52
  v_sub_f32 v121, v121, v52
  v_sub_f32 v122, v122, v52
  v_sub_f32 v123, v123, v52
  v_sub_f32 v124, v124, v52
  v_sub_f32 v125, v125, v52
  v_sub_f32 v126, v126, v52
  v_sub_f32 v127, v127, v52
  v_exp_f32 v112, v112
  v_exp_f32 v113, v113
  v_exp_f32 v114, v114
  v_exp_f32 v115, v115
  v_exp_f32 v116, v116
  v_exp_f32 v117, v117
  v_exp_f32 v118, v118
  v_exp_f32 v119, v119
  v_exp_f32 v120, v120
  v_exp_f32 v121, v121
  v_exp_f32 v122, v122
  v_exp_f32 v123, v123
  v_exp_f32 v124, v124
  v_exp_f32 v125, v125
  v_exp_f32 v126, v126
  v_exp_f32 v127, v127
  v_cvt_pk_bf16_f32 v144, v112, v113
  v_cvt_pk_bf16_f32 v145, v114, v115
  v_cvt_pk_bf16_f32 v146, v116, v117
  v_cvt_pk_bf16_f32 v147, v118, v119
  v_cvt_pk_bf16_f32 v148, v120, v121
  v_cvt_pk_bf16_f32 v149, v122, v123
  v_cvt_pk_bf16_f32 v150, v124, v125
  v_cvt_pk_bf16_f32 v151, v126, v127
  v_mfma_f32_32x32x16_bf16 v[224:239], a[208:211], v[144:147], v[224:239]
  s_nop 0
  v_mfma_f32_32x32x16_bf16 v[224:239], a[212:215], v[148:151], v[224:239]
  v_add_u32 v48, 5120, v48
  v_add_u32 v49, 5120, v49
  v_add_u32 v50, 5120, v50
  s_add_u32 s80, s80, 1
  s_cmp_le_u32 s80, s81
  s_cbranch_scc1 Lsl_100008
  s_nop 5
  v_rcp_f32 v236, v234
  s_nop 0
  v_pk_mul_f32 v[224:225], v[224:225], v[236:237] op_sel_hi:[1,0]
  v_pk_mul_f32 v[226:227], v[226:227], v[236:237] op_sel_hi:[1,0]
  v_pk_mul_f32 v[228:229], v[228:229], v[236:237] op_sel_hi:[1,0]
  v_pk_mul_f32 v[230:231], v[230:231], v[236:237] op_sel_hi:[1,0]
  v_pk_mul_f32 v[232:233], v[232:233], v[236:237] op_sel_hi:[1,0]
  v_cvt_pk_bf16_f32 v244, v224, v225
  v_cvt_pk_bf16_f32 v245, v226, v227
  v_cvt_pk_bf16_f32 v246, v228, v229
  v_cvt_pk_bf16_f32 v247, v230, v231
  s_cmp_lg_u32 s56, 0
  s_cbranch_scc1 Lsafe_100
  buffer_store_dwordx4 v[244:247], v7, s[8:11], s17 offen
Lback_101:
  v_cvt_pk_bf16_f32 v249, v232, v233
  s_mov_b32 s80, -1
  s_branch Lslowback_99
Lsafe_102:
  buffer_store_dwordx4 v[240:243], v7, s[8:11], s16 offen sc1
  buffer_store_dword v248, v175, s[8:11], s18 offen sc1
  s_branch Lback_103
Lsafe_104:
  buffer_store_dword v17, v48, s[8:11], s20 offen sc1
  s_branch Lback_105
Lsafe_110:
  buffer_store_dwordx4 v[56:59], v154, s[28:31], 0 offen sc1
  buffer_store_dwordx4 v[60:63], v155, s[28:31], 0 offen sc1
  buffer_store_dwordx4 v[64:67], v156, s[28:31], 0 offen sc1
  s_branch Lback_111
L_codeend:
.section .rodata,"a"
.p2align 6
.amdhsa_kernel interleave_layers__linear_attn_block__sliding_block__prompt_kernel
  .amdhsa_next_free_vgpr 512
  .amdhsa_next_free_sgpr 102
  .amdhsa_accum_offset 256
  .amdhsa_group_segment_fixed_size 0
  .amdhsa_kernarg_size 72
  .amdhsa_user_sgpr_count 2
  .amdhsa_user_sgpr_kernarg_segment_ptr 1
  .amdhsa_system_sgpr_workgroup_id_x 1
.end_amdhsa_kernel
```
